```python
import torch

def _softmax(x, axis=-1):
    return torch.softmax(x, dim=axis)
def _gelu(x):
    return torch.nn.functional.gelu(x, approximate="tanh")
def _silu(x):
    return torch.nn.functional.silu(x)
def _sigmoid(x):
    return torch.sigmoid(x)
def _layernorm(x, axis=-1, eps=1e-5):
    m = x.mean(dim=axis, keepdim=True)
    v = x.var(dim=axis, keepdim=True, unbiased=False)
    return (x - m) / torch.sqrt(v + eps)
def _scatter_add(tgt, idx, src, axis=0):
    return tgt.clone().index_add_(axis, idx, src)
def _segment_sum(src, seg, n):
    out = torch.zeros((n,) + src.shape[1:], dtype=src.dtype)
    return out.index_add_(0, seg, src)
def _pad(x, pw):
    flat = tuple(v for pair in reversed(pw) for v in pair)
    return torch.nn.functional.pad(x, flat)

kernel_name = 'parallel_sum__sliding_block__glu_gated_glu__prompt'

def setup_inputs():

    _w = (lambda a: (lambda t: t.to(torch.bfloat16) if t.is_floating_point() else t)(torch.as_tensor(a)))
    def _A_setup():
        B, S, D = 1, 2048, 640
        return {
            "x": _w((lambda *s: torch.randn(*s, dtype=torch.bfloat16) * 0.05)(B, S, D)),
            "wqkv": _w((lambda *s: torch.randn(*s, dtype=torch.bfloat16) * 0.05)(D, 3 * D)),
            "wo": _w((lambda *s: torch.randn(*s, dtype=torch.bfloat16) * 0.05)(D, D)),
        }
    _A_in = _A_setup()

    def _B_setup():
        B, S, D, F = 1, 2048, 640, 1536
        return {
            "x": _w((lambda *s: torch.randn(*s, dtype=torch.bfloat16) * 0.05)(B, S, D)),
            "w_gate": _w((lambda *s: torch.randn(*s, dtype=torch.bfloat16) * 0.05)(D, F)),
            "w_up": _w((lambda *s: torch.randn(*s, dtype=torch.bfloat16) * 0.05)(D, F)),
            "w_down": _w((lambda *s: torch.randn(*s, dtype=torch.bfloat16) * 0.05)(F, D)),
        }
    _B_in = _B_setup()

    return {
        "A_x": _A_in["x"],
        "A_wqkv": _A_in["wqkv"],
        "A_wo": _A_in["wo"],
        "B_x": _B_in["x"],
        "B_w_gate": _B_in["w_gate"],
        "B_w_up": _B_in["w_up"],
        "B_w_down": _B_in["w_down"],
    }

def reference(A_x, A_wqkv, A_wo, B_x, B_w_gate, B_w_up, B_w_down):
    def _A_ref(x, wqkv, wo):
        B, S, D = x.shape
        H = 32; Dh = D // H; W = 256
        qkv = (lambda x, *d: x.permute(*d))((x @ wqkv).reshape(B, S, 3, H, Dh), 2, 0, 3, 1, 4)
        q, k, v = qkv[0], qkv[1], qkv[2]
        scores = torch.einsum("bhqd,bhkd->bhqk", q, k) * (Dh ** -0.5)
        idx = torch.arange(S)
        mask = (idx[:, None] - idx[None, :] >= 0) & (idx[:, None] - idx[None, :] < W)
        scores = torch.where(mask[None, None], scores, -1e9)
        p = _softmax(scores, axis=-1)
        o = torch.einsum("bhqk,bhkd->bhqd", p, v)
        return (lambda x, *d: x.permute(*d))(o, 0, 2, 1, 3).reshape(B, S, D) @ wo

    def _B_ref(x, w_gate, w_up, w_down):
        g = torch.einsum("bsd,df->bsf", x, w_gate)
        u = torch.einsum("bsd,df->bsf", x, w_up)
        h = _sigmoid(g) * u
        return torch.einsum("bsf,fd->bsd", h, w_down)

    x = A_x
    xn = _layernorm(x, axis=-1)
    return x + _A_ref(xn, A_wqkv, A_wo) + _B_ref(xn, B_w_gate, B_w_up, B_w_down)
```

```asm
; @launch grid=(256,1,1) block=(256,1,1) lds=163840
.amdgcn_target "amdgcn-amd-amdhsa--gfx950"
.text
.globl parallel_sum__sliding_block__glu_gated_glu__prompt_kernel
.p2align 8
.type parallel_sum__sliding_block__glu_gated_glu__prompt_kernel,@function
parallel_sum__sliding_block__glu_gated_glu__prompt_kernel:
    s_cmp_ge_u32 s2, 256
    s_cbranch_scc1 L_end
    s_load_dwordx2 s[24:25], s[0:1], 0
    s_load_dwordx2 s[28:29], s[0:1], 8
    s_load_dwordx2 s[32:33], s[0:1], 32
    s_load_dwordx2 s[36:37], s[0:1], 40
    s_load_dwordx2 s[40:41], s[0:1], 72
    s_load_dwordx2 s[56:57], s[0:1], 64
    s_load_dwordx2 s[44:45], s[0:1], 16
    s_load_dwordx2 s[48:49], s[0:1], 48
    s_load_dwordx2 s[52:53], s[0:1], 56
    s_getpc_b64 s[60:61]
L_pc:
    s_mov_b32 s62, L_codeend-L_pc
    s_mov_b32 s63, 0x20000
    v_lshrrev_b32 v1, 2, v0
    v_lshlrev_b32 v1, 7, v1
    s_bfe_u32 s3, s2, 0x30003
    s_lshl_b32 s3, s3, 13
    buffer_load_dword v255, v1, s[60:63], s3 offen
    v_lshrrev_b32 v1, 6, v0
    v_and_b32 v0, 63, v0
    v_readfirstlane_b32 s64, v1
    s_mov_b32 s26, 2621440
    s_mov_b32 s27, 0x20000
    s_mov_b32 s30, 2457600
    s_mov_b32 s31, 0x20000
    s_mov_b32 s34, 1966080
    s_mov_b32 s35, 0x20000
    s_mov_b32 s38, 1966080
    s_mov_b32 s39, 0x20000
    s_mov_b32 s42, 29360128
    s_mov_b32 s43, 0x20000
    s_mov_b32 s58, 256
    s_mov_b32 s59, 0x20000
    s_mov_b32 s46, 819200
    s_mov_b32 s47, 0x20000
    s_mov_b32 s50, 1966080
    s_mov_b32 s51, 0x20000
    s_mov_b32 s54, 2621440
    s_mov_b32 s55, 0x20000
    v_lshrrev_b32 v148, 5, v0
    v_and_b32 v149, 31, v0
    v_mul_u32_u24 v150, 1280, v148
    v_lshl_add_u32 v150, v149, 3, v150
    s_and_b32 s17, s2, 1
    s_bfe_u32 s18, s2, 0x20001
    s_lshr_b32 s19, s2, 3
    s_lshl_b32 s8, s17, 10
    s_lshl_b32 s9, s18, 8
    s_add_u32 s8, s8, s9
    s_lshl_b32 s9, s19, 3
    s_add_u32 s8, s8, s9
    s_lshl_b32 s9, s64, 1
    s_add_u32 s8, s8, s9
    s_mul_i32 s9, s8, 1280
    s_and_b32 s75, s2, 1
    s_lshl_b32 s75, s75, 3
    s_bfe_u32 s76, s2, 0x30003
    s_add_u32 s66, s75, s76
    s_bfe_u32 s75, s2, 0x20001
    s_lshl_b32 s75, s75, 2
    s_lshr_b32 s76, s2, 6
    s_add_u32 s67, s75, s76
    s_and_b32 s68, s64, 1
    s_lshr_b32 s69, s64, 1
    s_lshl_b32 s74, s64, 10
    v_lshrrev_b32 v32, 3, v0
    v_and_b32 v33, 7, v0
    v_lshrrev_b32 v34, 4, v0
    s_lshl_b32 s75, s68, 2
    v_add_u32 v35, s75, v34
    v_xor_b32 v35, v35, v33
    v_mul_u32_u24 v1, 1280, v32
    v_lshl_add_u32 v1, v35, 4, v1
    s_lshl_b32 s75, s66, 7
    s_lshl_b32 s76, s64, 3
    s_add_u32 s75, s75, s76
    s_mul_i32 s70, s75, 1280
    v_and_b32 v35, 15, v0
    v_lshlrev_b32 v36, 2, v34
    v_xor_b32 v35, v35, v36
    v_mul_u32_u24 v2, 3840, v34
    v_lshl_add_u32 v2, v35, 4, v2
    s_lshl_b32 s75, s67, 8
    s_cmp_eq_u32 s67, 15
    s_cselect_b32 s75, 0x40000000, s75
    s_mul_i32 s71, s64, 15360
    s_add_u32 s71, s71, s75
    s_and_b32 s23, s67, 3
    s_mul_i32 s23, s23, 3
    s_and_b32 s81, s66, 7
    s_add_u32 s23, s23, s81
    s_cmp_ge_u32 s23, 10
    s_cselect_b32 s81, 10, 0
    s_sub_u32 s23, s23, s81
    s_waitcnt lgkmcnt(0)
    s_mul_i32 s81, s23, 128
    s_add_u32 s70, s70, s81
    s_sub_u32 s0, s70, 1280
    s_mul_i32 s81, s23, 245760
    s_add_u32 s71, s71, s81
    s_sub_u32 s1, s71, 2457600
    s_mov_b32 s4, s70
    s_add_u32 m0, s74, 0
    s_add_u32 s81, s4, 0
    buffer_load_dwordx4 v1, s[24:27], s81 offen lds
    s_add_u32 m0, s74, 4096
    s_add_u32 s81, s4, 40960
    buffer_load_dwordx4 v1, s[24:27], s81 offen lds
    s_add_u32 m0, s74, 8192
    s_add_u32 s81, s4, 81920
    buffer_load_dwordx4 v1, s[24:27], s81 offen lds
    s_add_u32 m0, s74, 12288
    s_add_u32 s81, s4, 122880
    buffer_load_dwordx4 v1, s[24:27], s81 offen lds
    s_mov_b32 s4, s71
    s_add_u32 m0, s74, 16384
    s_add_u32 s81, s4, 0
    buffer_load_dwordx4 v2, s[28:31], s81 offen lds
    s_add_u32 m0, s74, 20480
    s_add_u32 s81, s4, 61440
    buffer_load_dwordx4 v2, s[28:31], s81 offen lds
    s_add_u32 m0, s74, 24576
    s_add_u32 s81, s4, 122880
    buffer_load_dwordx4 v2, s[28:31], s81 offen lds
    s_add_u32 m0, s74, 28672
    s_add_u32 s81, s4, 184320
    buffer_load_dwordx4 v2, s[28:31], s81 offen lds
    buffer_load_dwordx2 v[128:129], v150, s[24:27], s9 offen offset:0
    buffer_load_dwordx2 v[130:131], v150, s[24:27], s9 offen offset:256
    buffer_load_dwordx2 v[132:133], v150, s[24:27], s9 offen offset:512
    buffer_load_dwordx2 v[134:135], v150, s[24:27], s9 offen offset:768
    buffer_load_dwordx2 v[136:137], v150, s[24:27], s9 offen offset:1024
    s_memrealtime s[4:5]
    s_or_b32 s6, s2, s64
    s_lshl_b32 s6, s6, 12
    v_lshlrev_b32 v178, 8, v0
    s_waitcnt lgkmcnt(0)
    s_lshl_b64 s[4:5], s[4:5], 3
    s_bitset1_b32 s5, 31
    v_mov_b32 v176, s4
    v_mov_b32 v177, s5
    buffer_store_dwordx2 v[176:177], v178, s[56:59], s6 offen sc1
    v_mov_b32 v190, 0
    buffer_load_dwordx2 v[188:189], v190, s[56:59], 0 offen sc1
    v_lshrrev_b32 v32, 3, v0
    v_and_b32 v33, 7, v0
    v_lshrrev_b32 v34, 4, v0
    v_and_b32 v35, 1, v34
    v_lshlrev_b32 v35, 1, v35
    v_xor_b32 v35, v35, v33
    v_mul_u32_u24 v3, 3072, v32
    v_lshl_add_u32 v3, v35, 4, v3
    v_xor_b32 v4, 64, v3
    s_mul_i32 s75, s67, 192
    s_and_b32 s3, s67, 1
    s_lshl_b32 s76, s3, 6
    s_mul_i32 s72, s64, 24576
    s_add_u32 s72, s72, s75
    s_add_u32 s72, s72, s76
    v_lshrrev_b32 v35, 2, v0
    v_and_b32 v36, 3, v0
    v_mul_u32_u24 v5, 3072, v35
    v_lshl_add_u32 v5, v36, 4, v5
    v_xor_b32 v6, 32, v5
    s_mul_i32 s73, s64, 49152
    s_add_u32 s73, s73, s75
    s_lshl_b32 s76, s3, 7
    s_sub_u32 s73, s73, s76
    s_add_u32 s73, s73, 128
    s_mul_i32 s81, s23, 196608
    s_add_u32 s72, s72, s81
    s_sub_u32 s21, s72, 1966080
    s_mul_i32 s81, s23, 196608
    s_add_u32 s73, s73, s81
    s_sub_u32 s22, s73, 1966080
    v_and_b32 v32, 31, v0
    v_lshrrev_b32 v33, 5, v0
    v_bfe_u32 v35, v0, 1, 3
    v_xor_b32 v35, v35, v33
    s_lshl_b32 s75, s68, 13
    v_lshlrev_b32 v36, 7, v32
    v_add_u32 v36, s75, v36
    v_xor_b32 v37, 0, v35
    v_lshl_add_u32 v7, v37, 4, v36
    v_xor_b32 v37, 2, v35
    v_lshl_add_u32 v8, v37, 4, v36
    v_xor_b32 v37, 4, v35
    v_lshl_add_u32 v9, v37, 4, v36
    v_xor_b32 v37, 6, v35
    v_lshl_add_u32 v10, v37, 4, v36
    v_bfe_u32 v35, v0, 2, 2
    v_and_b32 v36, 1, v0
    v_bfe_u32 v37, v0, 1, 1
    v_lshl_or_b32 v36, v36, 1, v37
    v_bfe_u32 v37, v0, 4, 1
    v_lshl_add_u32 v38, v33, 3, v35
    s_lshl_b32 s75, s69, 1
    v_lshlrev_b32 v39, 8, v38
    v_lshl_add_u32 v39, v37, 5, v39
    v_lshl_add_u32 v39, v36, 3, v39
    v_xor_b32 v34, s75, v35
    v_lshl_add_u32 v11, v34, 6, v39
    v_xor_b32 v12, 64, v11
    v_lshlrev_b32 v39, 7, v38
    v_lshl_add_u32 v39, v37, 13, v39
    v_lshl_add_u32 v39, v36, 3, v39
    v_lshrrev_b32 v34, 1, v35
    v_lshl_or_b32 v34, v37, 1, v34
    v_xor_b32 v34, s75, v34
    v_lshl_add_u32 v13, v34, 5, v39
    v_xor_b32 v14, 32, v13
    v_lshlrev_b32 v39, 6, v38
    v_lshl_add_u32 v39, v37, 13, v39
    v_lshl_add_u32 v39, v36, 3, v39
    v_xor_b32 v34, s69, v37
    v_lshl_add_u32 v15, v34, 5, v39
    v_lshlrev_b32 v16, 4, v0
    v_bfe_u32 v34, v0, 2, 1
    v_bfe_u32 v35, v0, 3, 1
    v_lshl_or_b32 v34, v34, 1, v35
    v_and_b32 v35, 3, v0
    v_lshl_add_u32 v34, v34, 2, v35
    v_lshl_add_u32 v35, v37, 4, v34
    v_lshlrev_b32 v26, 3, v35
    v_mul_u32_u24 v17, 10368, v33
    v_lshl_add_u32 v17, v35, 4, v17
    v_mul_u32_u24 v27, 12288, v37
    v_lshl_add_u32 v27, v34, 3, v27
    s_lshl_b32 s80, s66, 7
    s_lshl_b32 s75, s68, 6
    s_add_u32 s80, s80, s75
    v_mul_u32_u24 v35, 24576, v33
    v_add_u32 v35, v35, v27
    v_mov_b32 v34, v27
    s_lshl_b32 s7, s66, 4
    s_add_u32 s7, s7, s67
    s_lshl_b32 s7, s7, 7
    s_add_u32 s7, s7, 32768
    v_bfe_u32 v36, v0, 2, 1
    v_bfe_u32 v37, v0, 4, 1
    v_xor_b32 v36, v36, v37
    v_and_b32 v37, 3, v0
    v_or_b32 v36, v36, v37
    v_mov_b32 v37, 0x3f803f80
    v_cmp_eq_u32 vcc, 0, v36
    s_nop 1
    v_cndmask_b32 v180, 0, v37, vcc
    v_cndmask_b32 v181, 0, v37, vcc
    v_cndmask_b32 v182, 0, v37, vcc
    v_cndmask_b32 v183, 0, v37, vcc
    s_lshl_b32 s17, s17, 5
    s_add_u32 s17, s17, s19
    s_min_u32 s17, s17, 59
    s_mul_i32 s10, s17, 171
    s_lshr_b32 s10, s10, 11
    s_mul_i32 s11, s10, 12
    s_sub_u32 s11, s17, s11
    s_cmp_lt_u32 s11, 6
    s_cselect_b32 s60, s32, s36
    s_cselect_b32 s61, s33, s37
    s_cselect_b32 s12, 0, 6
    s_cselect_b32 s13, 0, 24
    s_mov_b32 s62, 1966080
    s_mov_b32 s63, 0x20000
    s_sub_u32 s11, s11, s12
    s_mul_i32 s12, s18, 6
    s_add_u32 s11, s11, s12
    s_lshl_b32 s14, s10, 7
    s_lshl_b32 s15, s64, 3
    s_add_u32 s14, s14, s15
    s_mul_i32 s14, s14, 3072
    s_lshl_b32 s15, s11, 7
    s_add_u32 s14, s14, s15
    s_add_u32 s11, s11, s13
    s_cmp_ge_u32 s67, 10
    s_cbranch_scc1 L_g1_V
L_g1_T:
    s_waitcnt vmcnt(7)
    s_barrier
    s_cmp_ge_u32 s23, 9
    s_cselect_b32 s4, s0, s70
    s_add_u32 m0, s74, 32768
    s_add_u32 s81, s4, 128
    buffer_load_dwordx4 v1, s[24:27], s81 offen lds
    s_add_u32 m0, s74, 36864
    s_add_u32 s81, s4, 41088
    buffer_load_dwordx4 v1, s[24:27], s81 offen lds
    s_add_u32 m0, s74, 40960
    s_add_u32 s81, s4, 82048
    buffer_load_dwordx4 v1, s[24:27], s81 offen lds
    s_add_u32 m0, s74, 45056
    s_add_u32 s81, s4, 123008
    buffer_load_dwordx4 v1, s[24:27], s81 offen lds
    s_cmp_ge_u32 s23, 9
    s_cselect_b32 s4, s1, s71
    s_add_u32 m0, s74, 49152
    s_add_u32 s81, s4, 245760
    buffer_load_dwordx4 v2, s[28:31], s81 offen lds
    s_add_u32 m0, s74, 53248
    s_add_u32 s81, s4, 307200
    buffer_load_dwordx4 v2, s[28:31], s81 offen lds
    s_add_u32 m0, s74, 57344
    s_add_u32 s81, s4, 368640
    buffer_load_dwordx4 v2, s[28:31], s81 offen lds
    s_add_u32 m0, s74, 61440
    s_add_u32 s81, s4, 430080
    buffer_load_dwordx4 v2, s[28:31], s81 offen lds
    ds_read_b128 a[0:3], v7 offset:0
    ds_read_b128 a[4:7], v7 offset:4096
    ds_read_b128 a[8:11], v8 offset:0
    ds_read_b128 a[12:15], v8 offset:4096
    ds_read_b128 a[16:19], v9 offset:0
    ds_read_b128 a[20:23], v9 offset:4096
    ds_read_b128 a[24:27], v10 offset:0
    ds_read_b128 a[28:31], v10 offset:4096
    v_add_u32 v11, 0x4000, v11
    ds_read_b64_tr_b16 v[40:41], v11 offset:0
    ds_read_b64_tr_b16 v[42:43], v11 offset:1024
    v_add_u32 v12, 0x4000, v12
    ds_read_b64_tr_b16 v[44:45], v12 offset:0
    ds_read_b64_tr_b16 v[46:47], v12 offset:1024
    ds_read_b64_tr_b16 v[48:49], v11 offset:4096
    ds_read_b64_tr_b16 v[50:51], v11 offset:5120
    ds_read_b64_tr_b16 v[52:53], v12 offset:4096
    ds_read_b64_tr_b16 v[54:55], v12 offset:5120
    ds_read_b64_tr_b16 v[56:57], v11 offset:8192
    ds_read_b64_tr_b16 v[58:59], v11 offset:9216
    ds_read_b64_tr_b16 v[60:61], v12 offset:8192
    ds_read_b64_tr_b16 v[62:63], v12 offset:9216
    s_waitcnt lgkmcnt(10)
    v_mfma_f32_32x32x16_bf16 v[64:79], v[40:43], a[0:3], 0
    s_cmp_ge_u32 s23, 8
    s_cselect_b32 s4, s0, s70
    s_add_u32 m0, s74, 65536
    s_add_u32 s81, s4, 256
    buffer_load_dwordx4 v1, s[24:27], s81 offen lds
    v_mfma_f32_16x16x32_bf16 v[36:39], v[180:183], v[40:43], 0
    s_waitcnt vmcnt(11)
    v_lshlrev_b32 v138, 16, v128
    v_and_b32 v128, 0xffff0000, v128
    v_mfma_f32_32x32x16_bf16 v[80:95], v[40:43], a[4:7], 0
    ds_read_b64_tr_b16 v[40:41], v11 offset:12288
    ds_read_b64_tr_b16 v[42:43], v11 offset:13312
    s_add_u32 m0, s74, 69632
    s_add_u32 s81, s4, 41216
    buffer_load_dwordx4 v1, s[24:27], s81 offen lds
    s_waitcnt lgkmcnt(10)
    v_mfma_f32_32x32x16_bf16 v[96:111], v[44:47], a[0:3], 0
    s_add_u32 m0, s74, 73728
    s_add_u32 s81, s4, 82176
    buffer_load_dwordx4 v1, s[24:27], s81 offen lds
    v_lshlrev_b32 v139, 16, v129
    v_and_b32 v129, 0xffff0000, v129
    v_mfma_f32_16x16x32_bf16 v[30:33], v[180:183], v[44:47], 0
    v_lshlrev_b32 v140, 16, v130
    v_and_b32 v130, 0xffff0000, v130
    v_mfma_f32_32x32x16_bf16 v[112:127], v[44:47], a[4:7], 0
    ds_read_b64_tr_b16 v[44:45], v12 offset:12288
    ds_read_b64_tr_b16 v[46:47], v12 offset:13312
    s_add_u32 m0, s74, 77824
    s_add_u32 s81, s4, 123136
    buffer_load_dwordx4 v1, s[24:27], s81 offen lds
    s_waitcnt lgkmcnt(10)
    v_mfma_f32_32x32x16_bf16 v[64:79], v[48:51], a[8:11], v[64:79]
    s_waitcnt vmcnt(8)
    s_waitcnt vmcnt(4)
    s_barrier
    s_cmp_ge_u32 s23, 8
    s_cselect_b32 s4, s1, s71
    s_add_u32 m0, s74, 81920
    s_add_u32 s81, s4, 491520
    buffer_load_dwordx4 v2, s[28:31], s81 offen lds
    v_mfma_f32_16x16x32_bf16 v[36:39], v[180:183], v[48:51], v[36:39]
    v_lshlrev_b32 v141, 16, v131
    v_and_b32 v131, 0xffff0000, v131
    v_mfma_f32_32x32x16_bf16 v[80:95], v[48:51], a[12:15], v[80:95]
    v_add_u32 v11, 0x8000, v11
    ds_read_b64_tr_b16 v[48:49], v11 offset:0
    ds_read_b64_tr_b16 v[50:51], v11 offset:1024
    v_add_u32 v7, 0x8000, v7
    ds_read_b128 a[32:35], v7 offset:0
    s_waitcnt lgkmcnt(11)
    v_mfma_f32_32x32x16_bf16 v[96:111], v[52:55], a[8:11], v[96:111]
    s_add_u32 m0, s74, 86016
    s_add_u32 s81, s4, 552960
    buffer_load_dwordx4 v2, s[28:31], s81 offen lds
    v_lshlrev_b32 v142, 16, v132
    v_and_b32 v132, 0xffff0000, v132
    v_mfma_f32_16x16x32_bf16 v[30:33], v[180:183], v[52:55], v[30:33]
    v_lshlrev_b32 v143, 16, v133
    v_and_b32 v133, 0xffff0000, v133
    v_mfma_f32_32x32x16_bf16 v[112:127], v[52:55], a[12:15], v[112:127]
    v_add_u32 v12, 0x8000, v12
    ds_read_b64_tr_b16 v[52:53], v12 offset:0
    ds_read_b64_tr_b16 v[54:55], v12 offset:1024
    ds_read_b128 a[36:39], v7 offset:4096
    s_add_u32 m0, s74, 90112
    s_add_u32 s81, s4, 614400
    buffer_load_dwordx4 v2, s[28:31], s81 offen lds
    s_waitcnt lgkmcnt(12)
    v_mfma_f32_32x32x16_bf16 v[64:79], v[56:59], a[16:19], v[64:79]
    v_lshlrev_b32 v144, 16, v134
    v_and_b32 v134, 0xffff0000, v134
    v_lshlrev_b32 v145, 16, v135
    v_and_b32 v135, 0xffff0000, v135
    v_lshlrev_b32 v146, 16, v136
    v_and_b32 v136, 0xffff0000, v136
    v_mfma_f32_16x16x32_bf16 v[36:39], v[180:183], v[56:59], v[36:39]
    v_lshlrev_b32 v147, 16, v137
    v_and_b32 v137, 0xffff0000, v137
    v_mfma_f32_32x32x16_bf16 v[80:95], v[56:59], a[20:23], v[80:95]
    ds_read_b64_tr_b16 v[56:57], v11 offset:4096
    ds_read_b64_tr_b16 v[58:59], v11 offset:5120
    v_add_u32 v8, 0x8000, v8
    ds_read_b128 a[40:43], v8 offset:0
    s_add_u32 m0, s74, 94208
    s_add_u32 s81, s4, 675840
    buffer_load_dwordx4 v2, s[28:31], s81 offen lds
    s_waitcnt lgkmcnt(13)
    v_mfma_f32_32x32x16_bf16 v[96:111], v[60:63], a[16:19], v[96:111]
    v_lshrrev_b32 v176, 3, v0
    v_and_b32 v177, 7, v0
    v_mul_u32_u24 v176, 3072, v176
    v_lshl_add_u32 v176, v177, 4, v176
    buffer_load_dwordx4 v[152:155], v176, s[60:63], s14 offen
    v_mfma_f32_16x16x32_bf16 v[30:33], v[180:183], v[60:63], v[30:33]
    v_add_f32 v184, v138, v139
    v_add_f32 v178, v140, v141
    v_mfma_f32_32x32x16_bf16 v[112:127], v[60:63], a[20:23], v[112:127]
    ds_read_b64_tr_b16 v[60:61], v12 offset:4096
    ds_read_b64_tr_b16 v[62:63], v12 offset:5120
    ds_read_b128 a[44:47], v8 offset:4096
    s_add_u32 s14, s14, 98304
    buffer_load_dwordx4 v[156:159], v176, s[60:63], s14 offen
    s_waitcnt lgkmcnt(14)
    v_mfma_f32_32x32x16_bf16 v[64:79], v[40:43], a[24:27], v[64:79]
    v_add_f32 v184, v184, v142
    v_add_f32 v178, v178, v143
    v_add_f32 v184, v184, v144
    v_add_f32 v178, v178, v145
    v_add_f32 v184, v184, v146
    v_add_f32 v178, v178, v147
    v_mfma_f32_16x16x32_bf16 v[36:39], v[180:183], v[40:43], v[36:39]
    v_add_f32 v184, v184, v128
    v_add_f32 v178, v178, v129
    v_mfma_f32_32x32x16_bf16 v[80:95], v[40:43], a[28:31], v[80:95]
    ds_read_b64_tr_b16 v[40:41], v11 offset:8192
    ds_read_b64_tr_b16 v[42:43], v11 offset:9216
    v_add_u32 v9, 0x8000, v9
    ds_read_b128 a[48:51], v9 offset:0
    s_add_u32 s14, s14, 98304
    buffer_load_dwordx4 v[160:163], v176, s[60:63], s14 offen
    s_waitcnt lgkmcnt(15)
    v_mfma_f32_32x32x16_bf16 v[96:111], v[44:47], a[24:27], v[96:111]
    v_add_f32 v184, v184, v130
    v_add_f32 v178, v178, v131
    v_add_f32 v184, v184, v132
    v_add_f32 v178, v178, v133
    v_add_f32 v184, v184, v134
    v_add_f32 v178, v178, v135
    v_mfma_f32_16x16x32_bf16 v[30:33], v[180:183], v[44:47], v[30:33]
    v_add_f32 v184, v184, v136
    v_add_f32 v178, v178, v137
    v_mfma_f32_32x32x16_bf16 v[112:127], v[44:47], a[28:31], v[112:127]
    ds_read_b64_tr_b16 v[44:45], v12 offset:8192
    ds_read_b64_tr_b16 v[46:47], v12 offset:9216
    ds_read_b128 a[52:55], v9 offset:4096
    s_add_u32 s14, s14, 98304
    buffer_load_dwordx4 v[164:167], v176, s[60:63], s14 offen
    s_waitcnt lgkmcnt(15)
    v_mfma_f32_32x32x16_bf16 v[64:79], v[48:51], a[32:35], v[64:79]
    s_cmp_ge_u32 s23, 7
    s_cselect_b32 s4, s0, s70
    s_add_u32 m0, s74, 98304
    s_add_u32 s81, s4, 384
    buffer_load_dwordx4 v1, s[24:27], s81 offen lds
    v_mfma_f32_16x16x32_bf16 v[36:39], v[180:183], v[48:51], v[36:39]
    v_add_f32 v184, v184, v178
    s_nop 1
    v_add_f32_dpp v184, v184, v184 quad_perm:[1,0,3,2] row_mask:0xf bank_mask:0xf
    s_waitcnt lgkmcnt(12)
    v_mfma_f32_32x32x16_bf16 v[80:95], v[48:51], a[36:39], v[80:95]
    ds_read_b64_tr_b16 v[48:49], v11 offset:12288
    ds_read_b64_tr_b16 v[50:51], v11 offset:13312
    v_add_u32 v10, 0x8000, v10
    ds_read_b128 a[56:59], v10 offset:0
    s_add_u32 m0, s74, 102400
    s_add_u32 s81, s4, 41344
    buffer_load_dwordx4 v1, s[24:27], s81 offen lds
    v_mfma_f32_32x32x16_bf16 v[96:111], v[52:55], a[32:35], v[96:111]
    v_add_f32_dpp v184, v184, v184 quad_perm:[2,3,0,1] row_mask:0xf bank_mask:0xf
    s_nop 1
    v_add_f32_dpp v184, v184, v184 row_half_mirror row_mask:0xf bank_mask:0xf
    s_nop 1
    v_add_f32_dpp v184, v184, v184 row_mirror row_mask:0xf bank_mask:0xf
    v_mov_b32 v178, v184
    s_nop 1
    v_permlane16_swap_b32 v184, v178
    s_nop 1
    v_add_f32 v184, v184, v178
    v_mfma_f32_16x16x32_bf16 v[30:33], v[180:183], v[52:55], v[30:33]
    v_mul_f32 v184, 0x3acccccd, v184
    v_mov_b32 v185, 0
    v_mov_b32 v179, 0
    v_mfma_f32_32x32x16_bf16 v[112:127], v[52:55], a[36:39], v[112:127]
    ds_read_b64_tr_b16 v[52:53], v12 offset:12288
    ds_read_b64_tr_b16 v[54:55], v12 offset:13312
    ds_read_b128 a[60:63], v10 offset:4096
    s_add_u32 m0, s74, 106496
    s_add_u32 s81, s4, 82304
    buffer_load_dwordx4 v1, s[24:27], s81 offen lds
    s_waitcnt lgkmcnt(15)
    v_mfma_f32_32x32x16_bf16 v[64:79], v[56:59], a[40:43], v[64:79]
    s_waitcnt vmcnt(11)
    s_waitcnt vmcnt(7)
    s_barrier
    v_sub_f32 v138, v138, v184
    v_sub_f32 v139, v139, v184
    v_fmac_f32 v185, v138, v138
    v_fmac_f32 v179, v139, v139
    v_mfma_f32_16x16x32_bf16 v[36:39], v[180:183], v[56:59], v[36:39]
    v_sub_f32 v140, v140, v184
    v_sub_f32 v141, v141, v184
    s_waitcnt lgkmcnt(12)
    v_mfma_f32_32x32x16_bf16 v[80:95], v[56:59], a[44:47], v[80:95]
    v_add_u32 v11, 0x8000, v11
    ds_read_b64_tr_b16 v[56:57], v11 offset:0
    ds_read_b64_tr_b16 v[58:59], v11 offset:1024
    v_add_u32 v7, 0x8000, v7
    ds_read_b128 a[64:67], v7 offset:0
    v_mfma_f32_32x32x16_bf16 v[96:111], v[60:63], a[40:43], v[96:111]
    s_add_u32 m0, s74, 110592
    s_add_u32 s81, s4, 123264
    buffer_load_dwordx4 v1, s[24:27], s81 offen lds
    v_fmac_f32 v185, v140, v140
    v_fmac_f32 v179, v141, v141
    v_mfma_f32_16x16x32_bf16 v[30:33], v[180:183], v[60:63], v[30:33]
    v_sub_f32 v142, v142, v184
    v_sub_f32 v143, v143, v184
    v_mfma_f32_32x32x16_bf16 v[112:127], v[60:63], a[44:47], v[112:127]
    v_add_u32 v12, 0x8000, v12
    ds_read_b64_tr_b16 v[60:61], v12 offset:0
    ds_read_b64_tr_b16 v[62:63], v12 offset:1024
    ds_read_b128 a[68:71], v7 offset:4096
    s_cmp_ge_u32 s23, 7
    s_cselect_b32 s4, s1, s71
    s_add_u32 m0, s74, 114688
    s_add_u32 s81, s4, 737280
    buffer_load_dwordx4 v2, s[28:31], s81 offen lds
    s_waitcnt lgkmcnt(15)
    v_mfma_f32_32x32x16_bf16 v[64:79], v[40:43], a[48:51], v[64:79]
    s_add_u32 m0, s74, 118784
    s_add_u32 s81, s4, 798720
    buffer_load_dwordx4 v2, s[28:31], s81 offen lds
    v_fmac_f32 v185, v142, v142
    v_fmac_f32 v179, v143, v143
    v_mfma_f32_16x16x32_bf16 v[36:39], v[180:183], v[40:43], v[36:39]
    v_sub_f32 v144, v144, v184
    v_sub_f32 v145, v145, v184
    s_waitcnt lgkmcnt(12)
    v_mfma_f32_32x32x16_bf16 v[80:95], v[40:43], a[52:55], v[80:95]
    ds_read_b64_tr_b16 v[40:41], v11 offset:4096
    ds_read_b64_tr_b16 v[42:43], v11 offset:5120
    v_add_u32 v8, 0x8000, v8
    ds_read_b128 a[72:75], v8 offset:0
    s_add_u32 m0, s74, 122880
    s_add_u32 s81, s4, 860160
    buffer_load_dwordx4 v2, s[28:31], s81 offen lds
    v_mfma_f32_32x32x16_bf16 v[96:111], v[44:47], a[48:51], v[96:111]
    v_fmac_f32 v185, v144, v144
    v_fmac_f32 v179, v145, v145
    v_sub_f32 v146, v146, v184
    v_sub_f32 v147, v147, v184
    v_fmac_f32 v185, v146, v146
    v_fmac_f32 v179, v147, v147
    v_mfma_f32_16x16x32_bf16 v[30:33], v[180:183], v[44:47], v[30:33]
    v_sub_f32 v128, v128, v184
    v_sub_f32 v129, v129, v184
    v_mfma_f32_32x32x16_bf16 v[112:127], v[44:47], a[52:55], v[112:127]
    ds_read_b64_tr_b16 v[44:45], v12 offset:4096
    ds_read_b64_tr_b16 v[46:47], v12 offset:5120
    ds_read_b128 a[76:79], v8 offset:4096
    s_add_u32 m0, s74, 126976
    s_add_u32 s81, s4, 921600
    buffer_load_dwordx4 v2, s[28:31], s81 offen lds
    s_waitcnt lgkmcnt(15)
    v_mfma_f32_32x32x16_bf16 v[64:79], v[48:51], a[56:59], v[64:79]
    s_cmp_ge_u32 s23, 6
    s_cselect_b32 s4, s0, s70
    s_add_u32 m0, s74, 131072
    s_add_u32 s81, s4, 512
    buffer_load_dwordx4 v1, s[24:27], s81 offen lds
    v_mfma_f32_16x16x32_bf16 v[36:39], v[180:183], v[48:51], v[36:39]
    v_fmac_f32 v185, v128, v128
    v_fmac_f32 v179, v129, v129
    s_waitcnt lgkmcnt(12)
    v_mfma_f32_32x32x16_bf16 v[80:95], v[48:51], a[60:63], v[80:95]
    ds_read_b64_tr_b16 v[48:49], v11 offset:8192
    ds_read_b64_tr_b16 v[50:51], v11 offset:9216
    v_add_u32 v9, 0x8000, v9
    ds_read_b128 a[80:83], v9 offset:0
    s_add_u32 m0, s74, 135168
    s_add_u32 s81, s4, 41472
    buffer_load_dwordx4 v1, s[24:27], s81 offen lds
    v_mfma_f32_32x32x16_bf16 v[96:111], v[52:55], a[56:59], v[96:111]
    v_sub_f32 v130, v130, v184
    v_sub_f32 v131, v131, v184
    v_fmac_f32 v185, v130, v130
    v_fmac_f32 v179, v131, v131
    v_sub_f32 v132, v132, v184
    v_sub_f32 v133, v133, v184
    v_mfma_f32_16x16x32_bf16 v[30:33], v[180:183], v[52:55], v[30:33]
    v_fmac_f32 v185, v132, v132
    v_fmac_f32 v179, v133, v133
    v_mfma_f32_32x32x16_bf16 v[112:127], v[52:55], a[60:63], v[112:127]
    ds_read_b64_tr_b16 v[52:53], v12 offset:8192
    ds_read_b64_tr_b16 v[54:55], v12 offset:9216
    ds_read_b128 a[84:87], v9 offset:4096
    s_add_u32 m0, s74, 139264
    s_add_u32 s81, s4, 82432
    buffer_load_dwordx4 v1, s[24:27], s81 offen lds
    s_waitcnt lgkmcnt(15)
    v_mfma_f32_32x32x16_bf16 v[64:79], v[56:59], a[64:67], v[64:79]
    v_sub_f32 v134, v134, v184
    v_sub_f32 v135, v135, v184
    v_fmac_f32 v185, v134, v134
    v_fmac_f32 v179, v135, v135
    v_sub_f32 v136, v136, v184
    v_sub_f32 v137, v137, v184
    v_mfma_f32_16x16x32_bf16 v[36:39], v[180:183], v[56:59], v[36:39]
    v_fmac_f32 v185, v136, v136
    v_fmac_f32 v179, v137, v137
    s_waitcnt lgkmcnt(12)
    v_mfma_f32_32x32x16_bf16 v[80:95], v[56:59], a[68:71], v[80:95]
    ds_read_b64_tr_b16 v[56:57], v11 offset:12288
    ds_read_b64_tr_b16 v[58:59], v11 offset:13312
    v_add_u32 v10, 0x8000, v10
    ds_read_b128 a[88:91], v10 offset:0
    s_add_u32 m0, s74, 143360
    s_add_u32 s81, s4, 123392
    buffer_load_dwordx4 v1, s[24:27], s81 offen lds
    v_mfma_f32_32x32x16_bf16 v[96:111], v[60:63], a[64:67], v[96:111]
    s_lshl_b32 s15, s2, 2
    s_add_u32 s15, s15, s64
    v_min_u32 v26, 14, v0
    v_lshlrev_b32 v26, 7, v26
    s_mul_i32 s16, s15, 1920
    buffer_load_dword v27, v26, s[48:51], s16 offen
    v_mfma_f32_16x16x32_bf16 v[30:33], v[180:183], v[60:63], v[30:33]
    v_add_f32 v185, v185, v179
    s_nop 1
    v_add_f32_dpp v185, v185, v185 quad_perm:[1,0,3,2] row_mask:0xf bank_mask:0xf
    v_mfma_f32_32x32x16_bf16 v[112:127], v[60:63], a[68:71], v[112:127]
    ds_read_b64_tr_b16 v[60:61], v12 offset:12288
    ds_read_b64_tr_b16 v[62:63], v12 offset:13312
    ds_read_b128 a[92:95], v10 offset:4096
    v_add_f32_dpp v185, v185, v185 quad_perm:[2,3,0,1] row_mask:0xf bank_mask:0xf
    s_nop 1
    v_add_f32_dpp v185, v185, v185 row_half_mirror row_mask:0xf bank_mask:0xf
    s_nop 1
    v_add_f32_dpp v185, v185, v185 row_mirror row_mask:0xf bank_mask:0xf
    s_waitcnt lgkmcnt(15)
    v_mfma_f32_32x32x16_bf16 v[64:79], v[40:43], a[72:75], v[64:79]
    s_waitcnt vmcnt(9)
    s_waitcnt vmcnt(5)
    s_barrier
    v_min_u32 v26, 6, v0
    v_lshlrev_b32 v26, 7, v26
    s_mul_i32 s16, s15, 896
    buffer_load_dword v27, v26, s[44:47], s16 offen
    v_mfma_f32_16x16x32_bf16 v[36:39], v[180:183], v[40:43], v[36:39]
    s_waitcnt lgkmcnt(12)
    v_mfma_f32_32x32x16_bf16 v[80:95], v[40:43], a[76:79], v[80:95]
    v_add_u32 v11, 0x8000, v11
    ds_read_b64_tr_b16 v[40:41], v11 offset:0
    ds_read_b64_tr_b16 v[42:43], v11 offset:1024
    v_add_u32 v7, 0x8000, v7
    ds_read_b128 a[96:99], v7 offset:0
    v_mfma_f32_32x32x16_bf16 v[96:111], v[44:47], a[72:75], v[96:111]
    s_cmp_ge_u32 s23, 6
    s_cselect_b32 s4, s1, s71
    s_add_u32 m0, s74, 0
    s_add_u32 s81, s4, 983040
    buffer_load_dwordx4 v2, s[28:31], s81 offen lds
    v_mfma_f32_16x16x32_bf16 v[30:33], v[180:183], v[44:47], v[30:33]
    v_mfma_f32_32x32x16_bf16 v[112:127], v[44:47], a[76:79], v[112:127]
    v_add_u32 v12, 0x8000, v12
    ds_read_b64_tr_b16 v[44:45], v12 offset:0
    ds_read_b64_tr_b16 v[46:47], v12 offset:1024
    ds_read_b128 a[100:103], v7 offset:4096
    s_add_u32 m0, s74, 4096
    s_add_u32 s81, s4, 1044480
    buffer_load_dwordx4 v2, s[28:31], s81 offen lds
    s_waitcnt lgkmcnt(15)
    v_mfma_f32_32x32x16_bf16 v[64:79], v[48:51], a[80:83], v[64:79]
    s_add_u32 m0, s74, 8192
    s_add_u32 s81, s4, 1105920
    buffer_load_dwordx4 v2, s[28:31], s81 offen lds
    v_mfma_f32_16x16x32_bf16 v[36:39], v[180:183], v[48:51], v[36:39]
    s_waitcnt lgkmcnt(12)
    v_mfma_f32_32x32x16_bf16 v[80:95], v[48:51], a[84:87], v[80:95]
    ds_read_b64_tr_b16 v[48:49], v11 offset:4096
    ds_read_b64_tr_b16 v[50:51], v11 offset:5120
    v_add_u32 v8, 0x8000, v8
    ds_read_b128 a[104:107], v8 offset:0
    s_add_u32 m0, s74, 12288
    s_add_u32 s81, s4, 1167360
    buffer_load_dwordx4 v2, s[28:31], s81 offen lds
    v_mfma_f32_32x32x16_bf16 v[96:111], v[52:55], a[80:83], v[96:111]
    s_cmp_ge_u32 s23, 5
    s_cselect_b32 s4, s0, s70
    s_add_u32 m0, s74, 16384
    s_add_u32 s81, s4, 640
    buffer_load_dwordx4 v1, s[24:27], s81 offen lds
    v_mfma_f32_16x16x32_bf16 v[30:33], v[180:183], v[52:55], v[30:33]
    v_mfma_f32_32x32x16_bf16 v[112:127], v[52:55], a[84:87], v[112:127]
    ds_read_b64_tr_b16 v[52:53], v12 offset:4096
    ds_read_b64_tr_b16 v[54:55], v12 offset:5120
    ds_read_b128 a[108:111], v8 offset:4096
    s_add_u32 m0, s74, 20480
    s_add_u32 s81, s4, 41600
    buffer_load_dwordx4 v1, s[24:27], s81 offen lds
    s_waitcnt lgkmcnt(15)
    v_mfma_f32_32x32x16_bf16 v[64:79], v[56:59], a[88:91], v[64:79]
    v_mov_b32 v178, v185
    s_nop 1
    v_permlane16_swap_b32 v185, v178
    s_nop 1
    v_add_f32 v185, v185, v178
    v_mfma_f32_16x16x32_bf16 v[36:39], v[180:183], v[56:59], v[36:39]
    s_waitcnt lgkmcnt(12)
    v_mfma_f32_32x32x16_bf16 v[80:95], v[56:59], a[92:95], v[80:95]
    ds_read_b64_tr_b16 v[56:57], v11 offset:8192
    ds_read_b64_tr_b16 v[58:59], v11 offset:9216
    v_add_u32 v9, 0x8000, v9
    ds_read_b128 a[112:115], v9 offset:0
    s_add_u32 m0, s74, 24576
    s_add_u32 s81, s4, 82560
    buffer_load_dwordx4 v1, s[24:27], s81 offen lds
    v_mfma_f32_32x32x16_bf16 v[96:111], v[60:63], a[88:91], v[96:111]
    v_mul_f32 v185, 0x3acccccd, v185
    v_cvt_pk_bf16_f32 v185, v185, v185
    v_and_b32 v185, 0xffff0000, v185
    v_add_f32 v185, 0x3727c5ac, v185
    v_cvt_pk_bf16_f32 v185, v185, v185
    v_and_b32 v185, 0xffff0000, v185
    v_mfma_f32_16x16x32_bf16 v[30:33], v[180:183], v[60:63], v[30:33]
    v_mfma_f32_32x32x16_bf16 v[112:127], v[60:63], a[92:95], v[112:127]
    ds_read_b64_tr_b16 v[60:61], v12 offset:8192
    ds_read_b64_tr_b16 v[62:63], v12 offset:9216
    ds_read_b128 a[116:119], v9 offset:4096
    v_sqrt_f32 v185, v185
    s_nop 0
    v_cvt_pk_bf16_f32 v185, v185, v185
    v_and_b32 v185, 0xffff0000, v185
    s_waitcnt lgkmcnt(15)
    v_mfma_f32_32x32x16_bf16 v[64:79], v[40:43], a[96:99], v[64:79]
    s_add_u32 m0, s74, 28672
    s_add_u32 s81, s4, 123520
    buffer_load_dwordx4 v1, s[24:27], s81 offen lds
    v_mfma_f32_16x16x32_bf16 v[36:39], v[180:183], v[40:43], v[36:39]
    s_waitcnt lgkmcnt(12)
    v_mfma_f32_32x32x16_bf16 v[80:95], v[40:43], a[100:103], v[80:95]
    ds_read_b64_tr_b16 v[40:41], v11 offset:12288
    ds_read_b64_tr_b16 v[42:43], v11 offset:13312
    v_add_u32 v10, 0x8000, v10
    ds_read_b128 a[120:123], v10 offset:0
    v_mfma_f32_32x32x16_bf16 v[96:111], v[44:47], a[96:99], v[96:111]
    s_cmp_ge_u32 s23, 5
    s_cselect_b32 s4, s1, s71
    s_add_u32 m0, s74, 32768
    s_add_u32 s81, s4, 1228800
    buffer_load_dwordx4 v2, s[28:31], s81 offen lds
    v_mfma_f32_16x16x32_bf16 v[30:33], v[180:183], v[44:47], v[30:33]
    v_mfma_f32_32x32x16_bf16 v[112:127], v[44:47], a[100:103], v[112:127]
    ds_read_b64_tr_b16 v[44:45], v12 offset:12288
    ds_read_b64_tr_b16 v[46:47], v12 offset:13312
    ds_read_b128 a[124:127], v10 offset:4096
    v_rcp_f32 v185, v185
    v_cvt_pk_bf16_f32 v184, -v184, -v184
    s_waitcnt lgkmcnt(15)
    v_mfma_f32_32x32x16_bf16 v[64:79], v[48:51], a[104:107], v[64:79]
    s_waitcnt vmcnt(11)
    s_waitcnt vmcnt(5)
    s_barrier
    s_add_u32 m0, s74, 36864
    s_add_u32 s81, s4, 1290240
    buffer_load_dwordx4 v2, s[28:31], s81 offen lds
    v_mfma_f32_16x16x32_bf16 v[36:39], v[180:183], v[48:51], v[36:39]
    v_readfirstlane_b32 s101, v189
    v_readfirstlane_b32 s100, v188
    s_nop 0
    s_cmp_lg_u32 s101, 0
    s_cbranch_scc1 L_nok1
    s_mov_b32 s65, 0x80000
L_nl1:
    s_sleep 2
    buffer_load_dwordx2 v[188:189], v190, s[56:59], 0 offen sc1
    s_waitcnt vmcnt(0)
    v_readfirstlane_b32 s101, v189
    v_readfirstlane_b32 s100, v188
    s_nop 0
    s_cmp_lg_u32 s101, 0
    s_cbranch_scc1 L_nok1
    s_sub_u32 s65, s65, 1
    s_cbranch_scc0 L_nl1
L_nok1:
    s_waitcnt lgkmcnt(12)
    v_mfma_f32_32x32x16_bf16 v[80:95], v[48:51], a[108:111], v[80:95]
    v_add_u32 v11, 0xfffe4000, v11
    ds_read_b64_tr_b16 v[48:49], v11 offset:0
    ds_read_b64_tr_b16 v[50:51], v11 offset:1024
    v_add_u32 v7, 0x8000, v7
    ds_read_b128 a[128:131], v7 offset:0
    v_mfma_f32_32x32x16_bf16 v[96:111], v[52:55], a[104:107], v[96:111]
    s_add_u32 m0, s74, 40960
    s_add_u32 s81, s4, 1351680
    buffer_load_dwordx4 v2, s[28:31], s81 offen lds
    v_mfma_f32_16x16x32_bf16 v[30:33], v[180:183], v[52:55], v[30:33]
    v_mfma_f32_32x32x16_bf16 v[112:127], v[52:55], a[108:111], v[112:127]
    v_add_u32 v12, 0xfffe4000, v12
    ds_read_b64_tr_b16 v[52:53], v12 offset:0
    ds_read_b64_tr_b16 v[54:55], v12 offset:1024
    ds_read_b128 a[132:135], v7 offset:4096
    s_add_u32 m0, s74, 45056
    s_add_u32 s81, s4, 1413120
    buffer_load_dwordx4 v2, s[28:31], s81 offen lds
    s_waitcnt lgkmcnt(15)
    v_mfma_f32_32x32x16_bf16 v[64:79], v[56:59], a[112:115], v[64:79]
    s_cmp_ge_u32 s23, 4
    s_cselect_b32 s4, s0, s70
    s_add_u32 m0, s74, 49152
    s_add_u32 s81, s4, 768
    buffer_load_dwordx4 v1, s[24:27], s81 offen lds
    v_mfma_f32_16x16x32_bf16 v[36:39], v[180:183], v[56:59], v[36:39]
    s_waitcnt lgkmcnt(12)
    v_mfma_f32_32x32x16_bf16 v[80:95], v[56:59], a[116:119], v[80:95]
    ds_read_b64_tr_b16 v[56:57], v11 offset:4096
    ds_read_b64_tr_b16 v[58:59], v11 offset:5120
    v_add_u32 v8, 0x8000, v8
    ds_read_b128 a[136:139], v8 offset:0
    s_add_u32 m0, s74, 53248
    s_add_u32 s81, s4, 41728
    buffer_load_dwordx4 v1, s[24:27], s81 offen lds
    v_mfma_f32_32x32x16_bf16 v[96:111], v[60:63], a[112:115], v[96:111]
    s_add_u32 m0, s74, 57344
    s_add_u32 s81, s4, 82688
    buffer_load_dwordx4 v1, s[24:27], s81 offen lds
    v_mfma_f32_16x16x32_bf16 v[30:33], v[180:183], v[60:63], v[30:33]
    v_mfma_f32_32x32x16_bf16 v[112:127], v[60:63], a[116:119], v[112:127]
    ds_read_b64_tr_b16 v[60:61], v12 offset:4096
    ds_read_b64_tr_b16 v[62:63], v12 offset:5120
    ds_read_b128 a[140:143], v8 offset:4096
    v_lshlrev_b32 v151, 4, v148
    v_lshl_add_u32 v151, v149, 25, v151
    s_lshl_b32 s9, s8, 4
    v_mov_b32 v186, s100
    v_mov_b32 v187, s101
    s_waitcnt lgkmcnt(15)
    v_mfma_f32_32x32x16_bf16 v[64:79], v[40:43], a[120:123], v[64:79]
    s_add_u32 m0, s74, 61440
    s_add_u32 s81, s4, 123648
    buffer_load_dwordx4 v1, s[24:27], s81 offen lds
    v_mfma_f32_16x16x32_bf16 v[36:39], v[180:183], v[40:43], v[36:39]
    s_waitcnt lgkmcnt(12)
    v_mfma_f32_32x32x16_bf16 v[80:95], v[40:43], a[124:127], v[80:95]
    ds_read_b64_tr_b16 v[40:41], v11 offset:8192
    ds_read_b64_tr_b16 v[42:43], v11 offset:9216
    v_add_u32 v9, 0x8000, v9
    ds_read_b128 a[144:147], v9 offset:0
    buffer_store_dwordx4 v[184:187], v151, s[40:43], s9 offen sc1
    v_mfma_f32_32x32x16_bf16 v[96:111], v[44:47], a[120:123], v[96:111]
    s_cmp_ge_u32 s23, 4
    s_cselect_b32 s4, s1, s71
    s_add_u32 m0, s74, 65536
    s_add_u32 s81, s4, 1474560
    buffer_load_dwordx4 v2, s[28:31], s81 offen lds
    v_mfma_f32_16x16x32_bf16 v[30:33], v[180:183], v[44:47], v[30:33]
    v_mfma_f32_32x32x16_bf16 v[112:127], v[44:47], a[124:127], v[112:127]
    ds_read_b64_tr_b16 v[44:45], v12 offset:8192
    ds_read_b64_tr_b16 v[46:47], v12 offset:9216
    ds_read_b128 a[148:151], v9 offset:4096
    s_waitcnt lgkmcnt(15)
    v_mfma_f32_32x32x16_bf16 v[64:79], v[48:51], a[128:131], v[64:79]
    s_add_u32 m0, s74, 69632
    s_add_u32 s81, s4, 1536000
    buffer_load_dwordx4 v2, s[28:31], s81 offen lds
    v_lshlrev_b32 v168, 16, v152
    v_mfma_f32_16x16x32_bf16 v[36:39], v[180:183], v[48:51], v[36:39]
    v_and_b32 v169, 0xffff0000, v152
    v_lshlrev_b32 v170, 16, v153
    s_waitcnt lgkmcnt(12)
    v_mfma_f32_32x32x16_bf16 v[80:95], v[48:51], a[132:135], v[80:95]
    ds_read_b64_tr_b16 v[48:49], v11 offset:12288
    ds_read_b64_tr_b16 v[50:51], v11 offset:13312
    v_add_u32 v10, 0x8000, v10
    ds_read_b128 a[152:155], v10 offset:0
    v_and_b32 v171, 0xffff0000, v153
    v_lshlrev_b32 v172, 16, v154
    v_mfma_f32_32x32x16_bf16 v[96:111], v[52:55], a[128:131], v[96:111]
    s_add_u32 m0, s74, 73728
    s_add_u32 s81, s4, 1597440
    buffer_load_dwordx4 v2, s[28:31], s81 offen lds
    v_and_b32 v173, 0xffff0000, v154
    v_lshlrev_b32 v174, 16, v155
    v_mfma_f32_16x16x32_bf16 v[30:33], v[180:183], v[52:55], v[30:33]
    v_and_b32 v175, 0xffff0000, v155
    v_lshlrev_b32 v178, 16, v156
    v_mfma_f32_32x32x16_bf16 v[112:127], v[52:55], a[132:135], v[112:127]
    ds_read_b64_tr_b16 v[52:53], v12 offset:12288
    ds_read_b64_tr_b16 v[54:55], v12 offset:13312
    ds_read_b128 a[156:159], v10 offset:4096
    v_and_b32 v156, 0xffff0000, v156
    v_add_f32 v168, v168, v178
    v_add_f32 v169, v169, v156
    s_waitcnt lgkmcnt(15)
    v_mfma_f32_32x32x16_bf16 v[64:79], v[56:59], a[136:139], v[64:79]
    s_waitcnt vmcnt(12)
    s_waitcnt vmcnt(8)
    s_barrier
    s_add_u32 m0, s74, 77824
    s_add_u32 s81, s4, 1658880
    buffer_load_dwordx4 v2, s[28:31], s81 offen lds
    v_mfma_f32_16x16x32_bf16 v[36:39], v[180:183], v[56:59], v[36:39]
    v_lshlrev_b32 v179, 16, v157
    v_and_b32 v157, 0xffff0000, v157
    s_waitcnt lgkmcnt(12)
    v_mfma_f32_32x32x16_bf16 v[80:95], v[56:59], a[140:143], v[80:95]
    v_add_u32 v11, 0x8000, v11
    ds_read_b64_tr_b16 v[56:57], v11 offset:0
    ds_read_b64_tr_b16 v[58:59], v11 offset:1024
    v_add_u32 v7, 0xfffe4000, v7
    ds_read_b128 a[160:163], v7 offset:0
    v_add_f32 v170, v170, v179
    v_mfma_f32_32x32x16_bf16 v[96:111], v[60:63], a[136:139], v[96:111]
    s_cmp_ge_u32 s23, 3
    s_cselect_b32 s4, s0, s70
    s_add_u32 m0, s74, 81920
    s_add_u32 s81, s4, 896
    buffer_load_dwordx4 v1, s[24:27], s81 offen lds
    v_mfma_f32_16x16x32_bf16 v[30:33], v[180:183], v[60:63], v[30:33]
    v_add_f32 v171, v171, v157
    v_lshlrev_b32 v178, 16, v158
    v_mfma_f32_32x32x16_bf16 v[112:127], v[60:63], a[140:143], v[112:127]
    v_add_u32 v12, 0x8000, v12
    ds_read_b64_tr_b16 v[60:61], v12 offset:0
    ds_read_b64_tr_b16 v[62:63], v12 offset:1024
    ds_read_b128 a[164:167], v7 offset:4096
    s_add_u32 m0, s74, 86016
    s_add_u32 s81, s4, 41856
    buffer_load_dwordx4 v1, s[24:27], s81 offen lds
    s_waitcnt lgkmcnt(15)
    v_mfma_f32_32x32x16_bf16 v[64:79], v[40:43], a[144:147], v[64:79]
    s_add_u32 m0, s74, 90112
    s_add_u32 s81, s4, 82816
    buffer_load_dwordx4 v1, s[24:27], s81 offen lds
    v_and_b32 v158, 0xffff0000, v158
    v_add_f32 v172, v172, v178
    v_mfma_f32_16x16x32_bf16 v[36:39], v[180:183], v[40:43], v[36:39]
    v_add_f32 v173, v173, v158
    v_lshlrev_b32 v179, 16, v159
    s_waitcnt lgkmcnt(12)
    v_mfma_f32_32x32x16_bf16 v[80:95], v[40:43], a[148:151], v[80:95]
    ds_read_b64_tr_b16 v[40:41], v11 offset:4096
    ds_read_b64_tr_b16 v[42:43], v11 offset:5120
    v_add_u32 v8, 0xfffe4000, v8
    ds_read_b128 a[168:171], v8 offset:0
    v_and_b32 v159, 0xffff0000, v159
    v_add_f32 v174, v174, v179
    v_mfma_f32_32x32x16_bf16 v[96:111], v[44:47], a[144:147], v[96:111]
    s_add_u32 m0, s74, 94208
    s_add_u32 s81, s4, 123776
    buffer_load_dwordx4 v1, s[24:27], s81 offen lds
    v_add_f32 v175, v175, v159
    v_lshlrev_b32 v178, 16, v160
    v_mfma_f32_16x16x32_bf16 v[30:33], v[180:183], v[44:47], v[30:33]
    v_and_b32 v160, 0xffff0000, v160
    v_add_f32 v168, v168, v178
    v_mfma_f32_32x32x16_bf16 v[112:127], v[44:47], a[148:151], v[112:127]
    ds_read_b64_tr_b16 v[44:45], v12 offset:4096
    ds_read_b64_tr_b16 v[46:47], v12 offset:5120
    ds_read_b128 a[172:175], v8 offset:4096
    v_add_f32 v169, v169, v160
    v_lshlrev_b32 v179, 16, v161
    v_and_b32 v161, 0xffff0000, v161
    s_waitcnt lgkmcnt(15)
    v_mfma_f32_32x32x16_bf16 v[64:79], v[48:51], a[152:155], v[64:79]
    s_cmp_ge_u32 s23, 3
    s_cselect_b32 s4, s1, s71
    s_add_u32 m0, s74, 98304
    s_add_u32 s81, s4, 1720320
    buffer_load_dwordx4 v2, s[28:31], s81 offen lds
    v_mfma_f32_16x16x32_bf16 v[36:39], v[180:183], v[48:51], v[36:39]
    v_add_f32 v170, v170, v179
    v_add_f32 v171, v171, v161
    s_waitcnt lgkmcnt(12)
    v_mfma_f32_32x32x16_bf16 v[80:95], v[48:51], a[156:159], v[80:95]
    ds_read_b64_tr_b16 v[48:49], v11 offset:8192
    ds_read_b64_tr_b16 v[50:51], v11 offset:9216
    v_add_u32 v9, 0xfffe4000, v9
    ds_read_b128 a[176:179], v9 offset:0
    v_lshlrev_b32 v178, 16, v162
    v_and_b32 v162, 0xffff0000, v162
    v_mfma_f32_32x32x16_bf16 v[96:111], v[52:55], a[152:155], v[96:111]
    s_add_u32 m0, s74, 102400
    s_add_u32 s81, s4, 1781760
    buffer_load_dwordx4 v2, s[28:31], s81 offen lds
    v_add_f32 v172, v172, v178
    v_add_f32 v173, v173, v162
    v_mfma_f32_16x16x32_bf16 v[30:33], v[180:183], v[52:55], v[30:33]
    v_lshlrev_b32 v179, 16, v163
    v_and_b32 v163, 0xffff0000, v163
    v_mfma_f32_32x32x16_bf16 v[112:127], v[52:55], a[156:159], v[112:127]
    ds_read_b64_tr_b16 v[52:53], v12 offset:8192
    ds_read_b64_tr_b16 v[54:55], v12 offset:9216
    ds_read_b128 a[180:183], v9 offset:4096
    v_add_f32 v174, v174, v179
    v_add_f32 v175, v175, v163
    v_lshlrev_b32 v178, 16, v164
    s_waitcnt lgkmcnt(15)
    v_mfma_f32_32x32x16_bf16 v[64:79], v[56:59], a[160:163], v[64:79]
    s_add_u32 m0, s74, 106496
    s_add_u32 s81, s4, 1843200
    buffer_load_dwordx4 v2, s[28:31], s81 offen lds
    v_and_b32 v164, 0xffff0000, v164
    v_add_f32 v168, v168, v178
    v_mfma_f32_16x16x32_bf16 v[36:39], v[180:183], v[56:59], v[36:39]
    v_add_f32 v169, v169, v164
    v_lshlrev_b32 v179, 16, v165
    s_waitcnt lgkmcnt(12)
    v_mfma_f32_32x32x16_bf16 v[80:95], v[56:59], a[164:167], v[80:95]
    ds_read_b64_tr_b16 v[56:57], v11 offset:12288
    ds_read_b64_tr_b16 v[58:59], v11 offset:13312
    v_add_u32 v10, 0xfffe4000, v10
    ds_read_b128 a[184:187], v10 offset:0
    v_and_b32 v165, 0xffff0000, v165
    v_add_f32 v170, v170, v179
    v_mfma_f32_32x32x16_bf16 v[96:111], v[60:63], a[160:163], v[96:111]
    s_add_u32 m0, s74, 110592
    s_add_u32 s81, s4, 1904640
    buffer_load_dwordx4 v2, s[28:31], s81 offen lds
    v_add_f32 v171, v171, v165
    v_lshlrev_b32 v178, 16, v166
    v_mfma_f32_16x16x32_bf16 v[30:33], v[180:183], v[60:63], v[30:33]
    v_and_b32 v166, 0xffff0000, v166
    v_add_f32 v172, v172, v178
    v_mfma_f32_32x32x16_bf16 v[112:127], v[60:63], a[164:167], v[112:127]
    ds_read_b64_tr_b16 v[60:61], v12 offset:12288
    ds_read_b64_tr_b16 v[62:63], v12 offset:13312
    ds_read_b128 a[188:191], v10 offset:4096
    v_add_f32 v173, v173, v166
    v_lshlrev_b32 v179, 16, v167
    v_and_b32 v167, 0xffff0000, v167
    s_waitcnt lgkmcnt(15)
    v_mfma_f32_32x32x16_bf16 v[64:79], v[40:43], a[168:171], v[64:79]
    s_waitcnt vmcnt(13)
    s_waitcnt vmcnt(8)
    s_barrier
    s_cmp_ge_u32 s23, 2
    s_cselect_b32 s4, s0, s70
    s_add_u32 m0, s74, 114688
    s_add_u32 s81, s4, 1024
    buffer_load_dwordx4 v1, s[24:27], s81 offen lds
    v_mfma_f32_16x16x32_bf16 v[36:39], v[180:183], v[40:43], v[36:39]
    v_add_f32 v174, v174, v179
    v_add_f32 v175, v175, v167
    s_waitcnt lgkmcnt(12)
    v_mfma_f32_32x32x16_bf16 v[80:95], v[40:43], a[172:175], v[80:95]
    v_add_u32 v11, 0x8000, v11
    ds_read_b64_tr_b16 v[40:41], v11 offset:0
    ds_read_b64_tr_b16 v[42:43], v11 offset:1024
    v_add_u32 v7, 0x8000, v7
    ds_read_b128 a[192:195], v7 offset:0
    v_add_f32_dpp v168, v168, v168 row_ror:8 row_mask:0xf bank_mask:0xf
    v_mfma_f32_32x32x16_bf16 v[96:111], v[44:47], a[168:171], v[96:111]
    s_add_u32 m0, s74, 118784
    s_add_u32 s81, s4, 41984
    buffer_load_dwordx4 v1, s[24:27], s81 offen lds
    v_add_f32_dpp v169, v169, v169 row_ror:8 row_mask:0xf bank_mask:0xf
    v_add_f32_dpp v170, v170, v170 row_ror:8 row_mask:0xf bank_mask:0xf
    v_mfma_f32_16x16x32_bf16 v[30:33], v[180:183], v[44:47], v[30:33]
    v_add_f32_dpp v171, v171, v171 row_ror:8 row_mask:0xf bank_mask:0xf
    v_add_f32_dpp v172, v172, v172 row_ror:8 row_mask:0xf bank_mask:0xf
    v_mfma_f32_32x32x16_bf16 v[112:127], v[44:47], a[172:175], v[112:127]
    v_add_u32 v12, 0x8000, v12
    ds_read_b64_tr_b16 v[44:45], v12 offset:0
    ds_read_b64_tr_b16 v[46:47], v12 offset:1024
    ds_read_b128 a[196:199], v7 offset:4096
    s_add_u32 m0, s74, 122880
    s_add_u32 s81, s4, 82944
    buffer_load_dwordx4 v1, s[24:27], s81 offen lds
    s_waitcnt lgkmcnt(15)
    v_mfma_f32_32x32x16_bf16 v[64:79], v[48:51], a[176:179], v[64:79]
    s_add_u32 m0, s74, 126976
    s_add_u32 s81, s4, 123904
    buffer_load_dwordx4 v1, s[24:27], s81 offen lds
    v_add_f32_dpp v173, v173, v173 row_ror:8 row_mask:0xf bank_mask:0xf
    v_add_f32_dpp v174, v174, v174 row_ror:8 row_mask:0xf bank_mask:0xf
    v_mfma_f32_16x16x32_bf16 v[36:39], v[180:183], v[48:51], v[36:39]
    v_add_f32_dpp v175, v175, v175 row_ror:8 row_mask:0xf bank_mask:0xf
    s_lshl_b32 s15, s64, 10
    s_waitcnt lgkmcnt(12)
    v_mfma_f32_32x32x16_bf16 v[80:95], v[48:51], a[180:183], v[80:95]
    ds_read_b64_tr_b16 v[48:49], v11 offset:4096
    ds_read_b64_tr_b16 v[50:51], v11 offset:5120
    v_add_u32 v8, 0x8000, v8
    ds_read_b128 a[200:203], v8 offset:0
    s_add_u32 s15, s15, 147456
    v_lshrrev_b32 v176, 4, v0
    v_mfma_f32_32x32x16_bf16 v[96:111], v[52:55], a[176:179], v[96:111]
    s_cmp_ge_u32 s23, 2
    s_cselect_b32 s4, s1, s71
    s_add_u32 m0, s74, 131072
    s_add_u32 s81, s4, 1966080
    buffer_load_dwordx4 v2, s[28:31], s81 offen lds
    v_mfma_f32_16x16x32_bf16 v[30:33], v[180:183], v[52:55], v[30:33]
    v_and_b32 v177, 7, v0
    v_lshlrev_b32 v176, 8, v176
    v_mfma_f32_32x32x16_bf16 v[112:127], v[52:55], a[180:183], v[112:127]
    ds_read_b64_tr_b16 v[52:53], v12 offset:4096
    ds_read_b64_tr_b16 v[54:55], v12 offset:5120
    ds_read_b128 a[204:207], v8 offset:4096
    v_lshl_add_u32 v176, v177, 5, v176
    v_add_u32 v176, s15, v176
    ds_write_b128 v176, v[168:171]
    s_waitcnt lgkmcnt(15)
    v_mfma_f32_32x32x16_bf16 v[64:79], v[56:59], a[184:187], v[64:79]
    s_add_u32 m0, s74, 135168
    s_add_u32 s81, s4, 2027520
    buffer_load_dwordx4 v2, s[28:31], s81 offen lds
    ds_write_b128 v176, v[172:175] offset:16
    v_mfma_f32_16x16x32_bf16 v[36:39], v[180:183], v[56:59], v[36:39]
    s_waitcnt lgkmcnt(14)
    v_mfma_f32_32x32x16_bf16 v[80:95], v[56:59], a[188:191], v[80:95]
    ds_read_b64_tr_b16 v[56:57], v11 offset:8192
    ds_read_b64_tr_b16 v[58:59], v11 offset:9216
    v_add_u32 v9, 0x8000, v9
    ds_read_b128 a[208:211], v9 offset:0
    v_mfma_f32_32x32x16_bf16 v[96:111], v[60:63], a[184:187], v[96:111]
    s_add_u32 m0, s74, 139264
    s_add_u32 s81, s4, 2088960
    buffer_load_dwordx4 v2, s[28:31], s81 offen lds
    v_mfma_f32_16x16x32_bf16 v[30:33], v[180:183], v[60:63], v[30:33]
    v_mfma_f32_32x32x16_bf16 v[112:127], v[60:63], a[188:191], v[112:127]
    ds_read_b64_tr_b16 v[60:61], v12 offset:8192
    ds_read_b64_tr_b16 v[62:63], v12 offset:9216
    ds_read_b128 a[212:215], v9 offset:4096
    s_waitcnt lgkmcnt(15)
    v_mfma_f32_32x32x16_bf16 v[64:79], v[40:43], a[192:195], v[64:79]
    s_add_u32 m0, s74, 143360
    s_add_u32 s81, s4, 2150400
    buffer_load_dwordx4 v2, s[28:31], s81 offen lds
    v_mfma_f32_16x16x32_bf16 v[36:39], v[180:183], v[40:43], v[36:39]
    s_waitcnt lgkmcnt(14)
    v_mfma_f32_32x32x16_bf16 v[80:95], v[40:43], a[196:199], v[80:95]
    ds_read_b64_tr_b16 v[40:41], v11 offset:12288
    ds_read_b64_tr_b16 v[42:43], v11 offset:13312
    v_add_u32 v10, 0x8000, v10
    ds_read_b128 a[216:219], v10 offset:0
    v_mfma_f32_32x32x16_bf16 v[96:111], v[44:47], a[192:195], v[96:111]
    s_cmp_ge_u32 s23, 1
    s_cselect_b32 s4, s0, s70
    s_add_u32 m0, s74, 0
    s_add_u32 s81, s4, 1152
    buffer_load_dwordx4 v1, s[24:27], s81 offen lds
    v_mfma_f32_16x16x32_bf16 v[30:33], v[180:183], v[44:47], v[30:33]
    v_mfma_f32_32x32x16_bf16 v[112:127], v[44:47], a[196:199], v[112:127]
    ds_read_b64_tr_b16 v[44:45], v12 offset:12288
    ds_read_b64_tr_b16 v[46:47], v12 offset:13312
    ds_read_b128 a[220:223], v10 offset:4096
    s_waitcnt lgkmcnt(15)
    v_mfma_f32_32x32x16_bf16 v[64:79], v[48:51], a[200:203], v[64:79]
    s_waitcnt vmcnt(13)
    s_waitcnt vmcnt(9)
    s_waitcnt lgkmcnt(12)
    s_barrier
    s_add_u32 m0, s74, 4096
    s_add_u32 s81, s4, 42112
    buffer_load_dwordx4 v1, s[24:27], s81 offen lds
    v_mfma_f32_16x16x32_bf16 v[36:39], v[180:183], v[48:51], v[36:39]
    v_lshlrev_b32 v176, 2, v0
    v_add_u32 v177, 147456, v176
    v_mfma_f32_32x32x16_bf16 v[80:95], v[48:51], a[204:207], v[80:95]
    v_add_u32 v11, 0x8000, v11
    ds_read_b64_tr_b16 v[48:49], v11 offset:0
    ds_read_b64_tr_b16 v[50:51], v11 offset:1024
    v_add_u32 v7, 0x8000, v7
    ds_read_b128 a[224:227], v7 offset:0
    ds_read_b32 v128, v177 offset:0
    v_mfma_f32_32x32x16_bf16 v[96:111], v[52:55], a[200:203], v[96:111]
    s_add_u32 m0, s74, 8192
    s_add_u32 s81, s4, 83072
    buffer_load_dwordx4 v1, s[24:27], s81 offen lds
    ds_read_b32 v129, v177 offset:256
    ds_read_b32 v130, v177 offset:512
    v_mfma_f32_16x16x32_bf16 v[30:33], v[180:183], v[52:55], v[30:33]
    ds_read_b32 v131, v177 offset:768
    ds_read_b32 v132, v177 offset:1024
    v_mfma_f32_32x32x16_bf16 v[112:127], v[52:55], a[204:207], v[112:127]
    v_add_u32 v12, 0x8000, v12
    ds_read_b64_tr_b16 v[52:53], v12 offset:0
    ds_read_b64_tr_b16 v[54:55], v12 offset:1024
    ds_read_b128 a[228:231], v7 offset:4096
    ds_read_b32 v133, v177 offset:1280
    ds_read_b32 v134, v177 offset:1536
    s_waitcnt lgkmcnt(15)
    v_mfma_f32_32x32x16_bf16 v[64:79], v[56:59], a[208:211], v[64:79]
    s_add_u32 m0, s74, 12288
    s_add_u32 s81, s4, 124032
    buffer_load_dwordx4 v1, s[24:27], s81 offen lds
    ds_read_b32 v135, v177 offset:1792
    ds_read_b32 v136, v177 offset:2048
    v_mfma_f32_16x16x32_bf16 v[36:39], v[180:183], v[56:59], v[36:39]
    ds_read_b32 v137, v177 offset:2304
    ds_read_b32 v138, v177 offset:2560
    v_mfma_f32_32x32x16_bf16 v[80:95], v[56:59], a[212:215], v[80:95]
    ds_read_b64_tr_b16 v[56:57], v11 offset:4096
    ds_read_b64_tr_b16 v[58:59], v11 offset:5120
    v_add_u32 v8, 0x8000, v8
    ds_read_b128 a[232:235], v8 offset:0
    ds_read_b32 v139, v177 offset:2816
    ds_read_b32 v140, v177 offset:3072
    v_mfma_f32_32x32x16_bf16 v[96:111], v[60:63], a[208:211], v[96:111]
    s_cmp_ge_u32 s23, 1
    s_cselect_b32 s4, s1, s71
    s_add_u32 m0, s74, 16384
    s_add_u32 s81, s4, 2211840
    buffer_load_dwordx4 v2, s[28:31], s81 offen lds
    v_mfma_f32_16x16x32_bf16 v[30:33], v[180:183], v[60:63], v[30:33]
    ds_read_b32 v141, v177 offset:3328
    ds_read_b32 v142, v177 offset:3584
    v_mfma_f32_32x32x16_bf16 v[112:127], v[60:63], a[212:215], v[112:127]
    ds_read_b64_tr_b16 v[60:61], v12 offset:4096
    ds_read_b64_tr_b16 v[62:63], v12 offset:5120
    ds_read_b128 a[236:239], v8 offset:4096
    ds_read_b32 v143, v177 offset:3840
    s_mul_i32 s14, s10, 24576
    s_lshl_b32 s15, s11, 9
    v_mfma_f32_32x32x16_bf16 v[64:79], v[40:43], a[216:219], v[64:79]
    s_add_u32 m0, s74, 20480
    s_add_u32 s81, s4, 2273280
    buffer_load_dwordx4 v2, s[28:31], s81 offen lds
    s_add_u32 s14, s14, s15
    s_add_u32 s14, s14, 131072
    v_mfma_f32_16x16x32_bf16 v[36:39], v[180:183], v[40:43], v[36:39]
    s_lshl_b32 s15, s64, 25
    s_add_u32 s14, s14, s15
    s_waitcnt lgkmcnt(15)
    v_mfma_f32_32x32x16_bf16 v[80:95], v[40:43], a[220:223], v[80:95]
    ds_read_b64_tr_b16 v[40:41], v11 offset:8192
    ds_read_b64_tr_b16 v[42:43], v11 offset:9216
    v_add_u32 v9, 0x8000, v9
    ds_read_b128 a[240:243], v9 offset:0
    v_lshlrev_b32 v176, 1, v176
    s_waitcnt lgkmcnt(15)
    v_add_f32 v128, v128, v136
    v_mfma_f32_32x32x16_bf16 v[96:111], v[44:47], a[216:219], v[96:111]
    s_add_u32 m0, s74, 24576
    s_add_u32 s81, s4, 2334720
    buffer_load_dwordx4 v2, s[28:31], s81 offen lds
    v_add_f32 v129, v129, v137
    v_mfma_f32_16x16x32_bf16 v[30:33], v[180:183], v[44:47], v[30:33]
    s_waitcnt lgkmcnt(14)
    v_add_f32 v130, v130, v138
    s_waitcnt lgkmcnt(10)
    v_add_f32 v131, v131, v139
    v_mfma_f32_32x32x16_bf16 v[112:127], v[44:47], a[220:223], v[112:127]
    ds_read_b64_tr_b16 v[44:45], v12 offset:8192
    ds_read_b64_tr_b16 v[46:47], v12 offset:9216
    ds_read_b128 a[244:247], v9 offset:4096
    s_waitcnt lgkmcnt(12)
    v_add_f32 v132, v132, v140
    s_waitcnt lgkmcnt(11)
    v_add_f32 v133, v133, v141
    v_mfma_f32_32x32x16_bf16 v[64:79], v[48:51], a[224:227], v[64:79]
    s_add_u32 m0, s74, 28672
    s_add_u32 s81, s4, 2396160
    buffer_load_dwordx4 v2, s[28:31], s81 offen lds
    s_waitcnt lgkmcnt(10)
    v_add_f32 v134, v134, v142
    v_mfma_f32_16x16x32_bf16 v[36:39], v[180:183], v[48:51], v[36:39]
    s_waitcnt lgkmcnt(6)
    v_add_f32 v135, v135, v143
    v_add_f32 v128, v128, v132
    v_mfma_f32_32x32x16_bf16 v[80:95], v[48:51], a[228:231], v[80:95]
    ds_read_b64_tr_b16 v[48:49], v11 offset:12288
    ds_read_b64_tr_b16 v[50:51], v11 offset:13312
    v_add_u32 v10, 0x8000, v10
    ds_read_b128 a[248:251], v10 offset:0
    v_add_f32 v129, v129, v133
    v_add_f32 v130, v130, v134
    v_mfma_f32_32x32x16_bf16 v[96:111], v[52:55], a[224:227], v[96:111]
    s_mov_b32 s4, s72
    s_add_u32 m0, s74, 32768
    s_add_u32 s81, s4, 0
    buffer_load_dwordx4 v3, s[32:35], s81 offen lds
    v_add_f32 v131, v131, v135
    v_mfma_f32_16x16x32_bf16 v[30:33], v[180:183], v[52:55], v[30:33]
    v_add_f32 v128, v128, v130
    v_add_f32 v129, v129, v131
    v_mfma_f32_32x32x16_bf16 v[112:127], v[52:55], a[228:231], v[112:127]
    ds_read_b64_tr_b16 v[52:53], v12 offset:12288
    ds_read_b64_tr_b16 v[54:55], v12 offset:13312
    ds_read_b128 a[252:255], v10 offset:4096
    v_add_f32 v128, v128, v129
    v_mov_b32 v129, s100
    v_mfma_f32_32x32x16_bf16 v[64:79], v[56:59], a[232:235], v[64:79]
    s_waitcnt vmcnt(13)
    s_waitcnt vmcnt(9)
    s_barrier
    s_add_u32 m0, s74, 36864
    s_add_u32 s81, s4, 98304
    buffer_load_dwordx4 v3, s[32:35], s81 offen lds
    v_mfma_f32_16x16x32_bf16 v[36:39], v[180:183], v[56:59], v[36:39]
    buffer_store_dwordx2 v[128:129], v176, s[40:43], s14 offen sc1
    v_mfma_f32_32x32x16_bf16 v[80:95], v[56:59], a[236:239], v[80:95]
    v_add_u32 v11, 0x8000, v11
    ds_read_b64_tr_b16 v[56:57], v11 offset:0
    ds_read_b64_tr_b16 v[58:59], v11 offset:1024
    v_add_u32 v7, 0x8000, v7
    ds_read_b128 v[192:195], v7 offset:0
    v_mfma_f32_32x32x16_bf16 v[96:111], v[60:63], a[232:235], v[96:111]
    s_add_u32 m0, s74, 40960
    s_add_u32 s81, s4, 0
    buffer_load_dwordx4 v4, s[36:39], s81 offen lds
    v_mfma_f32_16x16x32_bf16 v[30:33], v[180:183], v[60:63], v[30:33]
    v_mfma_f32_32x32x16_bf16 v[112:127], v[60:63], a[236:239], v[112:127]
    v_add_u32 v12, 0x8000, v12
    ds_read_b64_tr_b16 v[60:61], v12 offset:0
    ds_read_b64_tr_b16 v[62:63], v12 offset:1024
    ds_read_b128 v[196:199], v7 offset:4096
    s_waitcnt lgkmcnt(15)
    v_mfma_f32_32x32x16_bf16 v[64:79], v[40:43], a[240:243], v[64:79]
    s_add_u32 m0, s74, 45056
    s_add_u32 s81, s4, 98304
    buffer_load_dwordx4 v4, s[36:39], s81 offen lds
    v_and_b32 v161, 31, v0
    v_lshlrev_b32 v161, 4, v161
    v_mfma_f32_16x16x32_bf16 v[36:39], v[180:183], v[40:43], v[36:39]
    s_lshl_b32 s76, s80, 4
    buffer_load_dwordx4 v[152:155], v161, s[40:43], s76 offen offset:0
    s_waitcnt lgkmcnt(12)
    v_mfma_f32_32x32x16_bf16 v[80:95], v[40:43], a[244:247], v[80:95]
    ds_read_b64_tr_b16 v[40:41], v11 offset:4096
    ds_read_b64_tr_b16 v[42:43], v11 offset:5120
    v_add_u32 v8, 0x8000, v8
    ds_read_b128 v[200:203], v8 offset:0
    buffer_load_dwordx4 v[156:159], v161, s[40:43], s76 offen offset:512
    v_mfma_f32_32x32x16_bf16 v[96:111], v[44:47], a[240:243], v[96:111]
    v_mfma_f32_16x16x32_bf16 v[30:33], v[180:183], v[44:47], v[30:33]
    v_mfma_f32_32x32x16_bf16 v[112:127], v[44:47], a[244:247], v[112:127]
    ds_read_b64_tr_b16 v[44:45], v12 offset:4096
    ds_read_b64_tr_b16 v[46:47], v12 offset:5120
    ds_read_b128 v[204:207], v8 offset:4096
    s_waitcnt lgkmcnt(15)
    v_mfma_f32_32x32x16_bf16 v[64:79], v[48:51], a[248:251], v[64:79]
    s_cmp_ge_u32 s23, 9
    s_cselect_b32 s4, s21, s72
    s_add_u32 m0, s74, 49152
    s_add_u32 s81, s4, 196608
    buffer_load_dwordx4 v3, s[32:35], s81 offen lds
    v_mfma_f32_16x16x32_bf16 v[36:39], v[180:183], v[48:51], v[36:39]
    s_waitcnt lgkmcnt(12)
    v_mfma_f32_32x32x16_bf16 v[80:95], v[48:51], a[252:255], v[80:95]
    ds_read_b64_tr_b16 v[48:49], v11 offset:8192
    ds_read_b64_tr_b16 v[50:51], v11 offset:9216
    v_add_u32 v9, 0x8000, v9
    ds_read_b128 v[208:211], v9 offset:0
    v_mfma_f32_32x32x16_bf16 v[96:111], v[52:55], a[248:251], v[96:111]
    s_add_u32 m0, s74, 53248
    s_add_u32 s81, s4, 294912
    buffer_load_dwordx4 v3, s[32:35], s81 offen lds
    v_mfma_f32_16x16x32_bf16 v[30:33], v[180:183], v[52:55], v[30:33]
    v_mfma_f32_32x32x16_bf16 v[112:127], v[52:55], a[252:255], v[112:127]
    ds_read_b64_tr_b16 v[52:53], v12 offset:8192
    ds_read_b64_tr_b16 v[54:55], v12 offset:9216
    ds_read_b128 v[212:215], v9 offset:4096
    s_waitcnt lgkmcnt(15)
    v_mfma_f32_32x32x16_bf16 v[64:79], v[56:59], v[192:195], v[64:79]
    s_add_u32 m0, s74, 57344
    s_add_u32 s81, s4, 196608
    buffer_load_dwordx4 v4, s[36:39], s81 offen lds
    v_mfma_f32_16x16x32_bf16 v[36:39], v[180:183], v[56:59], v[36:39]
    s_waitcnt lgkmcnt(12)
    v_mfma_f32_32x32x16_bf16 v[80:95], v[56:59], v[196:199], v[80:95]
    ds_read_b64_tr_b16 v[56:57], v11 offset:12288
    ds_read_b64_tr_b16 v[58:59], v11 offset:13312
    v_add_u32 v10, 0x8000, v10
    ds_read_b128 v[216:219], v10 offset:0
    v_mfma_f32_32x32x16_bf16 v[96:111], v[60:63], v[192:195], v[96:111]
    s_add_u32 m0, s74, 61440
    s_add_u32 s81, s4, 294912
    buffer_load_dwordx4 v4, s[36:39], s81 offen lds
    v_mfma_f32_16x16x32_bf16 v[30:33], v[180:183], v[60:63], v[30:33]
    v_mfma_f32_32x32x16_bf16 v[112:127], v[60:63], v[196:199], v[112:127]
    ds_read_b64_tr_b16 v[60:61], v12 offset:12288
    ds_read_b64_tr_b16 v[62:63], v12 offset:13312
    ds_read_b128 v[220:223], v10 offset:4096
    s_waitcnt lgkmcnt(15)
    v_mfma_f32_32x32x16_bf16 v[64:79], v[40:43], v[200:203], v[64:79]
    s_waitcnt vmcnt(15)
    s_waitcnt vmcnt(11)
    s_barrier
    s_cmp_ge_u32 s23, 8
    s_cselect_b32 s4, s21, s72
    s_add_u32 m0, s74, 65536
    s_add_u32 s81, s4, 393216
    buffer_load_dwordx4 v3, s[32:35], s81 offen lds
    v_mfma_f32_16x16x32_bf16 v[36:39], v[180:183], v[40:43], v[36:39]
    s_waitcnt lgkmcnt(12)
    v_mfma_f32_32x32x16_bf16 v[80:95], v[40:43], v[204:207], v[80:95]
    v_add_u32 v11, 0xfffe4000, v11
    ds_read_b64_tr_b16 v[40:41], v11 offset:0
    ds_read_b64_tr_b16 v[42:43], v11 offset:1024
    v_add_u32 v7, 0xfffe4000, v7
    ds_read_b128 v[224:227], v7 offset:0
    v_mfma_f32_32x32x16_bf16 v[96:111], v[44:47], v[200:203], v[96:111]
    s_add_u32 m0, s74, 69632
    s_add_u32 s81, s4, 491520
    buffer_load_dwordx4 v3, s[32:35], s81 offen lds
    v_mfma_f32_16x16x32_bf16 v[30:33], v[180:183], v[44:47], v[30:33]
    v_mfma_f32_32x32x16_bf16 v[112:127], v[44:47], v[204:207], v[112:127]
    v_add_u32 v12, 0xfffe4000, v12
    ds_read_b64_tr_b16 v[44:45], v12 offset:0
    ds_read_b64_tr_b16 v[46:47], v12 offset:1024
    ds_read_b128 v[228:231], v7 offset:4096
    s_add_u32 m0, s74, 73728
    s_add_u32 s81, s4, 393216
    buffer_load_dwordx4 v4, s[36:39], s81 offen lds
    s_waitcnt lgkmcnt(15)
    v_mfma_f32_32x32x16_bf16 v[64:79], v[48:51], v[208:211], v[64:79]
    s_add_u32 m0, s74, 77824
    s_add_u32 s81, s4, 491520
    buffer_load_dwordx4 v4, s[36:39], s81 offen lds
    v_mfma_f32_16x16x32_bf16 v[36:39], v[180:183], v[48:51], v[36:39]
    s_waitcnt lgkmcnt(12)
    v_mfma_f32_32x32x16_bf16 v[80:95], v[48:51], v[212:215], v[80:95]
    ds_read_b64_tr_b16 v[48:49], v11 offset:4096
    ds_read_b64_tr_b16 v[50:51], v11 offset:5120
    v_add_u32 v8, 0xfffe4000, v8
    ds_read_b128 v[232:235], v8 offset:0
    v_mfma_f32_32x32x16_bf16 v[96:111], v[52:55], v[208:211], v[96:111]
    s_cmp_ge_u32 s23, 7
    s_cselect_b32 s4, s21, s72
    s_add_u32 m0, s74, 81920
    s_add_u32 s81, s4, 589824
    buffer_load_dwordx4 v3, s[32:35], s81 offen lds
    v_mfma_f32_16x16x32_bf16 v[30:33], v[180:183], v[52:55], v[30:33]
    v_mfma_f32_32x32x16_bf16 v[112:127], v[52:55], v[212:215], v[112:127]
    ds_read_b64_tr_b16 v[52:53], v12 offset:4096
    ds_read_b64_tr_b16 v[54:55], v12 offset:5120
    ds_read_b128 v[236:239], v8 offset:4096
    s_waitcnt lgkmcnt(15)
    v_mfma_f32_32x32x16_bf16 v[64:79], v[56:59], v[216:219], v[64:79]
    s_add_u32 m0, s74, 86016
    s_add_u32 s81, s4, 688128
    buffer_load_dwordx4 v3, s[32:35], s81 offen lds
    v_mfma_f32_16x16x32_bf16 v[36:39], v[180:183], v[56:59], v[36:39]
    s_waitcnt lgkmcnt(12)
    v_mfma_f32_32x32x16_bf16 v[80:95], v[56:59], v[220:223], v[80:95]
    ds_read_b64_tr_b16 v[56:57], v11 offset:8192
    ds_read_b64_tr_b16 v[58:59], v11 offset:9216
    v_add_u32 v9, 0xfffe4000, v9
    ds_read_b128 v[240:243], v9 offset:0
    v_mfma_f32_32x32x16_bf16 v[96:111], v[60:63], v[216:219], v[96:111]
    s_add_u32 m0, s74, 90112
    s_add_u32 s81, s4, 589824
    buffer_load_dwordx4 v4, s[36:39], s81 offen lds
    v_mfma_f32_16x16x32_bf16 v[30:33], v[180:183], v[60:63], v[30:33]
    v_mfma_f32_32x32x16_bf16 v[112:127], v[60:63], v[220:223], v[112:127]
    ds_read_b64_tr_b16 v[60:61], v12 offset:8192
    ds_read_b64_tr_b16 v[62:63], v12 offset:9216
    ds_read_b128 v[244:247], v9 offset:4096
    s_waitcnt lgkmcnt(15)
    v_mfma_f32_32x32x16_bf16 v[64:79], v[40:43], v[224:227], v[64:79]
    s_add_u32 m0, s74, 94208
    s_add_u32 s81, s4, 688128
    buffer_load_dwordx4 v4, s[36:39], s81 offen lds
    s_waitcnt vmcnt(12)
    v_xor_b32 v160, s100, v154
    v_mfma_f32_16x16x32_bf16 v[36:39], v[180:183], v[40:43], v[36:39]
    v_bitop3_b32 v160, v160, v158, s100 bitop3:0xf6
    v_bitop3_b32 v160, v160, v155, s101 bitop3:0xf6
    s_waitcnt lgkmcnt(12)
    v_mfma_f32_32x32x16_bf16 v[80:95], v[40:43], v[228:231], v[80:95]
    ds_read_b64_tr_b16 v[40:41], v11 offset:12288
    ds_read_b64_tr_b16 v[42:43], v11 offset:13312
    v_add_u32 v10, 0xfffe4000, v10
    ds_read_b128 v[248:251], v10 offset:0
    v_bitop3_b32 v160, v160, v159, s101 bitop3:0xf6
    v_cmp_ne_u32 vcc, 0, v160
    s_nop 0
    s_and_b64 vcc, vcc, exec
    s_cbranch_scc0 L_sok2
    s_mov_b32 s65, 0x40000
L_sl2:
    s_sleep 2
    v_and_b32 v161, 31, v0
    v_lshlrev_b32 v161, 4, v161
    s_lshl_b32 s76, s80, 4
    buffer_load_dwordx4 v[152:155], v161, s[40:43], s76 offen offset:0 sc1
    buffer_load_dwordx4 v[156:159], v161, s[40:43], s76 offen offset:512 sc1
    s_waitcnt vmcnt(0)
    v_xor_b32 v160, s100, v154
    v_bitop3_b32 v160, v160, v158, s100 bitop3:0xf6
    v_bitop3_b32 v160, v160, v155, s101 bitop3:0xf6
    v_bitop3_b32 v160, v160, v159, s101 bitop3:0xf6
    v_cmp_ne_u32 vcc, 0, v160
    s_nop 0
    s_and_b64 vcc, vcc, exec
    s_cbranch_scc0 L_sok2
    s_sub_u32 s65, s65, 1
    s_cbranch_scc0 L_sl2
L_sok2:
    v_mfma_f32_32x32x16_bf16 v[96:111], v[44:47], v[224:227], v[96:111]
    s_cmp_ge_u32 s23, 6
    s_cselect_b32 s4, s21, s72
    s_add_u32 m0, s74, 98304
    s_add_u32 s81, s4, 786432
    buffer_load_dwordx4 v3, s[32:35], s81 offen lds
    v_mfma_f32_16x16x32_bf16 v[30:33], v[180:183], v[44:47], v[30:33]
    v_mfma_f32_32x32x16_bf16 v[112:127], v[44:47], v[228:231], v[112:127]
    ds_read_b64_tr_b16 v[44:45], v12 offset:12288
    ds_read_b64_tr_b16 v[46:47], v12 offset:13312
    ds_read_b128 v[252:255], v10 offset:4096
    v_cmp_gt_u32 vcc, 32, v0
    s_cmp_lt_u32 s67, 5
    s_cselect_b32 s76, 1051011932, 1.0
    v_cndmask_b32 v22, 0, v152, vcc
    v_cndmask_b32 v24, 0, v156, vcc
    v_mul_f32 v20, s76, v153
    v_mul_f32 v21, s76, v157
    s_waitcnt lgkmcnt(15)
    v_mfma_f32_32x32x16_bf16 v[64:79], v[48:51], v[232:235], v[64:79]
    s_barrier
    s_add_u32 m0, s74, 102400
    s_add_u32 s81, s4, 884736
    buffer_load_dwordx4 v3, s[32:35], s81 offen lds
    v_mfma_f32_16x16x32_bf16 v[36:39], v[180:183], v[48:51], v[36:39]
    v_and_b32 v23, 0xffff, v22
    v_mov_b32 v18, v153
    s_waitcnt lgkmcnt(12)
    v_mfma_f32_32x32x16_bf16 v[80:95], v[48:51], v[236:239], v[80:95]
    v_add_u32 v13, 0x8000, v13
    ds_read_b64_tr_b16 v[48:49], v13 offset:0
    ds_read_b64_tr_b16 v[50:51], v13 offset:512
    s_add_u32 m0, s74, 106496
    s_add_u32 s81, s4, 786432
    buffer_load_dwordx4 v4, s[36:39], s81 offen lds
    v_mfma_f32_32x32x16_bf16 v[96:111], v[52:55], v[232:235], v[96:111]
    s_add_u32 m0, s74, 110592
    s_add_u32 s81, s4, 884736
    buffer_load_dwordx4 v4, s[36:39], s81 offen lds
    v_and_b32 v25, 0xffff, v24
    v_mov_b32 v19, v157
    v_mfma_f32_16x16x32_bf16 v[30:33], v[180:183], v[52:55], v[30:33]
    v_mfma_f32_32x32x16_bf16 v[112:127], v[52:55], v[236:239], v[112:127]
    v_add_u32 v14, 0x8000, v14
    ds_read_b64_tr_b16 v[52:53], v14 offset:0
    ds_read_b64_tr_b16 v[54:55], v14 offset:512
    s_waitcnt lgkmcnt(14)
    s_waitcnt lgkmcnt(13)
    v_mfma_f32_32x32x16_bf16 v[64:79], v[56:59], v[240:243], v[64:79]
    s_cmp_ge_u32 s23, 5
    s_cselect_b32 s4, s21, s72
    s_add_u32 m0, s74, 114688
    s_add_u32 s81, s4, 983040
    buffer_load_dwordx4 v3, s[32:35], s81 offen lds
    v_mfma_f32_16x16x32_bf16 v[36:39], v[180:183], v[56:59], v[36:39]
    s_waitcnt lgkmcnt(10)
    v_mfma_f32_32x32x16_bf16 v[80:95], v[56:59], v[244:247], v[80:95]
    ds_read_b64_tr_b16 v[56:57], v13 offset:2048
    ds_read_b64_tr_b16 v[58:59], v13 offset:2560
    v_mfma_f32_32x32x16_bf16 v[96:111], v[60:63], v[240:243], v[96:111]
    s_add_u32 m0, s74, 118784
    s_add_u32 s81, s4, 1081344
    buffer_load_dwordx4 v3, s[32:35], s81 offen lds
    v_mfma_f32_16x16x32_bf16 v[30:33], v[180:183], v[60:63], v[30:33]
    v_mfma_f32_32x32x16_bf16 v[112:127], v[60:63], v[244:247], v[112:127]
    ds_read_b64_tr_b16 v[60:61], v14 offset:2048
    ds_read_b64_tr_b16 v[62:63], v14 offset:2560
    s_waitcnt lgkmcnt(12)
    s_waitcnt lgkmcnt(11)
    v_mfma_f32_32x32x16_bf16 v[64:79], v[40:43], v[248:251], v[64:79]
    s_add_u32 m0, s74, 122880
    s_add_u32 s81, s4, 983040
    buffer_load_dwordx4 v4, s[36:39], s81 offen lds
    v_mfma_f32_16x16x32_bf16 v[36:39], v[180:183], v[40:43], v[36:39]
    s_waitcnt lgkmcnt(8)
    v_mfma_f32_32x32x16_bf16 v[80:95], v[40:43], v[252:255], v[80:95]
    ds_read_b64_tr_b16 v[40:41], v13 offset:4096
    ds_read_b64_tr_b16 v[42:43], v13 offset:4608
    v_mfma_f32_32x32x16_bf16 v[96:111], v[44:47], v[248:251], v[96:111]
    s_add_u32 m0, s74, 126976
    s_add_u32 s81, s4, 1081344
    buffer_load_dwordx4 v4, s[36:39], s81 offen lds
    v_mfma_f32_16x16x32_bf16 v[30:33], v[180:183], v[44:47], v[30:33]
    v_mfma_f32_32x32x16_bf16 v[112:127], v[44:47], v[252:255], v[112:127]
    ds_read_b64_tr_b16 v[44:45], v14 offset:4096
    ds_read_b64_tr_b16 v[46:47], v14 offset:4608
    s_waitcnt lgkmcnt(10)
    v_mfma_f32_32x32x16_bf16 v[128:143], v[48:51], a[0:3], 0
    s_cmp_ge_u32 s23, 4
    s_cselect_b32 s4, s21, s72
    s_add_u32 m0, s74, 131072
    s_add_u32 s81, s4, 1179648
    buffer_load_dwordx4 v3, s[32:35], s81 offen lds
    v_mfma_f32_32x32x16_bf16 v[144:159], v[48:51], a[4:7], 0
    ds_read_b64_tr_b16 v[48:49], v13 offset:6144
    ds_read_b64_tr_b16 v[50:51], v13 offset:6656
    s_add_u32 m0, s74, 135168
    s_add_u32 s81, s4, 1277952
    buffer_load_dwordx4 v3, s[32:35], s81 offen lds
    s_waitcnt lgkmcnt(10)
    v_mfma_f32_32x32x16_bf16 v[160:175], v[52:55], a[0:3], 0
    s_add_u32 m0, s74, 139264
    s_add_u32 s81, s4, 1179648
    buffer_load_dwordx4 v4, s[36:39], s81 offen lds
    v_cvt_pk_bf16_f32 v37, v36, v36
    v_and_b32 v37, 0xffff0000, v37
    v_mfma_f32_32x32x16_bf16 v[176:191], v[52:55], a[4:7], 0
    ds_read_b64_tr_b16 v[52:53], v14 offset:6144
    ds_read_b64_tr_b16 v[54:55], v14 offset:6656
    s_add_u32 m0, s74, 143360
    s_add_u32 s81, s4, 1277952
    buffer_load_dwordx4 v4, s[36:39], s81 offen lds
    s_waitcnt lgkmcnt(10)
    v_mfma_f32_32x32x16_bf16 v[128:143], v[56:59], a[8:11], v[128:143]
    s_waitcnt vmcnt(20)
    s_barrier
    v_sub_f32 v37, v36, v37
    v_cvt_pk_bf16_f32 v26, v36, v37
    v_and_b32 v38, 0xffff0000, v26
    v_sub_f32 v37, v37, v38
    v_mfma_f32_32x32x16_bf16 v[144:159], v[56:59], a[12:15], v[144:159]
    v_add_u32 v13, 0x4000, v13
    ds_read_b64_tr_b16 v[56:57], v13 offset:0
    ds_read_b64_tr_b16 v[58:59], v13 offset:512
    s_cmp_ge_u32 s23, 3
    s_cselect_b32 s4, s21, s72
    s_add_u32 m0, s74, 0
    s_add_u32 s81, s4, 1376256
    buffer_load_dwordx4 v3, s[32:35], s81 offen lds
    s_waitcnt lgkmcnt(10)
    v_mfma_f32_32x32x16_bf16 v[160:175], v[60:63], a[8:11], v[160:175]
    v_cvt_pk_bf16_f32 v27, v37, 0
    v_cvt_pk_bf16_f32 v31, v30, v30
    v_and_b32 v31, 0xffff0000, v31
    v_sub_f32 v31, v30, v31
    v_cvt_pk_bf16_f32 v28, v30, v31
    v_mfma_f32_32x32x16_bf16 v[176:191], v[60:63], a[12:15], v[176:191]
    v_add_u32 v14, 0x4000, v14
    ds_read_b64_tr_b16 v[60:61], v14 offset:0
    ds_read_b64_tr_b16 v[62:63], v14 offset:512
    s_add_u32 m0, s74, 4096
    s_add_u32 s81, s4, 1474560
    buffer_load_dwordx4 v3, s[32:35], s81 offen lds
    s_waitcnt lgkmcnt(10)
    v_mfma_f32_32x32x16_bf16 v[128:143], v[40:43], a[16:19], v[128:143]
    v_and_b32 v32, 0xffff0000, v28
    v_sub_f32 v31, v31, v32
    v_cvt_pk_bf16_f32 v29, v31, 0
    v_mfma_f32_32x32x8_bf16 v[64:79], v[26:27], v[22:23], v[64:79]
    v_mfma_f32_32x32x8_bf16 v[80:95], v[26:27], v[24:25], v[80:95]
    v_mfma_f32_32x32x8_bf16 v[96:111], v[28:29], v[22:23], v[96:111]
    v_mfma_f32_32x32x8_bf16 v[112:127], v[28:29], v[24:25], v[112:127]
    s_lshl_b32 s77, s67, 13
    s_lshl_b32 s76, s69, 12
    s_add_u32 s77, s77, s76
    s_lshr_b32 s76, s80, 5
    s_mul_i32 s76, s76, 81920
    s_add_u32 s77, s77, s76
    v_mfma_f32_32x32x16_bf16 v[144:159], v[40:43], a[20:23], v[144:159]
    ds_read_b64_tr_b16 v[40:41], v13 offset:2048
    ds_read_b64_tr_b16 v[42:43], v13 offset:2560
    s_add_u32 m0, s74, 8192
    s_add_u32 s81, s4, 1376256
    buffer_load_dwordx4 v4, s[36:39], s81 offen lds
    s_waitcnt lgkmcnt(10)
    v_mfma_f32_32x32x16_bf16 v[160:175], v[44:47], a[16:19], v[160:175]
    s_add_u32 m0, s74, 12288
    s_add_u32 s81, s4, 1474560
    buffer_load_dwordx4 v4, s[36:39], s81 offen lds
    s_add_u32 s77, s77, 1048576
    v_mul_f32 v64, v64, v20
    v_mfma_f32_32x32x16_bf16 v[176:191], v[44:47], a[20:23], v[176:191]
    ds_read_b64_tr_b16 v[44:45], v14 offset:2048
    ds_read_b64_tr_b16 v[46:47], v14 offset:2560
    s_cmp_ge_u32 s23, 2
    s_cselect_b32 s4, s21, s72
    s_add_u32 m0, s74, 16384
    s_add_u32 s81, s4, 1572864
    buffer_load_dwordx4 v3, s[32:35], s81 offen lds
    s_waitcnt lgkmcnt(10)
    v_mfma_f32_32x32x16_bf16 v[128:143], v[48:51], a[24:27], v[128:143]
    s_add_u32 m0, s74, 20480
    s_add_u32 s81, s4, 1671168
    buffer_load_dwordx4 v3, s[32:35], s81 offen lds
    v_mul_f32 v65, v65, v20
    v_mul_f32 v66, v66, v20
    v_mfma_f32_32x32x16_bf16 v[144:159], v[48:51], a[28:31], v[144:159]
    ds_read_b64_tr_b16 v[48:49], v13 offset:4096
    ds_read_b64_tr_b16 v[50:51], v13 offset:4608
    v_mul_f32 v67, v67, v20
    v_mul_f32 v68, v68, v20
    v_mul_f32 v69, v69, v20
    v_mul_f32 v70, v70, v20
    s_waitcnt lgkmcnt(10)
    v_mfma_f32_32x32x16_bf16 v[160:175], v[52:55], a[24:27], v[160:175]
    s_add_u32 m0, s74, 24576
    s_add_u32 s81, s4, 1572864
    buffer_load_dwordx4 v4, s[36:39], s81 offen lds
    v_mul_f32 v71, v71, v20
    v_mul_f32 v72, v72, v20
    v_mfma_f32_32x32x16_bf16 v[176:191], v[52:55], a[28:31], v[176:191]
    ds_read_b64_tr_b16 v[52:53], v14 offset:4096
    ds_read_b64_tr_b16 v[54:55], v14 offset:4608
    v_mul_f32 v73, v73, v20
    v_mul_f32 v74, v74, v20
    v_mul_f32 v75, v75, v20
    v_mul_f32 v76, v76, v20
    s_waitcnt lgkmcnt(10)
    v_mfma_f32_32x32x16_bf16 v[128:143], v[56:59], a[32:35], v[128:143]
    s_add_u32 m0, s74, 28672
    s_add_u32 s81, s4, 1671168
    buffer_load_dwordx4 v4, s[36:39], s81 offen lds
    v_mul_f32 v77, v77, v20
    v_mul_f32 v78, v78, v20
    v_mfma_f32_32x32x16_bf16 v[144:159], v[56:59], a[36:39], v[144:159]
    ds_read_b64_tr_b16 v[56:57], v13 offset:6144
    ds_read_b64_tr_b16 v[58:59], v13 offset:6656
    v_mul_f32 v79, v79, v20
    v_cvt_pk_bf16_f32 v64, v64, v65
    v_cvt_pk_bf16_f32 v65, v66, v67
    s_waitcnt lgkmcnt(10)
    v_mfma_f32_32x32x16_bf16 v[160:175], v[60:63], a[32:35], v[160:175]
    v_cvt_pk_bf16_f32 v66, v68, v69
    v_cvt_pk_bf16_f32 v67, v70, v71
    v_cvt_pk_bf16_f32 v72, v72, v73
    v_cvt_pk_bf16_f32 v73, v74, v75
    v_cvt_pk_bf16_f32 v74, v76, v77
    v_mfma_f32_32x32x16_bf16 v[176:191], v[60:63], a[36:39], v[176:191]
    ds_read_b64_tr_b16 v[60:61], v14 offset:6144
    ds_read_b64_tr_b16 v[62:63], v14 offset:6656
    s_add_u32 s5, s77, 0
    buffer_store_dwordx4 v[64:67], v16, s[40:43], s5 offen offset:0 sc1
    v_cvt_pk_bf16_f32 v75, v78, v79
    s_waitcnt lgkmcnt(10)
    v_mfma_f32_32x32x16_bf16 v[128:143], v[40:43], a[40:43], v[128:143]
    s_waitcnt vmcnt(25)
    s_barrier
    s_cmp_ge_u32 s23, 1
    s_cselect_b32 s4, s21, s72
    s_add_u32 m0, s74, 32768
    s_add_u32 s81, s4, 1769472
    buffer_load_dwordx4 v3, s[32:35], s81 offen lds
    v_mfma_f32_32x32x16_bf16 v[144:159], v[40:43], a[44:47], v[144:159]
    v_add_u32 v13, 0x4000, v13
    ds_read_b64_tr_b16 v[40:41], v13 offset:0
    ds_read_b64_tr_b16 v[42:43], v13 offset:512
    s_add_u32 m0, s74, 36864
    s_add_u32 s81, s4, 1867776
    buffer_load_dwordx4 v3, s[32:35], s81 offen lds
    s_waitcnt lgkmcnt(10)
    v_mfma_f32_32x32x16_bf16 v[160:175], v[44:47], a[40:43], v[160:175]
    s_add_u32 m0, s74, 40960
    s_add_u32 s81, s4, 1769472
    buffer_load_dwordx4 v4, s[36:39], s81 offen lds
    v_mul_f32 v80, v80, v21
    v_mul_f32 v81, v81, v21
    v_mfma_f32_32x32x16_bf16 v[176:191], v[44:47], a[44:47], v[176:191]
    v_add_u32 v14, 0x4000, v14
    ds_read_b64_tr_b16 v[44:45], v14 offset:0
    ds_read_b64_tr_b16 v[46:47], v14 offset:512
    v_mul_f32 v82, v82, v21
    v_mul_f32 v83, v83, v21
    v_mul_f32 v84, v84, v21
    s_waitcnt lgkmcnt(10)
    v_mfma_f32_32x32x16_bf16 v[128:143], v[48:51], a[48:51], v[128:143]
    s_add_u32 m0, s74, 45056
    s_add_u32 s81, s4, 1867776
    buffer_load_dwordx4 v4, s[36:39], s81 offen lds
    v_mul_f32 v85, v85, v21
    v_mul_f32 v86, v86, v21
    v_mfma_f32_32x32x16_bf16 v[144:159], v[48:51], a[52:55], v[144:159]
    ds_read_b64_tr_b16 v[48:49], v13 offset:2048
    ds_read_b64_tr_b16 v[50:51], v13 offset:2560
    v_mul_f32 v87, v87, v21
    v_mul_f32 v88, v88, v21
    v_mul_f32 v89, v89, v21
    v_mul_f32 v90, v90, v21
    s_waitcnt lgkmcnt(10)
    v_mfma_f32_32x32x16_bf16 v[160:175], v[52:55], a[48:51], v[160:175]
    s_add_u32 s5, s77, 0
    buffer_store_dwordx4 v[72:75], v16, s[40:43], s5 offen offset:1024 sc1
    v_mul_f32 v91, v91, v21
    v_mul_f32 v92, v92, v21
    v_mul_f32 v93, v93, v21
    v_mfma_f32_32x32x16_bf16 v[176:191], v[52:55], a[52:55], v[176:191]
    ds_read_b64_tr_b16 v[52:53], v14 offset:2048
    ds_read_b64_tr_b16 v[54:55], v14 offset:2560
    v_mul_f32 v94, v94, v21
    v_mul_f32 v95, v95, v21
    v_cvt_pk_bf16_f32 v80, v80, v81
    v_cvt_pk_bf16_f32 v81, v82, v83
    s_waitcnt lgkmcnt(10)
    v_mfma_f32_32x32x16_bf16 v[128:143], v[56:59], a[56:59], v[128:143]
    v_cvt_pk_bf16_f32 v82, v84, v85
    v_cvt_pk_bf16_f32 v83, v86, v87
    v_cvt_pk_bf16_f32 v88, v88, v89
    v_cvt_pk_bf16_f32 v89, v90, v91
    v_cvt_pk_bf16_f32 v90, v92, v93
    v_mfma_f32_32x32x16_bf16 v[144:159], v[56:59], a[60:63], v[144:159]
    ds_read_b64_tr_b16 v[56:57], v13 offset:4096
    ds_read_b64_tr_b16 v[58:59], v13 offset:4608
    v_cvt_pk_bf16_f32 v91, v94, v95
    v_mul_f32 v96, v96, v20
    v_mul_f32 v97, v97, v20
    v_mul_f32 v98, v98, v20
    s_waitcnt lgkmcnt(10)
    v_mfma_f32_32x32x16_bf16 v[160:175], v[60:63], a[56:59], v[160:175]
    v_mul_f32 v99, v99, v20
    v_mul_f32 v100, v100, v20
    v_mul_f32 v101, v101, v20
    v_mul_f32 v102, v102, v20
    v_mul_f32 v103, v103, v20
    v_mul_f32 v104, v104, v20
    v_mfma_f32_32x32x16_bf16 v[176:191], v[60:63], a[60:63], v[176:191]
    ds_read_b64_tr_b16 v[60:61], v14 offset:4096
    ds_read_b64_tr_b16 v[62:63], v14 offset:4608
    v_mul_f32 v105, v105, v20
    v_mul_f32 v106, v106, v20
    v_mul_f32 v107, v107, v20
    v_mul_f32 v108, v108, v20
    s_waitcnt lgkmcnt(10)
    v_mfma_f32_32x32x16_bf16 v[128:143], v[40:43], a[64:67], v[128:143]
    v_mul_f32 v109, v109, v20
    v_mul_f32 v110, v110, v20
    v_mul_f32 v111, v111, v20
    v_cvt_pk_bf16_f32 v96, v96, v97
    v_cvt_pk_bf16_f32 v97, v98, v99
    v_mfma_f32_32x32x16_bf16 v[144:159], v[40:43], a[68:71], v[144:159]
    ds_read_b64_tr_b16 v[40:41], v13 offset:6144
    ds_read_b64_tr_b16 v[42:43], v13 offset:6656
    s_add_u32 s5, s77, 81920
    buffer_store_dwordx4 v[80:83], v16, s[40:43], s5 offen offset:0 sc1
    v_cvt_pk_bf16_f32 v98, v100, v101
    s_waitcnt lgkmcnt(10)
    v_mfma_f32_32x32x16_bf16 v[160:175], v[44:47], a[64:67], v[160:175]
    v_cvt_pk_bf16_f32 v99, v102, v103
    v_cvt_pk_bf16_f32 v104, v104, v105
    v_cvt_pk_bf16_f32 v105, v106, v107
    v_cvt_pk_bf16_f32 v106, v108, v109
    v_cvt_pk_bf16_f32 v107, v110, v111
    v_mfma_f32_32x32x16_bf16 v[176:191], v[44:47], a[68:71], v[176:191]
    ds_read_b64_tr_b16 v[44:45], v14 offset:6144
    ds_read_b64_tr_b16 v[46:47], v14 offset:6656
    v_mul_f32 v112, v112, v21
    v_mul_f32 v113, v113, v21
    v_mul_f32 v114, v114, v21
    v_mul_f32 v115, v115, v21
    s_waitcnt lgkmcnt(10)
    v_mfma_f32_32x32x16_bf16 v[128:143], v[48:51], a[72:75], v[128:143]
    s_waitcnt vmcnt(27)
    s_barrier
    s_mov_b32 s4, s73
    s_add_u32 m0, s74, 49152
    s_add_u32 s81, s4, 0
    buffer_load_dwordx4 v5, s[32:35], s81 offen lds
    v_mfma_f32_32x32x16_bf16 v[144:159], v[48:51], a[76:79], v[144:159]
    v_add_u32 v13, 0x4000, v13
    ds_read_b64_tr_b16 v[48:49], v13 offset:0
    ds_read_b64_tr_b16 v[50:51], v13 offset:512
    s_add_u32 m0, s74, 57344
    s_add_u32 s81, s4, 0
    buffer_load_dwordx4 v6, s[36:39], s81 offen lds
    s_waitcnt lgkmcnt(10)
    v_mfma_f32_32x32x16_bf16 v[160:175], v[52:55], a[72:75], v[160:175]
    s_cmp_ge_u32 s23, 9
    s_cselect_b32 s4, s22, s73
    s_add_u32 m0, s74, 53248
    s_add_u32 s81, s4, 196608
    buffer_load_dwordx4 v5, s[32:35], s81 offen lds
    v_mfma_f32_32x32x16_bf16 v[176:191], v[52:55], a[76:79], v[176:191]
    v_add_u32 v14, 0x4000, v14
    ds_read_b64_tr_b16 v[52:53], v14 offset:0
    ds_read_b64_tr_b16 v[54:55], v14 offset:512
    s_add_u32 m0, s74, 61440
    s_add_u32 s81, s4, 196608
    buffer_load_dwordx4 v6, s[36:39], s81 offen lds
    s_waitcnt lgkmcnt(10)
    v_mfma_f32_32x32x16_bf16 v[128:143], v[56:59], a[80:83], v[128:143]
    s_add_u32 s5, s77, 81920
    buffer_store_dwordx4 v[88:91], v16, s[40:43], s5 offen offset:1024 sc1
    v_mul_f32 v116, v116, v21
    v_mul_f32 v117, v117, v21
    v_mul_f32 v118, v118, v21
    v_mfma_f32_32x32x16_bf16 v[144:159], v[56:59], a[84:87], v[144:159]
    ds_read_b64_tr_b16 v[56:57], v13 offset:2048
    ds_read_b64_tr_b16 v[58:59], v13 offset:2560
    v_mul_f32 v119, v119, v21
    v_mul_f32 v120, v120, v21
    v_mul_f32 v121, v121, v21
    v_mul_f32 v122, v122, v21
    s_waitcnt lgkmcnt(10)
    v_mfma_f32_32x32x16_bf16 v[160:175], v[60:63], a[80:83], v[160:175]
    v_mul_f32 v123, v123, v21
    v_mul_f32 v124, v124, v21
    v_mul_f32 v125, v125, v21
    v_mul_f32 v126, v126, v21
    v_mul_f32 v127, v127, v21
    v_cvt_pk_bf16_f32 v112, v112, v113
    v_mfma_f32_32x32x16_bf16 v[176:191], v[60:63], a[84:87], v[176:191]
    ds_read_b64_tr_b16 v[60:61], v14 offset:2048
    ds_read_b64_tr_b16 v[62:63], v14 offset:2560
    v_cvt_pk_bf16_f32 v113, v114, v115
    v_cvt_pk_bf16_f32 v114, v116, v117
    v_cvt_pk_bf16_f32 v115, v118, v119
    s_waitcnt lgkmcnt(10)
    v_mfma_f32_32x32x16_bf16 v[128:143], v[40:43], a[88:91], v[128:143]
    v_cvt_pk_bf16_f32 v120, v120, v121
    v_cvt_pk_bf16_f32 v121, v122, v123
    v_cvt_pk_bf16_f32 v122, v124, v125
    v_cvt_pk_bf16_f32 v123, v126, v127
    s_lshl_b32 s75, s66, 4
    v_mfma_f32_32x32x16_bf16 v[144:159], v[40:43], a[92:95], v[144:159]
    ds_read_b64_tr_b16 v[40:41], v13 offset:4096
    ds_read_b64_tr_b16 v[42:43], v13 offset:4608
    s_add_u32 s75, s75, s67
    s_min_u32 s76, s75, 169
    s_mul_i32 s79, s76, 241
    s_lshr_b32 s79, s79, 12
    s_waitcnt lgkmcnt(10)
    v_mfma_f32_32x32x16_bf16 v[160:175], v[44:47], a[88:91], v[160:175]
    s_mul_i32 s20, s79, 17
    s_sub_u32 s76, s76, s20
    s_lshl_b32 s76, s76, 2
    s_add_u32 s76, s76, s64
    s_mul_i32 s20, s79, 272
    s_add_u32 s20, s20, s76
    v_mfma_f32_32x32x16_bf16 v[176:191], v[44:47], a[92:95], v[176:191]
    ds_read_b64_tr_b16 v[44:45], v14 offset:4096
    ds_read_b64_tr_b16 v[46:47], v14 offset:4608
    s_add_u32 s5, s77, 0
    buffer_store_dwordx4 v[96:99], v16, s[40:43], s5 offen offset:2048 sc1
    s_lshl_b32 s20, s20, 10
    s_waitcnt lgkmcnt(10)
    v_mfma_f32_32x32x16_bf16 v[128:143], v[48:51], a[96:99], v[128:143]
    s_add_u32 s20, s20, 22020096
    s_cmp_gt_u32 s75, 169
    s_cselect_b32 s20, 0x7f000000, s20
    s_cmp_lt_u32 s76, 48
    s_cselect_b32 s60, s48, s44
    s_cselect_b32 s61, s49, s45
    s_cselect_b32 s62, s50, s46
    s_cselect_b32 s75, 0, 48
    v_mfma_f32_32x32x16_bf16 v[144:159], v[48:51], a[100:103], v[144:159]
    ds_read_b64_tr_b16 v[48:49], v13 offset:6144
    ds_read_b64_tr_b16 v[50:51], v13 offset:6656
    s_mov_b32 s63, 0x20000
    s_sub_u32 s76, s76, s75
    s_mul_i32 s76, s76, 40960
    s_lshl_b32 s79, s79, 7
    s_waitcnt lgkmcnt(10)
    v_mfma_f32_32x32x16_bf16 v[160:175], v[52:55], a[96:99], v[160:175]
    s_add_u32 s76, s76, s79
    v_lshrrev_b32 v1, 3, v0
    v_and_b32 v2, 7, v0
    v_mul_u32_u24 v1, 1280, v1
    v_lshl_add_u32 v1, v2, 4, v1
    s_lshl_b32 s79, s64, 12
    v_mfma_f32_32x32x16_bf16 v[176:191], v[52:55], a[100:103], v[176:191]
    ds_read_b64_tr_b16 v[52:53], v14 offset:6144
    ds_read_b64_tr_b16 v[54:55], v14 offset:6656
    s_add_u32 s79, s79, 147456
    s_add_u32 m0, s79, 0
    s_add_u32 s75, s76, 0
    buffer_load_dwordx4 v1, s[60:63], s75 offen lds
    s_waitcnt lgkmcnt(10)
    v_mfma_f32_32x32x16_bf16 v[128:143], v[56:59], a[104:107], v[128:143]
    s_waitcnt vmcnt(30)
    s_barrier
    s_cmp_ge_u32 s23, 8
    s_cselect_b32 s4, s22, s73
    s_add_u32 m0, s74, 65536
    s_add_u32 s81, s4, 393216
    buffer_load_dwordx4 v5, s[32:35], s81 offen lds
    v_mfma_f32_32x32x16_bf16 v[144:159], v[56:59], a[108:111], v[144:159]
    v_add_u32 v13, 0x4000, v13
    ds_read_b64_tr_b16 v[56:57], v13 offset:0
    ds_read_b64_tr_b16 v[58:59], v13 offset:512
    s_add_u32 m0, s74, 73728
    s_add_u32 s81, s4, 393216
    buffer_load_dwordx4 v6, s[36:39], s81 offen lds
    s_waitcnt lgkmcnt(10)
    v_mfma_f32_32x32x16_bf16 v[160:175], v[60:63], a[104:107], v[160:175]
    s_add_u32 s5, s77, 0
    buffer_store_dwordx4 v[104:107], v16, s[40:43], s5 offen offset:3072 sc1
    v_mfma_f32_32x32x16_bf16 v[176:191], v[60:63], a[108:111], v[176:191]
    v_add_u32 v14, 0x4000, v14
    ds_read_b64_tr_b16 v[60:61], v14 offset:0
    ds_read_b64_tr_b16 v[62:63], v14 offset:512
    s_cmp_ge_u32 s23, 7
    s_cselect_b32 s4, s22, s73
    s_add_u32 m0, s74, 69632
    s_add_u32 s81, s4, 589824
    buffer_load_dwordx4 v5, s[32:35], s81 offen lds
    s_waitcnt lgkmcnt(10)
    v_mfma_f32_32x32x16_bf16 v[128:143], v[40:43], a[112:115], v[128:143]
    v_mfma_f32_32x32x16_bf16 v[144:159], v[40:43], a[116:119], v[144:159]
    ds_read_b64_tr_b16 v[40:41], v13 offset:2048
    ds_read_b64_tr_b16 v[42:43], v13 offset:2560
    s_add_u32 m0, s74, 77824
    s_add_u32 s81, s4, 589824
    buffer_load_dwordx4 v6, s[36:39], s81 offen lds
    s_waitcnt lgkmcnt(10)
    v_mfma_f32_32x32x16_bf16 v[160:175], v[44:47], a[112:115], v[160:175]
    v_mfma_f32_32x32x16_bf16 v[176:191], v[44:47], a[116:119], v[176:191]
    ds_read_b64_tr_b16 v[44:45], v14 offset:2048
    ds_read_b64_tr_b16 v[46:47], v14 offset:2560
    s_add_u32 m0, s79, 1024
    s_add_u32 s75, s76, 10240
    buffer_load_dwordx4 v1, s[60:63], s75 offen lds
    s_waitcnt lgkmcnt(10)
    v_mfma_f32_32x32x16_bf16 v[128:143], v[48:51], a[120:123], v[128:143]
    v_mfma_f32_32x32x16_bf16 v[144:159], v[48:51], a[124:127], v[144:159]
    ds_read_b64_tr_b16 v[48:49], v13 offset:4096
    ds_read_b64_tr_b16 v[50:51], v13 offset:4608
    s_add_u32 s5, s77, 81920
    buffer_store_dwordx4 v[112:115], v16, s[40:43], s5 offen offset:2048 sc1
    s_waitcnt lgkmcnt(10)
    v_mfma_f32_32x32x16_bf16 v[160:175], v[52:55], a[120:123], v[160:175]
    s_add_u32 m0, s79, 2048
    s_add_u32 s75, s76, 20480
    buffer_load_dwordx4 v1, s[60:63], s75 offen lds
    v_mfma_f32_32x32x16_bf16 v[176:191], v[52:55], a[124:127], v[176:191]
    ds_read_b64_tr_b16 v[52:53], v14 offset:4096
    ds_read_b64_tr_b16 v[54:55], v14 offset:4608
    s_waitcnt lgkmcnt(10)
    v_mfma_f32_32x32x16_bf16 v[128:143], v[56:59], a[128:131], v[128:143]
    s_add_u32 m0, s79, 3072
    s_add_u32 s75, s76, 30720
    buffer_load_dwordx4 v1, s[60:63], s75 offen lds
    v_lshrrev_b32 v1, 4, v0
    v_bfe_u32 v2, v0, 2, 2
    v_mfma_f32_32x32x16_bf16 v[144:159], v[56:59], a[132:135], v[144:159]
    ds_read_b64_tr_b16 v[56:57], v13 offset:6144
    ds_read_b64_tr_b16 v[58:59], v13 offset:6656
    v_lshl_add_u32 v1, v1, 3, v2
    v_lshlrev_b32 v1, 7, v1
    v_and_b32 v2, 3, v0
    v_lshl_add_u32 v1, v2, 3, v1
    s_waitcnt lgkmcnt(10)
    v_mfma_f32_32x32x16_bf16 v[160:175], v[60:63], a[128:131], v[160:175]
    v_add_u32 v7, s79, v1
    s_mul_i32 s79, s67, 768
    s_add_u32 s76, s69, s3
    s_lshl_b32 s76, s76, 8
    s_add_u32 s79, s79, s76
    s_add_u32 s79, s79, 131072
    v_mfma_f32_32x32x16_bf16 v[176:191], v[60:63], a[132:135], v[176:191]
    ds_read_b64_tr_b16 v[60:61], v14 offset:6144
    ds_read_b64_tr_b16 v[62:63], v14 offset:6656
    s_add_u32 s76, s79, 0
    buffer_load_dwordx2 v[68:69], v35, s[40:43], s76 offen offset:0
    s_add_u32 s76, s79, 49152
    s_waitcnt lgkmcnt(10)
    v_mfma_f32_32x32x16_bf16 v[128:143], v[40:43], a[136:139], v[128:143]
    s_waitcnt vmcnt(36)
    s_barrier
    s_add_u32 s5, s77, 81920
    buffer_store_dwordx4 v[120:123], v16, s[40:43], s5 offen offset:3072 sc1
    v_mfma_f32_32x32x16_bf16 v[144:159], v[40:43], a[140:143], v[144:159]
    v_add_u32 v13, 0x4000, v13
    ds_read_b64_tr_b16 v[40:41], v13 offset:0
    ds_read_b64_tr_b16 v[42:43], v13 offset:512
    s_cmp_ge_u32 s23, 6
    s_cselect_b32 s4, s22, s73
    s_add_u32 m0, s74, 81920
    s_add_u32 s81, s4, 786432
    buffer_load_dwordx4 v5, s[32:35], s81 offen lds
    s_waitcnt lgkmcnt(10)
    v_mfma_f32_32x32x16_bf16 v[160:175], v[44:47], a[136:139], v[160:175]
    s_add_u32 m0, s74, 90112
    s_add_u32 s81, s4, 786432
    buffer_load_dwordx4 v6, s[36:39], s81 offen lds
    v_mfma_f32_32x32x16_bf16 v[176:191], v[44:47], a[140:143], v[176:191]
    v_add_u32 v14, 0x4000, v14
    ds_read_b64_tr_b16 v[44:45], v14 offset:0
    ds_read_b64_tr_b16 v[46:47], v14 offset:512
    s_cmp_ge_u32 s23, 5
    s_cselect_b32 s4, s22, s73
    s_add_u32 m0, s74, 86016
    s_add_u32 s81, s4, 983040
    buffer_load_dwordx4 v5, s[32:35], s81 offen lds
    s_waitcnt lgkmcnt(10)
    v_mfma_f32_32x32x16_bf16 v[128:143], v[48:51], a[144:147], v[128:143]
    v_mfma_f32_32x32x16_bf16 v[144:159], v[48:51], a[148:151], v[144:159]
    ds_read_b64_tr_b16 v[48:49], v13 offset:2048
    ds_read_b64_tr_b16 v[50:51], v13 offset:2560
    s_add_u32 m0, s74, 94208
    s_add_u32 s81, s4, 983040
    buffer_load_dwordx4 v6, s[36:39], s81 offen lds
    s_waitcnt lgkmcnt(10)
    v_mfma_f32_32x32x16_bf16 v[160:175], v[52:55], a[144:147], v[160:175]
    v_mfma_f32_32x32x16_bf16 v[176:191], v[52:55], a[148:151], v[176:191]
    ds_read_b64_tr_b16 v[52:53], v14 offset:2048
    ds_read_b64_tr_b16 v[54:55], v14 offset:2560
    buffer_load_dwordx2 v[70:71], v35, s[40:43], s76 offen offset:0
    s_add_u32 s76, s79, 98304
    s_waitcnt lgkmcnt(10)
    v_mfma_f32_32x32x16_bf16 v[128:143], v[56:59], a[152:155], v[128:143]
    buffer_load_dwordx2 v[76:77], v34, s[40:43], s76 offen offset:0
    s_add_u32 s76, s79, 0
    v_mfma_f32_32x32x16_bf16 v[144:159], v[56:59], a[156:159], v[144:159]
    ds_read_b64_tr_b16 v[56:57], v13 offset:4096
    ds_read_b64_tr_b16 v[58:59], v13 offset:4608
    buffer_load_dwordx2 v[78:79], v35, s[40:43], s76 offen offset:128
    s_add_u32 s76, s79, 49152
    s_waitcnt lgkmcnt(10)
    v_mfma_f32_32x32x16_bf16 v[160:175], v[60:63], a[152:155], v[160:175]
    buffer_load_dwordx2 v[84:85], v35, s[40:43], s76 offen offset:128
    s_add_u32 s76, s79, 98304
    buffer_load_dwordx2 v[86:87], v34, s[40:43], s76 offen offset:128
    s_mul_i32 s79, s67, 768
    v_mfma_f32_32x32x16_bf16 v[176:191], v[60:63], a[156:159], v[176:191]
    ds_read_b64_tr_b16 v[60:61], v14 offset:4096
    ds_read_b64_tr_b16 v[62:63], v14 offset:4608
    s_lshl_b32 s76, s69, 7
    s_add_u32 s79, s79, s76
    s_lshl_b32 s76, s3, 9
    s_sub_u32 s79, s79, s76
    s_waitcnt lgkmcnt(10)
    v_mfma_f32_32x32x16_bf16 v[128:143], v[40:43], a[160:163], v[128:143]
    s_add_u32 s79, s79, 131584
    s_add_u32 s76, s79, 0
    buffer_load_dwordx2 v[92:93], v35, s[40:43], s76 offen offset:0
    s_add_u32 s76, s79, 49152
    v_mfma_f32_32x32x16_bf16 v[144:159], v[40:43], a[164:167], v[144:159]
    ds_read_b64_tr_b16 v[40:41], v13 offset:6144
    ds_read_b64_tr_b16 v[42:43], v13 offset:6656
    buffer_load_dwordx2 v[94:95], v35, s[40:43], s76 offen offset:0
    s_add_u32 s76, s79, 98304
    s_waitcnt lgkmcnt(10)
    v_mfma_f32_32x32x16_bf16 v[160:175], v[44:47], a[160:163], v[160:175]
    buffer_load_dwordx2 v[100:101], v34, s[40:43], s76 offen offset:0
    v_mfma_f32_32x32x16_bf16 v[176:191], v[44:47], a[164:167], v[176:191]
    ds_read_b64_tr_b16 v[44:45], v14 offset:6144
    ds_read_b64_tr_b16 v[46:47], v14 offset:6656
    s_waitcnt lgkmcnt(10)
    v_mfma_f32_32x32x16_bf16 v[128:143], v[48:51], a[168:171], v[128:143]
    s_waitcnt vmcnt(45)
    s_barrier
    s_cmp_ge_u32 s23, 4
    s_cselect_b32 s4, s22, s73
    s_add_u32 m0, s74, 98304
    s_add_u32 s81, s4, 1179648
    buffer_load_dwordx4 v5, s[32:35], s81 offen lds
    v_mfma_f32_32x32x16_bf16 v[144:159], v[48:51], a[172:175], v[144:159]
    v_add_u32 v13, 0x4000, v13
    ds_read_b64_tr_b16 v[48:49], v13 offset:0
    ds_read_b64_tr_b16 v[50:51], v13 offset:512
    s_add_u32 m0, s74, 106496
    s_add_u32 s81, s4, 1179648
    buffer_load_dwordx4 v6, s[36:39], s81 offen lds
    s_waitcnt lgkmcnt(10)
    v_mfma_f32_32x32x16_bf16 v[160:175], v[52:55], a[168:171], v[160:175]
    s_cmp_ge_u32 s23, 3
    s_cselect_b32 s4, s22, s73
    s_add_u32 m0, s74, 102400
    s_add_u32 s81, s4, 1376256
    buffer_load_dwordx4 v5, s[32:35], s81 offen lds
    v_mfma_f32_32x32x16_bf16 v[176:191], v[52:55], a[172:175], v[176:191]
    v_add_u32 v14, 0x4000, v14
    ds_read_b64_tr_b16 v[52:53], v14 offset:0
    ds_read_b64_tr_b16 v[54:55], v14 offset:512
    s_add_u32 m0, s74, 110592
    s_add_u32 s81, s4, 1376256
    buffer_load_dwordx4 v6, s[36:39], s81 offen lds
    s_waitcnt lgkmcnt(10)
    v_mfma_f32_32x32x16_bf16 v[128:143], v[56:59], a[176:179], v[128:143]
    v_mfma_f32_32x32x16_bf16 v[144:159], v[56:59], a[180:183], v[144:159]
    ds_read_b64_tr_b16 v[56:57], v13 offset:2048
    ds_read_b64_tr_b16 v[58:59], v13 offset:2560
    s_waitcnt lgkmcnt(10)
    v_mfma_f32_32x32x16_bf16 v[160:175], v[60:63], a[176:179], v[160:175]
    v_mfma_f32_32x32x16_bf16 v[176:191], v[60:63], a[180:183], v[176:191]
    ds_read_b64_tr_b16 v[60:61], v14 offset:2048
    ds_read_b64_tr_b16 v[62:63], v14 offset:2560
    s_waitcnt lgkmcnt(10)
    v_mfma_f32_32x32x16_bf16 v[128:143], v[40:43], a[184:187], v[128:143]
    v_mfma_f32_32x32x16_bf16 v[144:159], v[40:43], a[188:191], v[144:159]
    ds_read_b64_tr_b16 v[40:41], v13 offset:4096
    ds_read_b64_tr_b16 v[42:43], v13 offset:4608
    s_waitcnt lgkmcnt(10)
    v_mfma_f32_32x32x16_bf16 v[160:175], v[44:47], a[184:187], v[160:175]
    v_mfma_f32_32x32x16_bf16 v[176:191], v[44:47], a[188:191], v[176:191]
    ds_read_b64_tr_b16 v[44:45], v14 offset:4096
    ds_read_b64_tr_b16 v[46:47], v14 offset:4608
    s_waitcnt vmcnt(18)
    ds_read_b64_tr_b16 v[64:65], v7 offset:0
    ds_read_b64_tr_b16 v[66:67], v7 offset:512
    ds_read_b64_tr_b16 v[72:73], v7 offset:32
    s_waitcnt lgkmcnt(13)
    v_mfma_f32_32x32x16_bf16 v[128:143], v[48:51], a[192:195], v[128:143]
    ds_read_b64_tr_b16 v[74:75], v7 offset:544
    ds_read_b64_tr_b16 v[80:81], v7 offset:64
    ds_read_b64_tr_b16 v[82:83], v7 offset:576
    ds_read_b64_tr_b16 v[88:89], v7 offset:96
    ds_read_b64_tr_b16 v[90:91], v7 offset:608
    v_mul_f32 v20, 0xbfb8aa3b, v18
    v_mfma_f32_32x32x16_bf16 v[144:159], v[48:51], a[196:199], v[144:159]
    ds_read_b64_tr_b16 v[48:49], v13 offset:6144
    ds_read_b64_tr_b16 v[50:51], v13 offset:6656
    s_add_u32 s5, s20, 0
    s_waitcnt lgkmcnt(8)
    buffer_store_dwordx4 v[64:67], v16, s[40:43], s5 offen sc1
    v_mfma_f32_32x32x16_bf16 v[160:175], v[52:55], a[192:195], v[160:175]
    v_mul_f32 v21, 0xbfb8aa3b, v19
    s_mul_i32 s78, s67, 6144
    s_lshr_b32 s76, s80, 5
    s_mul_i32 s76, s76, 139264
    s_add_u32 s78, s78, s76
    s_add_u32 s78, s78, 12582912
    v_mfma_f32_32x32x16_bf16 v[176:191], v[52:55], a[196:199], v[176:191]
    ds_read_b64_tr_b16 v[52:53], v14 offset:6144
    ds_read_b64_tr_b16 v[54:55], v14 offset:6656
    v_mfma_f32_32x32x16_bf16 v[128:143], v[56:59], a[200:203], v[128:143]
    s_barrier
    s_cmp_ge_u32 s23, 2
    s_cselect_b32 s4, s22, s73
    s_add_u32 m0, s74, 114688
    s_add_u32 s81, s4, 1572864
    buffer_load_dwordx4 v5, s[32:35], s81 offen lds
    v_mfma_f32_32x32x16_bf16 v[144:159], v[56:59], a[204:207], v[144:159]
    v_add_u32 v13, 0xfffe0000, v13
    ds_read_b64_tr_b16 v[56:57], v13 offset:0
    ds_read_b64_tr_b16 v[58:59], v13 offset:512
    s_add_u32 m0, s74, 122880
    s_add_u32 s81, s4, 1572864
    buffer_load_dwordx4 v6, s[36:39], s81 offen lds
    v_mfma_f32_32x32x16_bf16 v[160:175], v[60:63], a[200:203], v[160:175]
    s_cmp_ge_u32 s23, 1
    s_cselect_b32 s4, s22, s73
    s_add_u32 m0, s74, 118784
    s_add_u32 s81, s4, 1769472
    buffer_load_dwordx4 v5, s[32:35], s81 offen lds
    v_mfma_f32_32x32x16_bf16 v[176:191], v[60:63], a[204:207], v[176:191]
    v_add_u32 v14, 0xfffe0000, v14
    ds_read_b64_tr_b16 v[60:61], v14 offset:0
    ds_read_b64_tr_b16 v[62:63], v14 offset:512
    s_add_u32 m0, s74, 126976
    s_add_u32 s81, s4, 1769472
    buffer_load_dwordx4 v6, s[36:39], s81 offen lds
    v_mfma_f32_32x32x16_bf16 v[128:143], v[40:43], a[208:211], v[128:143]
    s_add_u32 s5, s20, 69632
    s_waitcnt lgkmcnt(12)
    buffer_store_dwordx4 v[72:75], v16, s[40:43], s5 offen sc1
    v_mfma_f32_32x32x16_bf16 v[144:159], v[40:43], a[212:215], v[144:159]
    ds_read_b64_tr_b16 v[40:41], v13 offset:2048
    ds_read_b64_tr_b16 v[42:43], v13 offset:2560
    v_mfma_f32_32x32x16_bf16 v[160:175], v[44:47], a[208:211], v[160:175]
    v_mfma_f32_32x32x16_bf16 v[176:191], v[44:47], a[212:215], v[176:191]
    ds_read_b64_tr_b16 v[44:45], v14 offset:2048
    ds_read_b64_tr_b16 v[46:47], v14 offset:2560
    s_waitcnt lgkmcnt(10)
    v_mfma_f32_32x32x16_bf16 v[128:143], v[48:51], a[216:219], v[128:143]
    v_mfma_f32_32x32x16_bf16 v[144:159], v[48:51], a[220:223], v[144:159]
    ds_read_b64_tr_b16 v[48:49], v13 offset:4096
    ds_read_b64_tr_b16 v[50:51], v13 offset:4608
    s_waitcnt lgkmcnt(10)
    v_mfma_f32_32x32x16_bf16 v[160:175], v[52:55], a[216:219], v[160:175]
    v_mfma_f32_32x32x16_bf16 v[176:191], v[52:55], a[220:223], v[176:191]
    ds_read_b64_tr_b16 v[52:53], v14 offset:4096
    ds_read_b64_tr_b16 v[54:55], v14 offset:4608
    s_add_u32 s5, s20, 139264
    buffer_store_dwordx4 v[80:83], v16, s[40:43], s5 offen sc1
    s_waitcnt lgkmcnt(10)
    v_mfma_f32_32x32x16_bf16 v[128:143], v[56:59], a[224:227], v[128:143]
    v_mfma_f32_32x32x16_bf16 v[144:159], v[56:59], a[228:231], v[144:159]
    ds_read_b64_tr_b16 v[56:57], v13 offset:6144
    ds_read_b64_tr_b16 v[58:59], v13 offset:6656
    s_waitcnt lgkmcnt(10)
    v_mfma_f32_32x32x16_bf16 v[160:175], v[60:63], a[224:227], v[160:175]
    s_waitcnt vmcnt(11)
    v_xor_b32 v102, s100, v69
    v_bitop3_b32 v102, v102, v71, s100 bitop3:0xf6
    v_bitop3_b32 v102, v102, v77, s100 bitop3:0xf6
    v_bitop3_b32 v102, v102, v79, s100 bitop3:0xf6
    v_bitop3_b32 v102, v102, v85, s100 bitop3:0xf6
    v_mfma_f32_32x32x16_bf16 v[176:191], v[60:63], a[228:231], v[176:191]
    ds_read_b64_tr_b16 v[60:61], v14 offset:6144
    ds_read_b64_tr_b16 v[62:63], v14 offset:6656
    v_bitop3_b32 v102, v102, v87, s100 bitop3:0xf6
    v_bitop3_b32 v102, v102, v93, s100 bitop3:0xf6
    v_bitop3_b32 v102, v102, v95, s100 bitop3:0xf6
    v_bitop3_b32 v102, v102, v101, s100 bitop3:0xf6
    s_waitcnt lgkmcnt(10)
    v_mfma_f32_32x32x16_bf16 v[128:143], v[40:43], a[232:235], v[128:143]
    s_barrier
    s_or_b32 s65, s100, 2
    v_mov_b32 v36, s65
    v_mov_b32 v37, s101
    s_lshl_b32 s65, s64, 25
    s_add_u32 s65, s65, s7
    v_lshlrev_b32 v38, 25, v0
    buffer_store_dwordx2 v[36:37], v38, s[40:43], s65 offen sc1
    v_mfma_f32_32x32x16_bf16 v[144:159], v[40:43], a[236:239], v[144:159]
    v_add_u32 v13, 0x4000, v13
    ds_read_b64_tr_b16 v[40:41], v13 offset:0
    ds_read_b64_tr_b16 v[42:43], v13 offset:512
    v_cmp_ne_u32 vcc, 0, v102
    s_nop 0
    s_and_b64 vcc, vcc, exec
    s_cbranch_scc0 L_sok3
    s_mov_b32 s65, 0x40000
L_sl3:
    s_sleep 2
    s_mul_i32 s79, s67, 768
    s_add_u32 s76, s69, s3
    s_lshl_b32 s76, s76, 8
    s_add_u32 s79, s79, s76
    s_add_u32 s79, s79, 131072
    s_add_u32 s76, s79, 0
    buffer_load_dwordx2 v[68:69], v35, s[40:43], s76 offen offset:0 sc1
    s_add_u32 s76, s79, 49152
    buffer_load_dwordx2 v[70:71], v35, s[40:43], s76 offen offset:0 sc1
    s_add_u32 s76, s79, 98304
    buffer_load_dwordx2 v[76:77], v34, s[40:43], s76 offen offset:0 sc1
    s_add_u32 s76, s79, 0
    buffer_load_dwordx2 v[78:79], v35, s[40:43], s76 offen offset:128 sc1
    s_add_u32 s76, s79, 49152
    buffer_load_dwordx2 v[84:85], v35, s[40:43], s76 offen offset:128 sc1
    s_add_u32 s76, s79, 98304
    buffer_load_dwordx2 v[86:87], v34, s[40:43], s76 offen offset:128 sc1
    s_mul_i32 s79, s67, 768
    s_lshl_b32 s76, s69, 7
    s_add_u32 s79, s79, s76
    s_lshl_b32 s76, s3, 9
    s_sub_u32 s79, s79, s76
    s_add_u32 s79, s79, 131584
    s_add_u32 s76, s79, 0
    buffer_load_dwordx2 v[92:93], v35, s[40:43], s76 offen offset:0 sc1
    s_add_u32 s76, s79, 49152
    buffer_load_dwordx2 v[94:95], v35, s[40:43], s76 offen offset:0 sc1
    s_add_u32 s76, s79, 98304
    buffer_load_dwordx2 v[100:101], v34, s[40:43], s76 offen offset:0 sc1
    s_waitcnt vmcnt(0)
    v_xor_b32 v102, s100, v69
    v_bitop3_b32 v102, v102, v71, s100 bitop3:0xf6
    v_bitop3_b32 v102, v102, v77, s100 bitop3:0xf6
    v_bitop3_b32 v102, v102, v79, s100 bitop3:0xf6
    v_bitop3_b32 v102, v102, v85, s100 bitop3:0xf6
    v_bitop3_b32 v102, v102, v87, s100 bitop3:0xf6
    v_bitop3_b32 v102, v102, v93, s100 bitop3:0xf6
    v_bitop3_b32 v102, v102, v95, s100 bitop3:0xf6
    v_bitop3_b32 v102, v102, v101, s100 bitop3:0xf6
    v_cmp_ne_u32 vcc, 0, v102
    s_nop 0
    s_and_b64 vcc, vcc, exec
    s_cbranch_scc0 L_sok3
    s_sub_u32 s65, s65, 1
    s_cbranch_scc0 L_sl3
L_sok3:
    s_waitcnt lgkmcnt(10)
    v_mfma_f32_32x32x16_bf16 v[160:175], v[44:47], a[232:235], v[160:175]
    s_add_u32 s5, s20, 208896
    buffer_store_dwordx4 v[88:91], v16, s[40:43], s5 offen sc1
    v_add_f32 v68, v68, v70
    v_mov_b32 v70, v68
    v_mfma_f32_32x32x16_bf16 v[176:191], v[44:47], a[236:239], v[176:191]
    v_add_u32 v14, 0x4000, v14
    ds_read_b64_tr_b16 v[44:45], v14 offset:0
    ds_read_b64_tr_b16 v[46:47], v14 offset:512
    v_permlane32_swap_b32 v68, v70
    v_add_f32 v68, v68, v70
    v_add_f32 v68, v68, v76
    s_waitcnt lgkmcnt(10)
    v_mfma_f32_32x32x16_bf16 v[128:143], v[48:51], a[240:243], v[128:143]
    v_cvt_pk_bf16_f32 v69, v68, v68
    v_and_b32 v69, 0xffff0000, v69
    v_sub_f32 v69, v68, v69
    v_cvt_pk_bf16_f32 v30, v68, v69
    v_and_b32 v70, 0xffff0000, v30
    v_mfma_f32_32x32x16_bf16 v[144:159], v[48:51], a[244:247], v[144:159]
    ds_read_b64_tr_b16 v[48:49], v13 offset:2048
    ds_read_b64_tr_b16 v[50:51], v13 offset:2560
    v_sub_f32 v69, v69, v70
    v_cvt_pk_bf16_f32 v31, v69, 0
    v_add_f32 v78, v78, v84
    v_mov_b32 v84, v78
    s_waitcnt lgkmcnt(10)
    v_mfma_f32_32x32x16_bf16 v[160:175], v[52:55], a[240:243], v[160:175]
    v_permlane32_swap_b32 v78, v84
    v_add_f32 v78, v78, v84
    v_add_f32 v78, v78, v86
    v_cvt_pk_bf16_f32 v79, v78, v78
    v_and_b32 v79, 0xffff0000, v79
    v_sub_f32 v79, v78, v79
    v_mfma_f32_32x32x16_bf16 v[176:191], v[52:55], a[244:247], v[176:191]
    ds_read_b64_tr_b16 v[52:53], v14 offset:2048
    ds_read_b64_tr_b16 v[54:55], v14 offset:2560
    v_cvt_pk_bf16_f32 v32, v78, v79
    v_and_b32 v84, 0xffff0000, v32
    v_sub_f32 v79, v79, v84
    v_cvt_pk_bf16_f32 v33, v79, 0
    s_waitcnt lgkmcnt(10)
    v_mfma_f32_32x32x16_bf16 v[128:143], v[56:59], a[248:251], v[128:143]
    v_add_f32 v92, v92, v94
    v_mov_b32 v94, v92
    s_nop 1
    v_permlane32_swap_b32 v92, v94
    v_add_f32 v92, v92, v94
    v_add_f32 v92, v92, v100
    v_cvt_pk_bf16_f32 v93, v92, v92
    v_mfma_f32_32x32x16_bf16 v[144:159], v[56:59], a[252:255], v[144:159]
    ds_read_b64_tr_b16 v[56:57], v13 offset:4096
    ds_read_b64_tr_b16 v[58:59], v13 offset:4608
    v_and_b32 v93, 0xffff0000, v93
    v_sub_f32 v93, v92, v93
    v_cvt_pk_bf16_f32 v34, v92, v93
    v_and_b32 v94, 0xffff0000, v34
    s_waitcnt lgkmcnt(10)
    v_mfma_f32_32x32x16_bf16 v[160:175], v[60:63], a[248:251], v[160:175]
    v_sub_f32 v93, v93, v94
    v_cvt_pk_bf16_f32 v35, v93, 0
    s_and_b32 s4, s2, 7
    s_lshl_b32 s4, s4, 2
    s_add_u32 s4, s4, s64
    s_lshr_b32 s5, s2, 3
    v_mfma_f32_32x32x16_bf16 v[176:191], v[60:63], a[252:255], v[176:191]
    ds_read_b64_tr_b16 v[60:61], v14 offset:4096
    ds_read_b64_tr_b16 v[62:63], v14 offset:4608
    s_mul_i32 s6, s4, 5
    s_add_u32 s6, s6, 1
    s_lshr_b32 s6, s6, 1
    s_lshl_b32 s11, s6, 9
    s_waitcnt lgkmcnt(10)
    v_mfma_f32_32x32x16_bf16 v[128:143], v[40:43], v[192:195], v[128:143]
    s_and_b32 s10, s4, 1
    s_movk_i32 s8, 1024
    s_cmp_eq_u32 s10, 1
    s_cselect_b32 s8, 0xfffffe08, s8
    s_add_u32 s12, s11, s8
    s_lshl_b32 s9, s5, 1
    v_mfma_f32_32x32x16_bf16 v[144:159], v[40:43], v[196:199], v[144:159]
    ds_read_b64_tr_b16 v[40:41], v13 offset:6144
    ds_read_b64_tr_b16 v[42:43], v13 offset:6656
    s_sub_u32 s9, s9, 8
    v_and_b32 v1, 31, v0
    v_lshrrev_b32 v2, 5, v0
    v_lshlrev_b32 v3, 4, v1
    s_waitcnt lgkmcnt(10)
    v_mfma_f32_32x32x16_bf16 v[160:175], v[44:47], v[192:195], v[160:175]
    v_lshlrev_b32 v4, 4, v0
    v_bfe_u32 v5, v0, 2, 1
    v_bfe_u32 v6, v0, 3, 1
    v_lshl_or_b32 v5, v5, 1, v6
    v_and_b32 v6, 3, v0
    v_lshl_add_u32 v5, v5, 2, v6
    v_mfma_f32_32x32x16_bf16 v[176:191], v[44:47], v[196:199], v[176:191]
    ds_read_b64_tr_b16 v[44:45], v14 offset:6144
    ds_read_b64_tr_b16 v[46:47], v14 offset:6656
    s_lshl_b32 s6, s10, 2
    v_add_u32 v5, s6, v5
    s_lshl_b32 s6, s10, 4
    v_subrev_u32 v6, s6, v1
    s_waitcnt lgkmcnt(10)
    v_mfma_f32_32x32x16_bf16 v[128:143], v[48:51], v[200:203], v[128:143]
    s_barrier
    v_cmp_gt_u32 vcc, 16, v1
    s_nop 1
    v_cndmask_b32 v5, v6, v5, vcc
    s_mul_i32 s13, s4, 20
    s_sub_u32 s6, 640, s13
    v_mfma_f32_32x32x16_bf16 v[144:159], v[48:51], v[204:207], v[144:159]
    v_add_u32 v13, 0x4000, v13
    ds_read_b64_tr_b16 v[48:49], v13 offset:0
    ds_read_b64_tr_b16 v[50:51], v13 offset:512
    v_mov_b32 v6, s6
    v_cmp_gt_u32 vcc, 20, v1
    s_nop 1
    v_cndmask_b32 v5, v6, v5, vcc
    s_waitcnt lgkmcnt(10)
    v_mfma_f32_32x32x16_bf16 v[160:175], v[52:55], v[200:203], v[160:175]
    v_mul_u32_u24 v6, 10368, v2
    v_lshl_add_u32 v5, v5, 4, v6
    s_lshl_b32 s13, s13, 4
    s_add_u32 s13, s13, 8388608
    v_and_b32 v6, 3, v0
    v_min_u32 v6, 2, v6
    v_mfma_f32_32x32x16_bf16 v[176:191], v[52:55], v[204:207], v[176:191]
    v_add_u32 v14, 0x4000, v14
    ds_read_b64_tr_b16 v[52:53], v14 offset:0
    ds_read_b64_tr_b16 v[54:55], v14 offset:512
    s_lshr_b32 s6, s5, 1
    v_sub_u32 v6, s6, v6
    v_max_i32 v6, 0, v6
    s_waitcnt lgkmcnt(10)
    v_mfma_f32_32x32x16_bf16 v[128:143], v[56:59], v[208:211], v[128:143]
    s_and_b32 s6, s2, 7
    s_mul_i32 s6, s6, 80
    v_bfe_u32 v8, v0, 2, 1
    v_mul_u32_u24 v8, 79, v8
    v_add_u32 v8, s6, v8
    v_lshrrev_b32 v8, 7, v8
    v_mfma_f32_32x32x16_bf16 v[144:159], v[56:59], v[212:215], v[144:159]
    ds_read_b64_tr_b16 v[56:57], v13 offset:2048
    ds_read_b64_tr_b16 v[58:59], v13 offset:2560
    v_bfe_u32 v9, v0, 3, 2
    v_mad_u32_u24 v8, v9, 5, v8
    v_min_u32 v8, 15, v8
    v_lshl_add_u32 v6, v6, 4, v8
    s_waitcnt lgkmcnt(10)
    v_mfma_f32_32x32x16_bf16 v[160:175], v[60:63], v[208:211], v[160:175]
    v_lshlrev_b32 v7, 7, v6
    v_add_u32 v7, 32768, v7
    v_mfma_f32_32x32x16_bf16 v[176:191], v[60:63], v[212:215], v[176:191]
    ds_read_b64_tr_b16 v[60:61], v14 offset:2048
    ds_read_b64_tr_b16 v[62:63], v14 offset:2560
    s_waitcnt lgkmcnt(10)
    v_mfma_f32_32x32x16_bf16 v[128:143], v[40:43], v[216:219], v[128:143]
    v_mfma_f32_32x32x16_bf16 v[144:159], v[40:43], v[220:223], v[144:159]
    ds_read_b64_tr_b16 v[40:41], v13 offset:4096
    ds_read_b64_tr_b16 v[42:43], v13 offset:4608
    s_waitcnt lgkmcnt(10)
    v_mfma_f32_32x32x16_bf16 v[160:175], v[44:47], v[216:219], v[160:175]
    v_mfma_f32_32x32x16_bf16 v[176:191], v[44:47], v[220:223], v[176:191]
    ds_read_b64_tr_b16 v[44:45], v14 offset:4096
    ds_read_b64_tr_b16 v[46:47], v14 offset:4608
    s_waitcnt lgkmcnt(10)
    v_mfma_f32_32x32x16_bf16 v[128:143], v[48:51], v[224:227], v[128:143]
    v_mfma_f32_32x32x16_bf16 v[144:159], v[48:51], v[228:231], v[144:159]
    ds_read_b64_tr_b16 v[48:49], v13 offset:6144
    ds_read_b64_tr_b16 v[50:51], v13 offset:6656
    s_waitcnt lgkmcnt(10)
    v_mfma_f32_32x32x16_bf16 v[160:175], v[52:55], v[224:227], v[160:175]
    v_mfma_f32_32x32x16_bf16 v[176:191], v[52:55], v[228:231], v[176:191]
    ds_read_b64_tr_b16 v[52:53], v14 offset:6144
    ds_read_b64_tr_b16 v[54:55], v14 offset:6656
    s_waitcnt lgkmcnt(10)
    v_mfma_f32_32x32x16_bf16 v[128:143], v[56:59], v[232:235], v[128:143]
    s_barrier
    v_mfma_f32_32x32x16_bf16 v[144:159], v[56:59], v[236:239], v[144:159]
    v_add_u32 v15, 0xc000, v15
    ds_read_b64_tr_b16 v[56:57], v15 offset:0
    ds_read_b64_tr_b16 v[58:59], v15 offset:256
    s_waitcnt lgkmcnt(10)
    v_mfma_f32_32x32x16_bf16 v[160:175], v[60:63], v[232:235], v[160:175]
    v_mfma_f32_32x32x16_bf16 v[176:191], v[60:63], v[236:239], v[176:191]
    ds_read_b64_tr_b16 v[60:61], v15 offset:1024
    ds_read_b64_tr_b16 v[62:63], v15 offset:1280
    s_waitcnt lgkmcnt(10)
    v_mfma_f32_32x32x16_bf16 v[128:143], v[40:43], v[240:243], v[128:143]
    v_mfma_f32_32x32x16_bf16 v[144:159], v[40:43], v[244:247], v[144:159]
    ds_read_b64_tr_b16 v[40:41], v15 offset:2048
    ds_read_b64_tr_b16 v[42:43], v15 offset:2304
    s_waitcnt lgkmcnt(10)
    v_mfma_f32_32x32x16_bf16 v[160:175], v[44:47], v[240:243], v[160:175]
    v_mfma_f32_32x32x16_bf16 v[176:191], v[44:47], v[244:247], v[176:191]
    ds_read_b64_tr_b16 v[44:45], v15 offset:3072
    ds_read_b64_tr_b16 v[46:47], v15 offset:3328
    s_waitcnt lgkmcnt(10)
    v_mfma_f32_32x32x16_bf16 v[128:143], v[48:51], v[248:251], v[128:143]
    v_mfma_f32_32x32x16_bf16 v[144:159], v[48:51], v[252:255], v[144:159]
    ds_read_b64_tr_b16 v[48:49], v15 offset:4096
    ds_read_b64_tr_b16 v[50:51], v15 offset:4352
    s_waitcnt lgkmcnt(10)
    v_mfma_f32_32x32x16_bf16 v[160:175], v[52:55], v[248:251], v[160:175]
    v_mfma_f32_32x32x16_bf16 v[176:191], v[52:55], v[252:255], v[176:191]
    ds_read_b64_tr_b16 v[52:53], v15 offset:5120
    ds_read_b64_tr_b16 v[54:55], v15 offset:5376
    s_waitcnt lgkmcnt(10)
    v_mfma_f32_32x32x16_bf16 v[64:79], v[56:59], a[0:3], 0
    v_mfma_f32_32x32x8_bf16 v[128:143], v[30:31], v[22:23], v[128:143]
    v_mfma_f32_32x32x8_bf16 v[144:159], v[30:31], v[24:25], v[144:159]
    v_mfma_f32_32x32x8_bf16 v[160:175], v[32:33], v[22:23], v[160:175]
    v_mfma_f32_32x32x8_bf16 v[176:191], v[32:33], v[24:25], v[176:191]
    s_add_u32 s76, s69, s3
    s_lshl_b32 s76, s76, 11
    s_add_u32 s78, s78, s76
    s_nop 5
    v_mul_f32 v128, v128, v20
    v_mul_f32 v129, v129, v20
    v_mul_f32 v130, v130, v20
    v_mfma_f32_32x32x16_bf16 v[80:95], v[56:59], a[4:7], 0
    ds_read_b64_tr_b16 v[56:57], v15 offset:6144
    ds_read_b64_tr_b16 v[58:59], v15 offset:6400
    v_mul_f32 v131, v131, v20
    v_exp_f32 v128, v128
    s_waitcnt lgkmcnt(10)
    v_mfma_f32_32x32x16_bf16 v[64:79], v[60:63], a[8:11], v[64:79]
    v_exp_f32 v129, v129
    v_exp_f32 v130, v130
    v_exp_f32 v131, v131
    v_mfma_f32_32x32x16_bf16 v[80:95], v[60:63], a[12:15], v[80:95]
    ds_read_b64_tr_b16 v[60:61], v15 offset:7168
    ds_read_b64_tr_b16 v[62:63], v15 offset:7424
    v_mul_f32 v136, v136, v18
    v_mul_f32 v137, v137, v18
    v_mul_f32 v138, v138, v18
    v_mul_f32 v139, v139, v18
    s_waitcnt lgkmcnt(10)
    v_mfma_f32_32x32x16_bf16 v[64:79], v[40:43], a[16:19], v[64:79]
    s_waitcnt vmcnt(0)
    s_barrier
    s_or_b32 s65, s100, 3
    v_mov_b32 v36, s65
    v_mov_b32 v37, s101
    s_lshl_b32 s65, s64, 25
    s_add_u32 s65, s65, s7
    v_lshlrev_b32 v38, 25, v0
    buffer_store_dwordx2 v[36:37], v38, s[40:43], s65 offen sc1
    v_mfma_f32_32x32x16_bf16 v[80:95], v[40:43], a[20:23], v[80:95]
    v_add_u32 v15, 0x4000, v15
    ds_read_b64_tr_b16 v[40:41], v15 offset:0
    ds_read_b64_tr_b16 v[42:43], v15 offset:256
    v_add_f32 v128, 1.0, v128
    v_add_f32 v129, 1.0, v129
    v_add_f32 v130, 1.0, v130
    s_waitcnt lgkmcnt(10)
    v_mfma_f32_32x32x16_bf16 v[64:79], v[44:47], a[24:27], v[64:79]
    v_add_f32 v131, 1.0, v131
    v_rcp_f32 v128, v128
    v_rcp_f32 v129, v129
    v_mfma_f32_32x32x16_bf16 v[80:95], v[44:47], a[28:31], v[80:95]
    ds_read_b64_tr_b16 v[44:45], v15 offset:1024
    ds_read_b64_tr_b16 v[46:47], v15 offset:1280
    v_rcp_f32 v130, v130
    v_rcp_f32 v131, v131
    s_waitcnt lgkmcnt(10)
    v_mfma_f32_32x32x16_bf16 v[64:79], v[48:51], a[32:35], v[64:79]
    s_nop 0
    v_mul_f32 v128, v128, v136
    v_mul_f32 v129, v129, v137
    v_mul_f32 v130, v130, v138
    v_mul_f32 v131, v131, v139
    v_mul_f32 v132, v132, v20
    v_mfma_f32_32x32x16_bf16 v[80:95], v[48:51], a[36:39], v[80:95]
    ds_read_b64_tr_b16 v[48:49], v15 offset:2048
    ds_read_b64_tr_b16 v[50:51], v15 offset:2304
    v_mul_f32 v133, v133, v20
    v_mul_f32 v134, v134, v20
    v_mul_f32 v135, v135, v20
    s_waitcnt lgkmcnt(10)
    v_mfma_f32_32x32x16_bf16 v[64:79], v[52:55], a[40:43], v[64:79]
    v_exp_f32 v132, v132
    v_exp_f32 v133, v133
    v_exp_f32 v134, v134
    v_mfma_f32_32x32x16_bf16 v[80:95], v[52:55], a[44:47], v[80:95]
    ds_read_b64_tr_b16 v[52:53], v15 offset:3072
    ds_read_b64_tr_b16 v[54:55], v15 offset:3328
    v_exp_f32 v135, v135
    v_mul_f32 v140, v140, v18
    v_mul_f32 v141, v141, v18
    s_waitcnt lgkmcnt(10)
    v_mfma_f32_32x32x16_bf16 v[64:79], v[56:59], a[48:51], v[64:79]
    v_mul_f32 v142, v142, v18
    v_mul_f32 v143, v143, v18
    v_add_f32 v132, 1.0, v132
    v_add_f32 v133, 1.0, v133
    v_add_f32 v134, 1.0, v134
    v_add_f32 v135, 1.0, v135
    v_mfma_f32_32x32x16_bf16 v[80:95], v[56:59], a[52:55], v[80:95]
    ds_read_b64_tr_b16 v[56:57], v15 offset:4096
    ds_read_b64_tr_b16 v[58:59], v15 offset:4352
    v_rcp_f32 v132, v132
    v_rcp_f32 v133, v133
    s_waitcnt lgkmcnt(10)
    v_mfma_f32_32x32x16_bf16 v[64:79], v[60:63], a[56:59], v[64:79]
    v_rcp_f32 v134, v134
    v_rcp_f32 v135, v135
    s_nop 0
    v_mul_f32 v132, v132, v140
    v_mfma_f32_32x32x16_bf16 v[80:95], v[60:63], a[60:63], v[80:95]
    ds_read_b64_tr_b16 v[60:61], v15 offset:5120
    ds_read_b64_tr_b16 v[62:63], v15 offset:5376
    v_mul_f32 v133, v133, v141
    v_mul_f32 v134, v134, v142
    v_mul_f32 v135, v135, v143
    v_cvt_pk_bf16_f32 v128, v128, v129
    s_waitcnt lgkmcnt(10)
    v_mfma_f32_32x32x16_bf16 v[64:79], v[40:43], a[64:67], v[64:79]
    v_cvt_pk_bf16_f32 v129, v130, v131
    v_cvt_pk_bf16_f32 v130, v132, v133
    v_cvt_pk_bf16_f32 v131, v134, v135
    s_add_u32 s76, s78, 0
    v_mfma_f32_32x32x16_bf16 v[80:95], v[40:43], a[68:71], v[80:95]
    ds_read_b64_tr_b16 v[40:41], v15 offset:6144
    ds_read_b64_tr_b16 v[42:43], v15 offset:6400
    buffer_store_dwordx4 v[128:131], v16, s[40:43], s76 offen sc1
    buffer_load_dwordx2 v[10:11], v7, s[40:43], 0 offen sc1
    s_waitcnt lgkmcnt(10)
    v_mfma_f32_32x32x16_bf16 v[64:79], v[44:47], a[72:75], v[64:79]
    v_mul_f32 v144, v144, v21
    v_mul_f32 v145, v145, v21
    v_mul_f32 v146, v146, v21
    v_mul_f32 v147, v147, v21
    v_exp_f32 v144, v144
    v_mfma_f32_32x32x16_bf16 v[80:95], v[44:47], a[76:79], v[80:95]
    ds_read_b64_tr_b16 v[44:45], v15 offset:7168
    ds_read_b64_tr_b16 v[46:47], v15 offset:7424
    v_exp_f32 v145, v145
    v_exp_f32 v146, v146
    s_waitcnt lgkmcnt(10)
    v_mfma_f32_32x32x16_bf16 v[64:79], v[48:51], a[80:83], v[64:79]
    s_barrier
    v_exp_f32 v147, v147
    v_mul_f32 v152, v152, v19
    v_mul_f32 v153, v153, v19
    v_mfma_f32_32x32x16_bf16 v[80:95], v[48:51], a[84:87], v[80:95]
    v_add_u32 v15, 0x4000, v15
    ds_read_b64_tr_b16 v[48:49], v15 offset:0
    ds_read_b64_tr_b16 v[50:51], v15 offset:256
    v_mul_f32 v154, v154, v19
    v_mul_f32 v155, v155, v19
    v_add_f32 v144, 1.0, v144
    s_waitcnt lgkmcnt(10)
    v_mfma_f32_32x32x16_bf16 v[64:79], v[52:55], a[88:91], v[64:79]
    v_add_f32 v145, 1.0, v145
    v_add_f32 v146, 1.0, v146
    v_add_f32 v147, 1.0, v147
    v_rcp_f32 v144, v144
    v_mfma_f32_32x32x16_bf16 v[80:95], v[52:55], a[92:95], v[80:95]
    ds_read_b64_tr_b16 v[52:53], v15 offset:1024
    ds_read_b64_tr_b16 v[54:55], v15 offset:1280
    v_rcp_f32 v145, v145
    v_rcp_f32 v146, v146
    s_waitcnt lgkmcnt(10)
    v_mfma_f32_32x32x16_bf16 v[64:79], v[56:59], a[96:99], v[64:79]
    v_rcp_f32 v147, v147
    s_nop 0
    v_mul_f32 v144, v144, v152
    v_mul_f32 v145, v145, v153
    v_mul_f32 v146, v146, v154
    v_mfma_f32_32x32x16_bf16 v[80:95], v[56:59], a[100:103], v[80:95]
    ds_read_b64_tr_b16 v[56:57], v15 offset:2048
    ds_read_b64_tr_b16 v[58:59], v15 offset:2304
    v_mul_f32 v147, v147, v155
    v_mul_f32 v148, v148, v21
    v_mul_f32 v149, v149, v21
    v_mul_f32 v150, v150, v21
    s_waitcnt lgkmcnt(10)
    v_mfma_f32_32x32x16_bf16 v[64:79], v[60:63], a[104:107], v[64:79]
    v_mul_f32 v151, v151, v21
    v_exp_f32 v148, v148
    v_exp_f32 v149, v149
    v_mfma_f32_32x32x16_bf16 v[80:95], v[60:63], a[108:111], v[80:95]
    ds_read_b64_tr_b16 v[60:61], v15 offset:3072
    ds_read_b64_tr_b16 v[62:63], v15 offset:3328
    v_exp_f32 v150, v150
    v_exp_f32 v151, v151
    s_waitcnt lgkmcnt(10)
    v_mfma_f32_32x32x16_bf16 v[64:79], v[40:43], a[112:115], v[64:79]
    v_mul_f32 v156, v156, v19
    v_mul_f32 v157, v157, v19
    v_mul_f32 v158, v158, v19
    v_mul_f32 v159, v159, v19
    v_add_f32 v148, 1.0, v148
    v_add_f32 v149, 1.0, v149
    v_mfma_f32_32x32x16_bf16 v[80:95], v[40:43], a[116:119], v[80:95]
    ds_read_b64_tr_b16 v[40:41], v15 offset:4096
    ds_read_b64_tr_b16 v[42:43], v15 offset:4352
    v_add_f32 v150, 1.0, v150
    v_add_f32 v151, 1.0, v151
    v_rcp_f32 v148, v148
    s_waitcnt lgkmcnt(10)
    v_mfma_f32_32x32x16_bf16 v[64:79], v[44:47], a[120:123], v[64:79]
    v_rcp_f32 v149, v149
    v_rcp_f32 v150, v150
    v_rcp_f32 v151, v151
    v_mfma_f32_32x32x16_bf16 v[80:95], v[44:47], a[124:127], v[80:95]
    ds_read_b64_tr_b16 v[44:45], v15 offset:5120
    ds_read_b64_tr_b16 v[46:47], v15 offset:5376
    s_nop 0
    v_mul_f32 v148, v148, v156
    v_mul_f32 v149, v149, v157
    v_mul_f32 v150, v150, v158
    s_waitcnt lgkmcnt(10)
    v_mfma_f32_32x32x16_bf16 v[64:79], v[48:51], a[128:131], v[64:79]
    v_mul_f32 v151, v151, v159
    v_cvt_pk_bf16_f32 v144, v144, v145
    v_cvt_pk_bf16_f32 v145, v146, v147
    v_cvt_pk_bf16_f32 v146, v148, v149
    v_cvt_pk_bf16_f32 v147, v150, v151
    v_mfma_f32_32x32x16_bf16 v[80:95], v[48:51], a[132:135], v[80:95]
    ds_read_b64_tr_b16 v[48:49], v15 offset:6144
    ds_read_b64_tr_b16 v[50:51], v15 offset:6400
    s_add_u32 s76, s78, 139264
    buffer_store_dwordx4 v[144:147], v16, s[40:43], s76 offen sc1
    s_waitcnt vmcnt(1)
    v_subrev_u32 v10, s100, v10
    v_subrev_u32 v10, 2, v10
    v_cmp_ne_u32 s[62:63], s101, v11
    v_cmp_lt_u32 vcc, 5, v10
    s_nop 0
    s_or_b64 vcc, vcc, s[62:63]
    s_cbranch_scc0 L_pok4
    s_mov_b32 s65, 0x80000
L_pl4:
    s_sleep 2
    buffer_load_dwordx2 v[10:11], v7, s[40:43], 0 offen sc1
    s_waitcnt vmcnt(0)
    v_subrev_u32 v10, s100, v10
    v_subrev_u32 v10, 2, v10
    v_cmp_ne_u32 s[62:63], s101, v11
    v_cmp_lt_u32 vcc, 5, v10
    s_nop 0
    s_or_b64 vcc, vcc, s[62:63]
    s_cbranch_scc0 L_pok4
    s_sub_u32 s65, s65, 1
    s_cbranch_scc0 L_pl4
L_pok4:
    s_waitcnt lgkmcnt(10)
    v_mfma_f32_32x32x16_bf16 v[64:79], v[52:55], a[136:139], v[64:79]
    s_sub_u32 s6, s12, s11
    s_add_u32 s6, s6, 512
    v_add_u32 v6, s6, v3
    v_mov_b32 v148, 0x3f80
    v_mov_b32 v149, 0
    v_mov_b32 v150, 0x3f80
    v_mfma_f32_32x32x16_bf16 v[80:95], v[52:55], a[140:143], v[80:95]
    ds_read_b64_tr_b16 v[52:53], v15 offset:7168
    ds_read_b64_tr_b16 v[54:55], v15 offset:7424
    v_mov_b32 v151, 0
    s_cmp_lt_i32 s9, 0
    s_cselect_b32 s6, 61769, 0
    v_mov_b32 v128, s6
    s_waitcnt lgkmcnt(10)
    v_mfma_f32_32x32x16_bf16 v[64:79], v[56:59], a[144:147], v[64:79]
    s_barrier
    v_mov_b32 v129, 0
    s_cmp_lt_i32 s9, -1
    s_cselect_b32 s6, 61769, 0
    v_mov_b32 v130, s6
    v_mfma_f32_32x32x16_bf16 v[80:95], v[56:59], a[148:151], v[80:95]
    v_add_u32 v15, 0x4000, v15
    ds_read_b64_tr_b16 v[56:57], v15 offset:0
    ds_read_b64_tr_b16 v[58:59], v15 offset:256
    v_mov_b32 v131, 0
    s_waitcnt lgkmcnt(10)
    v_mfma_f32_32x32x16_bf16 v[64:79], v[60:63], a[152:155], v[64:79]
    s_cmp_lt_i32 s9, -2
    s_cselect_b32 s6, 61769, 0
    v_mov_b32 v132, s6
    v_mov_b32 v133, 0
    v_mfma_f32_32x32x16_bf16 v[80:95], v[60:63], a[156:159], v[80:95]
    ds_read_b64_tr_b16 v[60:61], v15 offset:1024
    ds_read_b64_tr_b16 v[62:63], v15 offset:1280
    s_cmp_lt_i32 s9, -3
    s_cselect_b32 s6, 61769, 0
    v_mov_b32 v134, s6
    v_mov_b32 v135, 0
    s_waitcnt lgkmcnt(10)
    v_mfma_f32_32x32x16_bf16 v[64:79], v[40:43], a[160:163], v[64:79]
    s_cmp_lt_i32 s9, -4
    s_cselect_b32 s6, 61769, 0
    v_mov_b32 v136, s6
    v_mov_b32 v137, 0
    v_mfma_f32_32x32x16_bf16 v[80:95], v[40:43], a[164:167], v[80:95]
    ds_read_b64_tr_b16 v[40:41], v15 offset:2048
    ds_read_b64_tr_b16 v[42:43], v15 offset:2304
    s_cmp_lt_i32 s9, -5
    s_cselect_b32 s6, 61769, 0
    v_mov_b32 v138, s6
    v_mov_b32 v139, 0
    s_waitcnt lgkmcnt(10)
    v_mfma_f32_32x32x16_bf16 v[64:79], v[44:47], a[168:171], v[64:79]
    s_cmp_lt_i32 s9, -6
    s_cselect_b32 s6, 61769, 0
    v_mov_b32 v140, s6
    v_mov_b32 v141, 0
    v_mfma_f32_32x32x16_bf16 v[80:95], v[44:47], a[172:175], v[80:95]
    ds_read_b64_tr_b16 v[44:45], v15 offset:3072
    ds_read_b64_tr_b16 v[46:47], v15 offset:3328
    s_cmp_lt_i32 s9, -7
    s_cselect_b32 s6, 61769, 0
    v_mov_b32 v142, s6
    v_mov_b32 v143, 0
    s_waitcnt lgkmcnt(10)
    v_mfma_f32_32x32x16_bf16 v[64:79], v[48:51], a[176:179], v[64:79]
    v_mov_b32 v144, 0
    v_mov_b32 v145, 0
    v_mov_b32 v146, 0
    v_mov_b32 v147, 0
    v_mul_f32 v160, v160, v20
    v_mul_f32 v161, v161, v20
    v_mfma_f32_32x32x16_bf16 v[80:95], v[48:51], a[180:183], v[80:95]
    ds_read_b64_tr_b16 v[48:49], v15 offset:4096
    ds_read_b64_tr_b16 v[50:51], v15 offset:4352
    s_mul_i32 s14, s9, 81920
    s_add_u32 s8, s11, 1089536
    s_max_i32 s6, s14, 0
    s_add_u32 s70, s6, s8
    buffer_load_dwordx4 a[0:3], v4, s[40:43], s70 offen
    s_waitcnt lgkmcnt(10)
    v_mfma_f32_32x32x16_bf16 v[64:79], v[52:55], a[184:187], v[64:79]
    s_add_u32 s14, s14, 81920
    s_max_i32 s6, s14, 0
    s_add_u32 s71, s6, s8
    buffer_load_dwordx4 a[4:7], v4, s[40:43], s71 offen
    v_mul_f32 v162, v162, v20
    v_mfma_f32_32x32x16_bf16 v[80:95], v[52:55], a[188:191], v[80:95]
    ds_read_b64_tr_b16 v[52:53], v15 offset:5120
    ds_read_b64_tr_b16 v[54:55], v15 offset:5376
    s_add_u32 s14, s14, 81920
    s_max_i32 s6, s14, 0
    s_add_u32 s72, s6, s8
    buffer_load_dwordx4 a[8:11], v4, s[40:43], s72 offen
    s_waitcnt lgkmcnt(10)
    v_mfma_f32_32x32x16_bf16 v[64:79], v[56:59], a[192:195], v[64:79]
    s_add_u32 s14, s14, 81920
    s_max_i32 s6, s14, 0
    s_add_u32 s73, s6, s8
    buffer_load_dwordx4 a[12:15], v4, s[40:43], s73 offen
    v_mul_f32 v163, v163, v20
    v_mfma_f32_32x32x16_bf16 v[80:95], v[56:59], a[196:199], v[80:95]
    ds_read_b64_tr_b16 v[56:57], v15 offset:6144
    ds_read_b64_tr_b16 v[58:59], v15 offset:6400
    v_exp_f32 v160, v160
    v_exp_f32 v161, v161
    s_waitcnt lgkmcnt(10)
    v_mfma_f32_32x32x16_bf16 v[64:79], v[60:63], a[200:203], v[64:79]
    s_add_u32 s14, s14, 81920
    s_max_i32 s6, s14, 0
    s_add_u32 s0, s6, s8
    buffer_load_dwordx4 a[16:19], v4, s[40:43], s0 offen
    v_mfma_f32_32x32x16_bf16 v[80:95], v[60:63], a[204:207], v[80:95]
    ds_read_b64_tr_b16 v[60:61], v15 offset:7168
    ds_read_b64_tr_b16 v[62:63], v15 offset:7424
    v_exp_f32 v162, v162
    v_exp_f32 v163, v163
    s_waitcnt lgkmcnt(10)
    v_mfma_f32_32x32x16_bf16 v[64:79], v[40:43], a[208:211], v[64:79]
    s_barrier
    s_add_u32 s14, s14, 81920
    s_max_i32 s6, s14, 0
    s_add_u32 s1, s6, s8
    buffer_load_dwordx4 a[20:23], v4, s[40:43], s1 offen
    v_mfma_f32_32x32x16_bf16 v[80:95], v[40:43], a[212:215], v[80:95]
    v_add_u32 v15, 0x4000, v15
    ds_read_b64_tr_b16 v[40:41], v15 offset:0
    ds_read_b64_tr_b16 v[42:43], v15 offset:256
    v_mul_f32 v168, v168, v18
    v_mul_f32 v169, v169, v18
    v_mul_f32 v170, v170, v18
    s_waitcnt lgkmcnt(10)
    v_mfma_f32_32x32x16_bf16 v[64:79], v[44:47], a[216:219], v[64:79]
    s_add_u32 s14, s14, 81920
    s_max_i32 s6, s14, 0
    s_add_u32 s20, s6, s8
    buffer_load_dwordx4 a[24:27], v4, s[40:43], s20 offen
    v_mul_f32 v171, v171, v18
    v_mfma_f32_32x32x16_bf16 v[80:95], v[44:47], a[220:223], v[80:95]
    ds_read_b64_tr_b16 v[44:45], v15 offset:1024
    ds_read_b64_tr_b16 v[46:47], v15 offset:1280
    v_add_f32 v160, 1.0, v160
    v_add_f32 v161, 1.0, v161
    v_add_f32 v162, 1.0, v162
    v_add_f32 v163, 1.0, v163
    s_waitcnt lgkmcnt(10)
    v_mfma_f32_32x32x16_bf16 v[64:79], v[48:51], a[224:227], v[64:79]
    s_add_u32 s14, s14, 81920
    s_max_i32 s6, s14, 0
    s_add_u32 s21, s6, s8
    buffer_load_dwordx4 a[28:31], v4, s[40:43], s21 offen
    v_mfma_f32_32x32x16_bf16 v[80:95], v[48:51], a[228:231], v[80:95]
    ds_read_b64_tr_b16 v[48:49], v15 offset:2048
    ds_read_b64_tr_b16 v[50:51], v15 offset:2304
    s_add_u32 s14, s14, 81920
    s_max_i32 s6, s14, 0
    s_add_u32 s22, s6, s8
    buffer_load_dwordx4 a[32:35], v4, s[40:43], s22 offen
    s_waitcnt lgkmcnt(10)
    v_mfma_f32_32x32x16_bf16 v[64:79], v[52:55], a[232:235], v[64:79]
    v_rcp_f32 v160, v160
    v_rcp_f32 v161, v161
    v_rcp_f32 v162, v162
    v_mfma_f32_32x32x16_bf16 v[80:95], v[52:55], a[236:239], v[80:95]
    ds_read_b64_tr_b16 v[52:53], v15 offset:3072
    ds_read_b64_tr_b16 v[54:55], v15 offset:3328
    s_sub_u32 s6, s22, 40960
    buffer_load_dwordx4 a[120:123], v4, s[40:43], s6 offen
    s_waitcnt lgkmcnt(10)
    v_mfma_f32_32x32x16_bf16 v[64:79], v[56:59], a[240:243], v[64:79]
    v_rcp_f32 v163, v163
    s_nop 0
    v_mul_f32 v160, v160, v168
    v_mul_f32 v161, v161, v169
    v_mul_f32 v162, v162, v170
    v_mfma_f32_32x32x16_bf16 v[80:95], v[56:59], a[244:247], v[80:95]
    ds_read_b64_tr_b16 v[56:57], v15 offset:4096
    ds_read_b64_tr_b16 v[58:59], v15 offset:4352
    s_add_u32 s14, s14, 81920
    s_max_i32 s6, s14, 0
    s_add_u32 s23, s6, s8
    buffer_load_dwordx4 a[36:39], v4, s[40:43], s23 offen
    s_waitcnt lgkmcnt(10)
    v_mfma_f32_32x32x16_bf16 v[64:79], v[60:63], a[248:251], v[64:79]
    v_mul_f32 v163, v163, v171
    v_mul_f32 v164, v164, v20
    v_mul_f32 v165, v165, v20
    v_mul_f32 v166, v166, v20
    v_mul_f32 v167, v167, v20
    v_mfma_f32_32x32x16_bf16 v[80:95], v[60:63], a[252:255], v[80:95]
    ds_read_b64_tr_b16 v[60:61], v15 offset:5120
    ds_read_b64_tr_b16 v[62:63], v15 offset:5376
    s_sub_u32 s6, s23, 40960
    buffer_load_dwordx4 a[124:127], v4, s[40:43], s6 offen
    s_waitcnt lgkmcnt(10)
    v_mfma_f32_32x32x16_bf16 v[64:79], v[40:43], v[192:195], v[64:79]
    v_exp_f32 v164, v164
    v_exp_f32 v165, v165
    v_exp_f32 v166, v166
    v_mfma_f32_32x32x16_bf16 v[80:95], v[40:43], v[196:199], v[80:95]
    ds_read_b64_tr_b16 v[40:41], v15 offset:6144
    ds_read_b64_tr_b16 v[42:43], v15 offset:6400
    s_sub_u32 s6, s70, 512
    s_mov_b32 exec_hi, 0
    buffer_load_dwordx2 v[128:129], v6, s[40:43], s6 offen
    s_mov_b32 exec_hi, -1
    s_waitcnt lgkmcnt(10)
    v_mfma_f32_32x32x16_bf16 v[64:79], v[44:47], v[200:203], v[64:79]
    s_sub_u32 s6, s71, 512
    s_mov_b32 exec_hi, 0
    buffer_load_dwordx2 v[130:131], v6, s[40:43], s6 offen
    s_mov_b32 exec_hi, -1
    v_mfma_f32_32x32x16_bf16 v[80:95], v[44:47], v[204:207], v[80:95]
    ds_read_b64_tr_b16 v[44:45], v15 offset:7168
    ds_read_b64_tr_b16 v[46:47], v15 offset:7424
    s_sub_u32 s6, s72, 512
    s_mov_b32 exec_hi, 0
    buffer_load_dwordx2 v[132:133], v6, s[40:43], s6 offen
    s_mov_b32 exec_hi, -1
    s_waitcnt lgkmcnt(10)
    v_mfma_f32_32x32x16_bf16 v[64:79], v[48:51], v[208:211], v[64:79]
    s_sub_u32 s6, s73, 512
    s_mov_b32 exec_hi, 0
    buffer_load_dwordx2 v[134:135], v6, s[40:43], s6 offen
    s_mov_b32 exec_hi, -1
    v_mfma_f32_32x32x16_bf16 v[80:95], v[48:51], v[212:215], v[80:95]
    s_sub_u32 s6, s0, 512
    s_mov_b32 exec_hi, 0
    buffer_load_dwordx2 v[136:137], v6, s[40:43], s6 offen
    s_mov_b32 exec_hi, -1
    s_waitcnt lgkmcnt(8)
    v_mfma_f32_32x32x16_bf16 v[64:79], v[52:55], v[216:219], v[64:79]
    s_sub_u32 s6, s1, 512
    s_mov_b32 exec_hi, 0
    buffer_load_dwordx2 v[138:139], v6, s[40:43], s6 offen
    s_mov_b32 exec_hi, -1
    v_mfma_f32_32x32x16_bf16 v[80:95], v[52:55], v[220:223], v[80:95]
    s_sub_u32 s6, s20, 512
    s_mov_b32 exec_hi, 0
    buffer_load_dwordx2 v[140:141], v6, s[40:43], s6 offen
    s_mov_b32 exec_hi, -1
    s_waitcnt lgkmcnt(6)
    v_mfma_f32_32x32x16_bf16 v[64:79], v[56:59], v[224:227], v[64:79]
    s_sub_u32 s6, s21, 512
    s_mov_b32 exec_hi, 0
    buffer_load_dwordx2 v[142:143], v6, s[40:43], s6 offen
    s_mov_b32 exec_hi, -1
    v_mfma_f32_32x32x16_bf16 v[80:95], v[56:59], v[228:231], v[80:95]
    s_sub_u32 s6, s22, 512
    s_mov_b32 exec_hi, 0
    buffer_load_dwordx2 v[144:145], v6, s[40:43], s6 offen
    s_sub_u32 s6, s6, 40960
    buffer_load_dwordx2 v[148:149], v6, s[40:43], s6 offen
    s_mov_b32 exec_hi, -1
    s_waitcnt lgkmcnt(4)
    v_mfma_f32_32x32x16_bf16 v[64:79], v[60:63], v[232:235], v[64:79]
    s_sub_u32 s6, s23, 512
    s_mov_b32 exec_hi, 0
    buffer_load_dwordx2 v[146:147], v6, s[40:43], s6 offen
    s_sub_u32 s6, s6, 40960
    buffer_load_dwordx2 v[150:151], v6, s[40:43], s6 offen
    s_mov_b32 exec_hi, -1
    v_mfma_f32_32x32x16_bf16 v[80:95], v[60:63], v[236:239], v[80:95]
    s_mul_i32 s15, s9, 41472
    s_max_i32 s6, s15, 0
    s_add_u32 s6, s6, s13
    buffer_load_dwordx4 a[40:43], v5, s[40:43], s6 offen
    s_waitcnt lgkmcnt(2)
    v_mfma_f32_32x32x16_bf16 v[64:79], v[40:43], v[240:243], v[64:79]
    v_exp_f32 v167, v167
    v_mul_f32 v172, v172, v18
    v_mul_f32 v173, v173, v18
    v_mul_f32 v174, v174, v18
    v_mul_f32 v175, v175, v18
    v_mfma_f32_32x32x16_bf16 v[80:95], v[40:43], v[244:247], v[80:95]
    s_add_u32 s6, s6, 20736
    buffer_load_dwordx4 a[44:47], v5, s[40:43], s6 offen
    v_add_f32 v164, 1.0, v164
    v_add_f32 v165, 1.0, v165
    v_add_f32 v166, 1.0, v166
    s_waitcnt lgkmcnt(0)
    v_mfma_f32_32x32x16_bf16 v[64:79], v[44:47], v[248:251], v[64:79]
    v_add_f32 v167, 1.0, v167
    v_rcp_f32 v164, v164
    v_rcp_f32 v165, v165
    v_mfma_f32_32x32x16_bf16 v[80:95], v[44:47], v[252:255], v[80:95]
    s_add_u32 s15, s15, 41472
    s_max_i32 s6, s15, 0
    s_add_u32 s6, s6, s13
    buffer_load_dwordx4 a[48:51], v5, s[40:43], s6 offen
    v_rcp_f32 v166, v166
    v_rcp_f32 v167, v167
    s_nop 0
    v_mul_f32 v164, v164, v172
    v_mul_f32 v165, v165, v173
    v_mul_f32 v166, v166, v174
    v_mul_f32 v167, v167, v175
    v_cvt_pk_bf16_f32 v160, v160, v161
    v_cvt_pk_bf16_f32 v161, v162, v163
    v_cvt_pk_bf16_f32 v162, v164, v165
    v_cvt_pk_bf16_f32 v163, v166, v167
    s_add_u32 s76, s78, 1024
    buffer_store_dwordx4 v[160:163], v16, s[40:43], s76 offen sc1
    v_mul_f32 v176, v176, v21
    v_mul_f32 v177, v177, v21
    v_mul_f32 v178, v178, v21
    v_mul_f32 v179, v179, v21
    v_exp_f32 v176, v176
    v_exp_f32 v177, v177
    v_exp_f32 v178, v178
    v_exp_f32 v179, v179
    v_mul_f32 v184, v184, v19
    v_mul_f32 v185, v185, v19
    v_mul_f32 v186, v186, v19
    v_mul_f32 v187, v187, v19
    v_add_f32 v176, 1.0, v176
    v_add_f32 v177, 1.0, v177
    v_add_f32 v178, 1.0, v178
    v_add_f32 v179, 1.0, v179
    v_rcp_f32 v176, v176
    v_rcp_f32 v177, v177
    v_rcp_f32 v178, v178
    v_rcp_f32 v179, v179
    s_nop 0
    v_mul_f32 v176, v176, v184
    v_mul_f32 v177, v177, v185
    v_mul_f32 v178, v178, v186
    v_mul_f32 v179, v179, v187
    v_mul_f32 v180, v180, v21
    v_mul_f32 v181, v181, v21
    v_mul_f32 v182, v182, v21
    v_mul_f32 v183, v183, v21
    v_exp_f32 v180, v180
    v_exp_f32 v181, v181
    v_exp_f32 v182, v182
    v_exp_f32 v183, v183
    v_mul_f32 v188, v188, v19
    v_mul_f32 v189, v189, v19
    v_mul_f32 v190, v190, v19
    v_mul_f32 v191, v191, v19
    v_add_f32 v180, 1.0, v180
    v_add_f32 v181, 1.0, v181
    v_add_f32 v182, 1.0, v182
    v_add_f32 v183, 1.0, v183
    v_rcp_f32 v180, v180
    v_rcp_f32 v181, v181
    v_rcp_f32 v182, v182
    v_rcp_f32 v183, v183
    s_nop 0
    v_mul_f32 v180, v180, v188
    v_mul_f32 v181, v181, v189
    v_mul_f32 v182, v182, v190
    v_mul_f32 v183, v183, v191
    v_cvt_pk_bf16_f32 v176, v176, v177
    v_cvt_pk_bf16_f32 v177, v178, v179
    v_cvt_pk_bf16_f32 v178, v180, v181
    v_cvt_pk_bf16_f32 v179, v182, v183
    s_add_u32 s76, s78, 140288
    buffer_store_dwordx4 v[176:179], v16, s[40:43], s76 offen sc1
    s_lshl_b32 s76, s69, 10
    s_sub_u32 s78, s78, s76
    s_mul_i32 s76, s3, 6144
    s_sub_u32 s78, s78, s76
    v_mfma_f32_32x32x8_bf16 v[64:79], v[34:35], v[22:23], v[64:79]
    v_mfma_f32_32x32x8_bf16 v[80:95], v[34:35], v[24:25], v[80:95]
    s_add_u32 s6, s6, 20736
    buffer_load_dwordx4 a[52:55], v5, s[40:43], s6 offen
    s_add_u32 s15, s15, 41472
    s_max_i32 s6, s15, 0
    s_add_u32 s6, s6, s13
    buffer_load_dwordx4 a[56:59], v5, s[40:43], s6 offen
    s_add_u32 s6, s6, 20736
    buffer_load_dwordx4 a[60:63], v5, s[40:43], s6 offen
    s_add_u32 s15, s15, 41472
    s_max_i32 s6, s15, 0
    s_add_u32 s6, s6, s13
    buffer_load_dwordx4 a[64:67], v5, s[40:43], s6 offen
    s_add_u32 s6, s6, 20736
    buffer_load_dwordx4 a[68:71], v5, s[40:43], s6 offen
    s_add_u32 s15, s15, 41472
    s_max_i32 s6, s15, 0
    s_add_u32 s6, s6, s13
    buffer_load_dwordx4 a[72:75], v5, s[40:43], s6 offen
    s_add_u32 s6, s6, 20736
    buffer_load_dwordx4 a[76:79], v5, s[40:43], s6 offen
    s_add_u32 s15, s15, 41472
    s_max_i32 s6, s15, 0
    s_add_u32 s6, s6, s13
    buffer_load_dwordx4 a[80:83], v5, s[40:43], s6 offen
    s_add_u32 s6, s6, 20736
    buffer_load_dwordx4 a[84:87], v5, s[40:43], s6 offen
    s_add_u32 s15, s15, 41472
    s_max_i32 s6, s15, 0
    s_add_u32 s6, s6, s13
    buffer_load_dwordx4 a[88:91], v5, s[40:43], s6 offen
    s_add_u32 s6, s6, 20736
    buffer_load_dwordx4 a[92:95], v5, s[40:43], s6 offen
    s_add_u32 s15, s15, 41472
    s_max_i32 s6, s15, 0
    s_add_u32 s6, s6, s13
    buffer_load_dwordx4 a[96:99], v5, s[40:43], s6 offen
    s_add_u32 s6, s6, 20736
    buffer_load_dwordx4 a[100:103], v5, s[40:43], s6 offen
    s_add_u32 s15, s15, 41472
    s_max_i32 s6, s15, 0
    s_add_u32 s6, s6, s13
    buffer_load_dwordx4 a[104:107], v5, s[40:43], s6 offen
    s_add_u32 s6, s6, 20736
    buffer_load_dwordx4 a[108:111], v5, s[40:43], s6 offen
    s_add_u32 s15, s15, 41472
    s_max_i32 s6, s15, 0
    s_add_u32 s6, s6, s13
    buffer_load_dwordx4 a[112:115], v5, s[40:43], s6 offen
    s_add_u32 s6, s6, 20736
    buffer_load_dwordx4 a[116:119], v5, s[40:43], s6 offen
    s_bfe_u32 s18, s2, 0x20001
    s_lshl_b32 s18, s18, 3
    s_bfe_u32 s19, s2, 0x30003
    s_add_u32 s16, s18, s19
    s_and_b32 s18, s2, 1
    s_lshl_b32 s18, s18, 2
    s_lshr_b32 s19, s2, 6
    s_add_u32 s17, s18, s19
    s_mul_i32 s18, s17, 80
    v_lshrrev_b32 v12, 5, v0
    v_mul_u32_u24 v12, 79, v12
    v_add_u32 v12, s18, v12
    v_lshrrev_b32 v12, 6, v12
    v_and_b32 v13, 31, v0
    v_min_u32 v13, 16, v13
    v_mad_u32_u24 v12, v12, 17, v13
    v_lshlrev_b32 v188, 7, v12
    v_add_u32 v188, 32768, v188
    v_lshlrev_b32 v184, 4, v0
    s_mul_i32 s18, s17, 348160
    s_add_u32 s18, s18, 22020096
    s_mul_i32 s21, s64, 12288
    s_add_u32 s21, s21, s18
    s_mul_i32 s22, s64, 5120
    s_add_u32 s22, s22, s18
    s_add_u32 s22, s22, 49152
    s_mul_i32 s23, s64, 40960
    v_add_u32 v186, s23, v184
    v_and_b32 v12, 15, v0
    v_lshrrev_b32 v13, 4, v0
    v_lshlrev_b32 v185, 9, v13
    v_lshl_add_u32 v185, v12, 4, v185
    s_mul_i32 s20, s16, 278528
    s_add_u32 s20, s20, 12582912
    s_and_b32 s71, s17, 3
    s_mul_i32 s71, s71, 3
    s_and_b32 s18, s16, 7
    s_add_u32 s71, s71, s18
    s_cmp_ge_u32 s71, 12
    s_cselect_b32 s18, 12, 0
    s_sub_u32 s71, s71, s18
    s_lshl_b32 s18, s71, 10
    s_add_u32 s21, s21, s18
    s_sub_u32 s67, s21, 12288
    s_mul_i32 s68, s64, 24576
    s_add_u32 s68, s68, s20
    s_lshl_b32 s18, s71, 11
    s_add_u32 s68, s68, s18
    s_sub_u32 s69, s68, 24576
    s_mul_i32 s70, s64, 10240
    s_add_u32 s70, s70, s20
    s_add_u32 s70, s70, 98304
    s_lshr_b32 s18, s16, 1
    s_lshl_b32 s18, s18, 11
    s_add_u32 s18, s18, 32768
    v_lshl_add_u32 v187, v12, 7, s18
    buffer_load_dwordx2 v[12:13], v188, s[40:43], 0 offen sc1
    v_mul_f32 v64, v64, v20
    v_mul_f32 v65, v65, v20
    v_mul_f32 v66, v66, v20
    v_mul_f32 v67, v67, v20
    v_exp_f32 v64, v64
    v_exp_f32 v65, v65
    v_exp_f32 v66, v66
    v_exp_f32 v67, v67
    v_mul_f32 v72, v72, v18
    v_mul_f32 v73, v73, v18
    v_mul_f32 v74, v74, v18
    v_mul_f32 v75, v75, v18
    v_add_f32 v64, 1.0, v64
    v_add_f32 v65, 1.0, v65
    v_add_f32 v66, 1.0, v66
    v_add_f32 v67, 1.0, v67
    v_rcp_f32 v64, v64
    v_rcp_f32 v65, v65
    v_rcp_f32 v66, v66
    v_rcp_f32 v67, v67
    s_nop 0
    v_mul_f32 v64, v64, v72
    v_mul_f32 v65, v65, v73
    v_mul_f32 v66, v66, v74
    v_mul_f32 v67, v67, v75
    v_mul_f32 v68, v68, v20
    v_mul_f32 v69, v69, v20
    v_mul_f32 v70, v70, v20
    v_mul_f32 v71, v71, v20
    v_exp_f32 v68, v68
    v_exp_f32 v69, v69
    v_exp_f32 v70, v70
    v_exp_f32 v71, v71
    v_mul_f32 v76, v76, v18
    v_mul_f32 v77, v77, v18
    v_mul_f32 v78, v78, v18
    v_mul_f32 v79, v79, v18
    v_add_f32 v68, 1.0, v68
    v_add_f32 v69, 1.0, v69
    v_add_f32 v70, 1.0, v70
    v_add_f32 v71, 1.0, v71
    v_rcp_f32 v68, v68
    v_rcp_f32 v69, v69
    v_rcp_f32 v70, v70
    v_rcp_f32 v71, v71
    s_nop 0
    v_mul_f32 v68, v68, v76
    v_mul_f32 v69, v69, v77
    v_mul_f32 v70, v70, v78
    v_mul_f32 v71, v71, v79
    v_cvt_pk_bf16_f32 v64, v64, v65
    v_cvt_pk_bf16_f32 v65, v66, v67
    v_cvt_pk_bf16_f32 v66, v68, v69
    v_cvt_pk_bf16_f32 v67, v70, v71
    s_add_u32 s76, s78, 4096
    buffer_store_dwordx4 v[64:67], v16, s[40:43], s76 offen sc1
    v_mul_f32 v80, v80, v21
    v_mul_f32 v81, v81, v21
    v_mul_f32 v82, v82, v21
    v_mul_f32 v83, v83, v21
    v_exp_f32 v80, v80
    v_exp_f32 v81, v81
    v_exp_f32 v82, v82
    v_exp_f32 v83, v83
    v_mul_f32 v88, v88, v19
    v_mul_f32 v89, v89, v19
    v_mul_f32 v90, v90, v19
    v_mul_f32 v91, v91, v19
    v_add_f32 v80, 1.0, v80
    v_add_f32 v81, 1.0, v81
    v_add_f32 v82, 1.0, v82
    v_add_f32 v83, 1.0, v83
    v_rcp_f32 v80, v80
    v_rcp_f32 v81, v81
    v_rcp_f32 v82, v82
    v_rcp_f32 v83, v83
    s_nop 0
    v_mul_f32 v80, v80, v88
    v_mul_f32 v81, v81, v89
    v_mul_f32 v82, v82, v90
    v_mul_f32 v83, v83, v91
    v_mul_f32 v84, v84, v21
    v_mul_f32 v85, v85, v21
    v_mul_f32 v86, v86, v21
    v_mul_f32 v87, v87, v21
    v_exp_f32 v84, v84
    v_exp_f32 v85, v85
    v_exp_f32 v86, v86
    v_exp_f32 v87, v87
    v_mul_f32 v92, v92, v19
    v_mul_f32 v93, v93, v19
    v_mul_f32 v94, v94, v19
    v_mul_f32 v95, v95, v19
    v_add_f32 v84, 1.0, v84
    v_add_f32 v85, 1.0, v85
    v_add_f32 v86, 1.0, v86
    v_add_f32 v87, 1.0, v87
    v_rcp_f32 v84, v84
    v_rcp_f32 v85, v85
    v_rcp_f32 v86, v86
    v_rcp_f32 v87, v87
    s_nop 0
    v_mul_f32 v84, v84, v92
    v_mul_f32 v85, v85, v93
    v_mul_f32 v86, v86, v94
    v_mul_f32 v87, v87, v95
    v_cvt_pk_bf16_f32 v80, v80, v81
    v_cvt_pk_bf16_f32 v81, v82, v83
    v_cvt_pk_bf16_f32 v82, v84, v85
    v_cvt_pk_bf16_f32 v83, v86, v87
    s_add_u32 s76, s78, 143360
    buffer_store_dwordx4 v[80:83], v16, s[40:43], s76 offen sc1
    s_branch L_g1_join
.p2align 3
L_g1_V:
    s_waitcnt vmcnt(7)
    s_barrier
    s_cmp_ge_u32 s23, 9
    s_cselect_b32 s4, s0, s70
    s_add_u32 m0, s74, 32768
    s_add_u32 s81, s4, 128
    buffer_load_dwordx4 v1, s[24:27], s81 offen lds
    s_add_u32 m0, s74, 36864
    s_add_u32 s81, s4, 41088
    buffer_load_dwordx4 v1, s[24:27], s81 offen lds
    s_add_u32 m0, s74, 40960
    s_add_u32 s81, s4, 82048
    buffer_load_dwordx4 v1, s[24:27], s81 offen lds
    s_add_u32 m0, s74, 45056
    s_add_u32 s81, s4, 123008
    buffer_load_dwordx4 v1, s[24:27], s81 offen lds
    s_cmp_ge_u32 s23, 9
    s_cselect_b32 s4, s1, s71
    s_add_u32 m0, s74, 49152
    s_add_u32 s81, s4, 245760
    buffer_load_dwordx4 v2, s[28:31], s81 offen lds
    s_add_u32 m0, s74, 53248
    s_add_u32 s81, s4, 307200
    buffer_load_dwordx4 v2, s[28:31], s81 offen lds
    s_add_u32 m0, s74, 57344
    s_add_u32 s81, s4, 368640
    buffer_load_dwordx4 v2, s[28:31], s81 offen lds
    s_add_u32 m0, s74, 61440
    s_add_u32 s81, s4, 430080
    buffer_load_dwordx4 v2, s[28:31], s81 offen lds
    ds_read_b128 a[0:3], v7 offset:0
    ds_read_b128 a[4:7], v7 offset:4096
    ds_read_b128 a[8:11], v8 offset:0
    ds_read_b128 a[12:15], v8 offset:4096
    ds_read_b128 a[16:19], v9 offset:0
    ds_read_b128 a[20:23], v9 offset:4096
    ds_read_b128 a[24:27], v10 offset:0
    ds_read_b128 a[28:31], v10 offset:4096
    v_add_u32 v11, 0x4000, v11
    ds_read_b64_tr_b16 v[40:41], v11 offset:0
    ds_read_b64_tr_b16 v[42:43], v11 offset:1024
    v_add_u32 v12, 0x4000, v12
    ds_read_b64_tr_b16 v[44:45], v12 offset:0
    ds_read_b64_tr_b16 v[46:47], v12 offset:1024
    ds_read_b64_tr_b16 v[48:49], v11 offset:4096
    ds_read_b64_tr_b16 v[50:51], v11 offset:5120
    ds_read_b64_tr_b16 v[52:53], v12 offset:4096
    ds_read_b64_tr_b16 v[54:55], v12 offset:5120
    ds_read_b64_tr_b16 v[56:57], v11 offset:8192
    ds_read_b64_tr_b16 v[58:59], v11 offset:9216
    ds_read_b64_tr_b16 v[60:61], v12 offset:8192
    ds_read_b64_tr_b16 v[62:63], v12 offset:9216
    s_waitcnt lgkmcnt(10)
    v_mfma_f32_32x32x16_bf16 v[64:79], a[0:3], v[40:43], 0
    s_cmp_ge_u32 s23, 8
    s_cselect_b32 s4, s0, s70
    s_add_u32 m0, s74, 65536
    s_add_u32 s81, s4, 256
    buffer_load_dwordx4 v1, s[24:27], s81 offen lds
    v_mfma_f32_16x16x32_bf16 v[36:39], v[180:183], v[40:43], 0
    s_waitcnt vmcnt(11)
    v_lshlrev_b32 v138, 16, v128
    v_and_b32 v128, 0xffff0000, v128
    v_mfma_f32_32x32x16_bf16 v[80:95], a[4:7], v[40:43], 0
    ds_read_b64_tr_b16 v[40:41], v11 offset:12288
    ds_read_b64_tr_b16 v[42:43], v11 offset:13312
    s_add_u32 m0, s74, 69632
    s_add_u32 s81, s4, 41216
    buffer_load_dwordx4 v1, s[24:27], s81 offen lds
    s_waitcnt lgkmcnt(10)
    v_mfma_f32_32x32x16_bf16 v[96:111], a[0:3], v[44:47], 0
    s_add_u32 m0, s74, 73728
    s_add_u32 s81, s4, 82176
    buffer_load_dwordx4 v1, s[24:27], s81 offen lds
    v_lshlrev_b32 v139, 16, v129
    v_and_b32 v129, 0xffff0000, v129
    v_mfma_f32_16x16x32_bf16 v[30:33], v[180:183], v[44:47], 0
    v_lshlrev_b32 v140, 16, v130
    v_and_b32 v130, 0xffff0000, v130
    v_mfma_f32_32x32x16_bf16 v[112:127], a[4:7], v[44:47], 0
    ds_read_b64_tr_b16 v[44:45], v12 offset:12288
    ds_read_b64_tr_b16 v[46:47], v12 offset:13312
    s_add_u32 m0, s74, 77824
    s_add_u32 s81, s4, 123136
    buffer_load_dwordx4 v1, s[24:27], s81 offen lds
    s_waitcnt lgkmcnt(10)
    v_mfma_f32_32x32x16_bf16 v[64:79], a[8:11], v[48:51], v[64:79]
    s_waitcnt vmcnt(8)
    s_waitcnt vmcnt(4)
    s_barrier
    s_cmp_ge_u32 s23, 8
    s_cselect_b32 s4, s1, s71
    s_add_u32 m0, s74, 81920
    s_add_u32 s81, s4, 491520
    buffer_load_dwordx4 v2, s[28:31], s81 offen lds
    v_mfma_f32_16x16x32_bf16 v[36:39], v[180:183], v[48:51], v[36:39]
    v_lshlrev_b32 v141, 16, v131
    v_and_b32 v131, 0xffff0000, v131
    v_mfma_f32_32x32x16_bf16 v[80:95], a[12:15], v[48:51], v[80:95]
    v_add_u32 v11, 0x8000, v11
    ds_read_b64_tr_b16 v[48:49], v11 offset:0
    ds_read_b64_tr_b16 v[50:51], v11 offset:1024
    v_add_u32 v7, 0x8000, v7
    ds_read_b128 a[32:35], v7 offset:0
    s_waitcnt lgkmcnt(11)
    v_mfma_f32_32x32x16_bf16 v[96:111], a[8:11], v[52:55], v[96:111]
    s_add_u32 m0, s74, 86016
    s_add_u32 s81, s4, 552960
    buffer_load_dwordx4 v2, s[28:31], s81 offen lds
    v_lshlrev_b32 v142, 16, v132
    v_and_b32 v132, 0xffff0000, v132
    v_mfma_f32_16x16x32_bf16 v[30:33], v[180:183], v[52:55], v[30:33]
    v_lshlrev_b32 v143, 16, v133
    v_and_b32 v133, 0xffff0000, v133
    v_mfma_f32_32x32x16_bf16 v[112:127], a[12:15], v[52:55], v[112:127]
    v_add_u32 v12, 0x8000, v12
    ds_read_b64_tr_b16 v[52:53], v12 offset:0
    ds_read_b64_tr_b16 v[54:55], v12 offset:1024
    ds_read_b128 a[36:39], v7 offset:4096
    s_add_u32 m0, s74, 90112
    s_add_u32 s81, s4, 614400
    buffer_load_dwordx4 v2, s[28:31], s81 offen lds
    s_waitcnt lgkmcnt(12)
    v_mfma_f32_32x32x16_bf16 v[64:79], a[16:19], v[56:59], v[64:79]
    v_lshlrev_b32 v144, 16, v134
    v_and_b32 v134, 0xffff0000, v134
    v_lshlrev_b32 v145, 16, v135
    v_and_b32 v135, 0xffff0000, v135
    v_lshlrev_b32 v146, 16, v136
    v_and_b32 v136, 0xffff0000, v136
    v_mfma_f32_16x16x32_bf16 v[36:39], v[180:183], v[56:59], v[36:39]
    v_lshlrev_b32 v147, 16, v137
    v_and_b32 v137, 0xffff0000, v137
    v_mfma_f32_32x32x16_bf16 v[80:95], a[20:23], v[56:59], v[80:95]
    ds_read_b64_tr_b16 v[56:57], v11 offset:4096
    ds_read_b64_tr_b16 v[58:59], v11 offset:5120
    v_add_u32 v8, 0x8000, v8
    ds_read_b128 a[40:43], v8 offset:0
    s_add_u32 m0, s74, 94208
    s_add_u32 s81, s4, 675840
    buffer_load_dwordx4 v2, s[28:31], s81 offen lds
    s_waitcnt lgkmcnt(13)
    v_mfma_f32_32x32x16_bf16 v[96:111], a[16:19], v[60:63], v[96:111]
    v_lshrrev_b32 v176, 3, v0
    v_and_b32 v177, 7, v0
    v_mul_u32_u24 v176, 3072, v176
    v_lshl_add_u32 v176, v177, 4, v176
    buffer_load_dwordx4 v[152:155], v176, s[60:63], s14 offen
    v_mfma_f32_16x16x32_bf16 v[30:33], v[180:183], v[60:63], v[30:33]
    v_add_f32 v184, v138, v139
    v_add_f32 v178, v140, v141
    v_mfma_f32_32x32x16_bf16 v[112:127], a[20:23], v[60:63], v[112:127]
    ds_read_b64_tr_b16 v[60:61], v12 offset:4096
    ds_read_b64_tr_b16 v[62:63], v12 offset:5120
    ds_read_b128 a[44:47], v8 offset:4096
    s_add_u32 s14, s14, 98304
    buffer_load_dwordx4 v[156:159], v176, s[60:63], s14 offen
    s_waitcnt lgkmcnt(14)
    v_mfma_f32_32x32x16_bf16 v[64:79], a[24:27], v[40:43], v[64:79]
    v_add_f32 v184, v184, v142
    v_add_f32 v178, v178, v143
    v_add_f32 v184, v184, v144
    v_add_f32 v178, v178, v145
    v_add_f32 v184, v184, v146
    v_add_f32 v178, v178, v147
    v_mfma_f32_16x16x32_bf16 v[36:39], v[180:183], v[40:43], v[36:39]
    v_add_f32 v184, v184, v128
    v_add_f32 v178, v178, v129
    v_mfma_f32_32x32x16_bf16 v[80:95], a[28:31], v[40:43], v[80:95]
    ds_read_b64_tr_b16 v[40:41], v11 offset:8192
    ds_read_b64_tr_b16 v[42:43], v11 offset:9216
    v_add_u32 v9, 0x8000, v9
    ds_read_b128 a[48:51], v9 offset:0
    s_add_u32 s14, s14, 98304
    buffer_load_dwordx4 v[160:163], v176, s[60:63], s14 offen
    s_waitcnt lgkmcnt(15)
    v_mfma_f32_32x32x16_bf16 v[96:111], a[24:27], v[44:47], v[96:111]
    v_add_f32 v184, v184, v130
    v_add_f32 v178, v178, v131
    v_add_f32 v184, v184, v132
    v_add_f32 v178, v178, v133
    v_add_f32 v184, v184, v134
    v_add_f32 v178, v178, v135
    v_mfma_f32_16x16x32_bf16 v[30:33], v[180:183], v[44:47], v[30:33]
    v_add_f32 v184, v184, v136
    v_add_f32 v178, v178, v137
    v_mfma_f32_32x32x16_bf16 v[112:127], a[28:31], v[44:47], v[112:127]
    ds_read_b64_tr_b16 v[44:45], v12 offset:8192
    ds_read_b64_tr_b16 v[46:47], v12 offset:9216
    ds_read_b128 a[52:55], v9 offset:4096
    s_add_u32 s14, s14, 98304
    buffer_load_dwordx4 v[164:167], v176, s[60:63], s14 offen
    s_waitcnt lgkmcnt(15)
    v_mfma_f32_32x32x16_bf16 v[64:79], a[32:35], v[48:51], v[64:79]
    s_cmp_ge_u32 s23, 7
    s_cselect_b32 s4, s0, s70
    s_add_u32 m0, s74, 98304
    s_add_u32 s81, s4, 384
    buffer_load_dwordx4 v1, s[24:27], s81 offen lds
    v_mfma_f32_16x16x32_bf16 v[36:39], v[180:183], v[48:51], v[36:39]
    v_add_f32 v184, v184, v178
    s_nop 1
    v_add_f32_dpp v184, v184, v184 quad_perm:[1,0,3,2] row_mask:0xf bank_mask:0xf
    s_waitcnt lgkmcnt(12)
    v_mfma_f32_32x32x16_bf16 v[80:95], a[36:39], v[48:51], v[80:95]
    ds_read_b64_tr_b16 v[48:49], v11 offset:12288
    ds_read_b64_tr_b16 v[50:51], v11 offset:13312
    v_add_u32 v10, 0x8000, v10
    ds_read_b128 a[56:59], v10 offset:0
    s_add_u32 m0, s74, 102400
    s_add_u32 s81, s4, 41344
    buffer_load_dwordx4 v1, s[24:27], s81 offen lds
    v_mfma_f32_32x32x16_bf16 v[96:111], a[32:35], v[52:55], v[96:111]
    v_add_f32_dpp v184, v184, v184 quad_perm:[2,3,0,1] row_mask:0xf bank_mask:0xf
    s_nop 1
    v_add_f32_dpp v184, v184, v184 row_half_mirror row_mask:0xf bank_mask:0xf
    s_nop 1
    v_add_f32_dpp v184, v184, v184 row_mirror row_mask:0xf bank_mask:0xf
    v_mov_b32 v178, v184
    s_nop 1
    v_permlane16_swap_b32 v184, v178
    s_nop 1
    v_add_f32 v184, v184, v178
    v_mfma_f32_16x16x32_bf16 v[30:33], v[180:183], v[52:55], v[30:33]
    v_mul_f32 v184, 0x3acccccd, v184
    v_mov_b32 v185, 0
    v_mov_b32 v179, 0
    v_mfma_f32_32x32x16_bf16 v[112:127], a[36:39], v[52:55], v[112:127]
    ds_read_b64_tr_b16 v[52:53], v12 offset:12288
    ds_read_b64_tr_b16 v[54:55], v12 offset:13312
    ds_read_b128 a[60:63], v10 offset:4096
    s_add_u32 m0, s74, 106496
    s_add_u32 s81, s4, 82304
    buffer_load_dwordx4 v1, s[24:27], s81 offen lds
    s_waitcnt lgkmcnt(15)
    v_mfma_f32_32x32x16_bf16 v[64:79], a[40:43], v[56:59], v[64:79]
    s_waitcnt vmcnt(11)
    s_waitcnt vmcnt(7)
    s_barrier
    v_sub_f32 v138, v138, v184
    v_sub_f32 v139, v139, v184
    v_fmac_f32 v185, v138, v138
    v_fmac_f32 v179, v139, v139
    v_mfma_f32_16x16x32_bf16 v[36:39], v[180:183], v[56:59], v[36:39]
    v_sub_f32 v140, v140, v184
    v_sub_f32 v141, v141, v184
    s_waitcnt lgkmcnt(12)
    v_mfma_f32_32x32x16_bf16 v[80:95], a[44:47], v[56:59], v[80:95]
    v_add_u32 v11, 0x8000, v11
    ds_read_b64_tr_b16 v[56:57], v11 offset:0
    ds_read_b64_tr_b16 v[58:59], v11 offset:1024
    v_add_u32 v7, 0x8000, v7
    ds_read_b128 a[64:67], v7 offset:0
    v_mfma_f32_32x32x16_bf16 v[96:111], a[40:43], v[60:63], v[96:111]
    s_add_u32 m0, s74, 110592
    s_add_u32 s81, s4, 123264
    buffer_load_dwordx4 v1, s[24:27], s81 offen lds
    v_fmac_f32 v185, v140, v140
    v_fmac_f32 v179, v141, v141
    v_mfma_f32_16x16x32_bf16 v[30:33], v[180:183], v[60:63], v[30:33]
    v_sub_f32 v142, v142, v184
    v_sub_f32 v143, v143, v184
    v_mfma_f32_32x32x16_bf16 v[112:127], a[44:47], v[60:63], v[112:127]
    v_add_u32 v12, 0x8000, v12
    ds_read_b64_tr_b16 v[60:61], v12 offset:0
    ds_read_b64_tr_b16 v[62:63], v12 offset:1024
    ds_read_b128 a[68:71], v7 offset:4096
    s_cmp_ge_u32 s23, 7
    s_cselect_b32 s4, s1, s71
    s_add_u32 m0, s74, 114688
    s_add_u32 s81, s4, 737280
    buffer_load_dwordx4 v2, s[28:31], s81 offen lds
    s_waitcnt lgkmcnt(15)
    v_mfma_f32_32x32x16_bf16 v[64:79], a[48:51], v[40:43], v[64:79]
    s_add_u32 m0, s74, 118784
    s_add_u32 s81, s4, 798720
    buffer_load_dwordx4 v2, s[28:31], s81 offen lds
    v_fmac_f32 v185, v142, v142
    v_fmac_f32 v179, v143, v143
    v_mfma_f32_16x16x32_bf16 v[36:39], v[180:183], v[40:43], v[36:39]
    v_sub_f32 v144, v144, v184
    v_sub_f32 v145, v145, v184
    s_waitcnt lgkmcnt(12)
    v_mfma_f32_32x32x16_bf16 v[80:95], a[52:55], v[40:43], v[80:95]
    ds_read_b64_tr_b16 v[40:41], v11 offset:4096
    ds_read_b64_tr_b16 v[42:43], v11 offset:5120
    v_add_u32 v8, 0x8000, v8
    ds_read_b128 a[72:75], v8 offset:0
    s_add_u32 m0, s74, 122880
    s_add_u32 s81, s4, 860160
    buffer_load_dwordx4 v2, s[28:31], s81 offen lds
    v_mfma_f32_32x32x16_bf16 v[96:111], a[48:51], v[44:47], v[96:111]
    v_fmac_f32 v185, v144, v144
    v_fmac_f32 v179, v145, v145
    v_sub_f32 v146, v146, v184
    v_sub_f32 v147, v147, v184
    v_fmac_f32 v185, v146, v146
    v_fmac_f32 v179, v147, v147
    v_mfma_f32_16x16x32_bf16 v[30:33], v[180:183], v[44:47], v[30:33]
    v_sub_f32 v128, v128, v184
    v_sub_f32 v129, v129, v184
    v_mfma_f32_32x32x16_bf16 v[112:127], a[52:55], v[44:47], v[112:127]
    ds_read_b64_tr_b16 v[44:45], v12 offset:4096
    ds_read_b64_tr_b16 v[46:47], v12 offset:5120
    ds_read_b128 a[76:79], v8 offset:4096
    s_add_u32 m0, s74, 126976
    s_add_u32 s81, s4, 921600
    buffer_load_dwordx4 v2, s[28:31], s81 offen lds
    s_waitcnt lgkmcnt(15)
    v_mfma_f32_32x32x16_bf16 v[64:79], a[56:59], v[48:51], v[64:79]
    s_cmp_ge_u32 s23, 6
    s_cselect_b32 s4, s0, s70
    s_add_u32 m0, s74, 131072
    s_add_u32 s81, s4, 512
    buffer_load_dwordx4 v1, s[24:27], s81 offen lds
    v_mfma_f32_16x16x32_bf16 v[36:39], v[180:183], v[48:51], v[36:39]
    v_fmac_f32 v185, v128, v128
    v_fmac_f32 v179, v129, v129
    s_waitcnt lgkmcnt(12)
    v_mfma_f32_32x32x16_bf16 v[80:95], a[60:63], v[48:51], v[80:95]
    ds_read_b64_tr_b16 v[48:49], v11 offset:8192
    ds_read_b64_tr_b16 v[50:51], v11 offset:9216
    v_add_u32 v9, 0x8000, v9
    ds_read_b128 a[80:83], v9 offset:0
    s_add_u32 m0, s74, 135168
    s_add_u32 s81, s4, 41472
    buffer_load_dwordx4 v1, s[24:27], s81 offen lds
    v_mfma_f32_32x32x16_bf16 v[96:111], a[56:59], v[52:55], v[96:111]
    v_sub_f32 v130, v130, v184
    v_sub_f32 v131, v131, v184
    v_fmac_f32 v185, v130, v130
    v_fmac_f32 v179, v131, v131
    v_sub_f32 v132, v132, v184
    v_sub_f32 v133, v133, v184
    v_mfma_f32_16x16x32_bf16 v[30:33], v[180:183], v[52:55], v[30:33]
    v_fmac_f32 v185, v132, v132
    v_fmac_f32 v179, v133, v133
    v_mfma_f32_32x32x16_bf16 v[112:127], a[60:63], v[52:55], v[112:127]
    ds_read_b64_tr_b16 v[52:53], v12 offset:8192
    ds_read_b64_tr_b16 v[54:55], v12 offset:9216
    ds_read_b128 a[84:87], v9 offset:4096
    s_add_u32 m0, s74, 139264
    s_add_u32 s81, s4, 82432
    buffer_load_dwordx4 v1, s[24:27], s81 offen lds
    s_waitcnt lgkmcnt(15)
    v_mfma_f32_32x32x16_bf16 v[64:79], a[64:67], v[56:59], v[64:79]
    v_sub_f32 v134, v134, v184
    v_sub_f32 v135, v135, v184
    v_fmac_f32 v185, v134, v134
    v_fmac_f32 v179, v135, v135
    v_sub_f32 v136, v136, v184
    v_sub_f32 v137, v137, v184
    v_mfma_f32_16x16x32_bf16 v[36:39], v[180:183], v[56:59], v[36:39]
    v_fmac_f32 v185, v136, v136
    v_fmac_f32 v179, v137, v137
    s_waitcnt lgkmcnt(12)
    v_mfma_f32_32x32x16_bf16 v[80:95], a[68:71], v[56:59], v[80:95]
    ds_read_b64_tr_b16 v[56:57], v11 offset:12288
    ds_read_b64_tr_b16 v[58:59], v11 offset:13312
    v_add_u32 v10, 0x8000, v10
    ds_read_b128 a[88:91], v10 offset:0
    s_add_u32 m0, s74, 143360
    s_add_u32 s81, s4, 123392
    buffer_load_dwordx4 v1, s[24:27], s81 offen lds
    v_mfma_f32_32x32x16_bf16 v[96:111], a[64:67], v[60:63], v[96:111]
    s_lshl_b32 s15, s2, 2
    s_add_u32 s15, s15, s64
    v_min_u32 v26, 14, v0
    v_lshlrev_b32 v26, 7, v26
    s_mul_i32 s16, s15, 1920
    buffer_load_dword v27, v26, s[48:51], s16 offen
    v_mfma_f32_16x16x32_bf16 v[30:33], v[180:183], v[60:63], v[30:33]
    v_add_f32 v185, v185, v179
    s_nop 1
    v_add_f32_dpp v185, v185, v185 quad_perm:[1,0,3,2] row_mask:0xf bank_mask:0xf
    v_mfma_f32_32x32x16_bf16 v[112:127], a[68:71], v[60:63], v[112:127]
    ds_read_b64_tr_b16 v[60:61], v12 offset:12288
    ds_read_b64_tr_b16 v[62:63], v12 offset:13312
    ds_read_b128 a[92:95], v10 offset:4096
    v_add_f32_dpp v185, v185, v185 quad_perm:[2,3,0,1] row_mask:0xf bank_mask:0xf
    s_nop 1
    v_add_f32_dpp v185, v185, v185 row_half_mirror row_mask:0xf bank_mask:0xf
    s_nop 1
    v_add_f32_dpp v185, v185, v185 row_mirror row_mask:0xf bank_mask:0xf
    s_waitcnt lgkmcnt(15)
    v_mfma_f32_32x32x16_bf16 v[64:79], a[72:75], v[40:43], v[64:79]
    s_waitcnt vmcnt(9)
    s_waitcnt vmcnt(5)
    s_barrier
    v_min_u32 v26, 6, v0
    v_lshlrev_b32 v26, 7, v26
    s_mul_i32 s16, s15, 896
    buffer_load_dword v27, v26, s[44:47], s16 offen
    v_mfma_f32_16x16x32_bf16 v[36:39], v[180:183], v[40:43], v[36:39]
    s_waitcnt lgkmcnt(12)
    v_mfma_f32_32x32x16_bf16 v[80:95], a[76:79], v[40:43], v[80:95]
    v_add_u32 v11, 0x8000, v11
    ds_read_b64_tr_b16 v[40:41], v11 offset:0
    ds_read_b64_tr_b16 v[42:43], v11 offset:1024
    v_add_u32 v7, 0x8000, v7
    ds_read_b128 a[96:99], v7 offset:0
    v_mfma_f32_32x32x16_bf16 v[96:111], a[72:75], v[44:47], v[96:111]
    s_cmp_ge_u32 s23, 6
    s_cselect_b32 s4, s1, s71
    s_add_u32 m0, s74, 0
    s_add_u32 s81, s4, 983040
    buffer_load_dwordx4 v2, s[28:31], s81 offen lds
    v_mfma_f32_16x16x32_bf16 v[30:33], v[180:183], v[44:47], v[30:33]
    v_mfma_f32_32x32x16_bf16 v[112:127], a[76:79], v[44:47], v[112:127]
    v_add_u32 v12, 0x8000, v12
    ds_read_b64_tr_b16 v[44:45], v12 offset:0
    ds_read_b64_tr_b16 v[46:47], v12 offset:1024
    ds_read_b128 a[100:103], v7 offset:4096
    s_add_u32 m0, s74, 4096
    s_add_u32 s81, s4, 1044480
    buffer_load_dwordx4 v2, s[28:31], s81 offen lds
    s_waitcnt lgkmcnt(15)
    v_mfma_f32_32x32x16_bf16 v[64:79], a[80:83], v[48:51], v[64:79]
    s_add_u32 m0, s74, 8192
    s_add_u32 s81, s4, 1105920
    buffer_load_dwordx4 v2, s[28:31], s81 offen lds
    v_mfma_f32_16x16x32_bf16 v[36:39], v[180:183], v[48:51], v[36:39]
    s_waitcnt lgkmcnt(12)
    v_mfma_f32_32x32x16_bf16 v[80:95], a[84:87], v[48:51], v[80:95]
    ds_read_b64_tr_b16 v[48:49], v11 offset:4096
    ds_read_b64_tr_b16 v[50:51], v11 offset:5120
    v_add_u32 v8, 0x8000, v8
    ds_read_b128 a[104:107], v8 offset:0
    s_add_u32 m0, s74, 12288
    s_add_u32 s81, s4, 1167360
    buffer_load_dwordx4 v2, s[28:31], s81 offen lds
    v_mfma_f32_32x32x16_bf16 v[96:111], a[80:83], v[52:55], v[96:111]
    s_cmp_ge_u32 s23, 5
    s_cselect_b32 s4, s0, s70
    s_add_u32 m0, s74, 16384
    s_add_u32 s81, s4, 640
    buffer_load_dwordx4 v1, s[24:27], s81 offen lds
    v_mfma_f32_16x16x32_bf16 v[30:33], v[180:183], v[52:55], v[30:33]
    v_mfma_f32_32x32x16_bf16 v[112:127], a[84:87], v[52:55], v[112:127]
    ds_read_b64_tr_b16 v[52:53], v12 offset:4096
    ds_read_b64_tr_b16 v[54:55], v12 offset:5120
    ds_read_b128 a[108:111], v8 offset:4096
    s_add_u32 m0, s74, 20480
    s_add_u32 s81, s4, 41600
    buffer_load_dwordx4 v1, s[24:27], s81 offen lds
    s_waitcnt lgkmcnt(15)
    v_mfma_f32_32x32x16_bf16 v[64:79], a[88:91], v[56:59], v[64:79]
    v_mov_b32 v178, v185
    s_nop 1
    v_permlane16_swap_b32 v185, v178
    s_nop 1
    v_add_f32 v185, v185, v178
    v_mfma_f32_16x16x32_bf16 v[36:39], v[180:183], v[56:59], v[36:39]
    s_waitcnt lgkmcnt(12)
    v_mfma_f32_32x32x16_bf16 v[80:95], a[92:95], v[56:59], v[80:95]
    ds_read_b64_tr_b16 v[56:57], v11 offset:8192
    ds_read_b64_tr_b16 v[58:59], v11 offset:9216
    v_add_u32 v9, 0x8000, v9
    ds_read_b128 a[112:115], v9 offset:0
    s_add_u32 m0, s74, 24576
    s_add_u32 s81, s4, 82560
    buffer_load_dwordx4 v1, s[24:27], s81 offen lds
    v_mfma_f32_32x32x16_bf16 v[96:111], a[88:91], v[60:63], v[96:111]
    v_mul_f32 v185, 0x3acccccd, v185
    v_cvt_pk_bf16_f32 v185, v185, v185
    v_and_b32 v185, 0xffff0000, v185
    v_add_f32 v185, 0x3727c5ac, v185
    v_cvt_pk_bf16_f32 v185, v185, v185
    v_and_b32 v185, 0xffff0000, v185
    v_mfma_f32_16x16x32_bf16 v[30:33], v[180:183], v[60:63], v[30:33]
    v_mfma_f32_32x32x16_bf16 v[112:127], a[92:95], v[60:63], v[112:127]
    ds_read_b64_tr_b16 v[60:61], v12 offset:8192
    ds_read_b64_tr_b16 v[62:63], v12 offset:9216
    ds_read_b128 a[116:119], v9 offset:4096
    v_sqrt_f32 v185, v185
    s_nop 0
    v_cvt_pk_bf16_f32 v185, v185, v185
    v_and_b32 v185, 0xffff0000, v185
    s_waitcnt lgkmcnt(15)
    v_mfma_f32_32x32x16_bf16 v[64:79], a[96:99], v[40:43], v[64:79]
    s_add_u32 m0, s74, 28672
    s_add_u32 s81, s4, 123520
    buffer_load_dwordx4 v1, s[24:27], s81 offen lds
    v_mfma_f32_16x16x32_bf16 v[36:39], v[180:183], v[40:43], v[36:39]
    s_waitcnt lgkmcnt(12)
    v_mfma_f32_32x32x16_bf16 v[80:95], a[100:103], v[40:43], v[80:95]
    ds_read_b64_tr_b16 v[40:41], v11 offset:12288
    ds_read_b64_tr_b16 v[42:43], v11 offset:13312
    v_add_u32 v10, 0x8000, v10
    ds_read_b128 a[120:123], v10 offset:0
    v_mfma_f32_32x32x16_bf16 v[96:111], a[96:99], v[44:47], v[96:111]
    s_cmp_ge_u32 s23, 5
    s_cselect_b32 s4, s1, s71
    s_add_u32 m0, s74, 32768
    s_add_u32 s81, s4, 1228800
    buffer_load_dwordx4 v2, s[28:31], s81 offen lds
    v_mfma_f32_16x16x32_bf16 v[30:33], v[180:183], v[44:47], v[30:33]
    v_mfma_f32_32x32x16_bf16 v[112:127], a[100:103], v[44:47], v[112:127]
    ds_read_b64_tr_b16 v[44:45], v12 offset:12288
    ds_read_b64_tr_b16 v[46:47], v12 offset:13312
    ds_read_b128 a[124:127], v10 offset:4096
    v_rcp_f32 v185, v185
    v_cvt_pk_bf16_f32 v184, -v184, -v184
    s_waitcnt lgkmcnt(15)
    v_mfma_f32_32x32x16_bf16 v[64:79], a[104:107], v[48:51], v[64:79]
    s_waitcnt vmcnt(11)
    s_waitcnt vmcnt(5)
    s_barrier
    s_add_u32 m0, s74, 36864
    s_add_u32 s81, s4, 1290240
    buffer_load_dwordx4 v2, s[28:31], s81 offen lds
    v_mfma_f32_16x16x32_bf16 v[36:39], v[180:183], v[48:51], v[36:39]
    v_readfirstlane_b32 s101, v189
    v_readfirstlane_b32 s100, v188
    s_nop 0
    s_cmp_lg_u32 s101, 0
    s_cbranch_scc1 L_nok5
    s_mov_b32 s65, 0x80000
L_nl5:
    s_sleep 2
    buffer_load_dwordx2 v[188:189], v190, s[56:59], 0 offen sc1
    s_waitcnt vmcnt(0)
    v_readfirstlane_b32 s101, v189
    v_readfirstlane_b32 s100, v188
    s_nop 0
    s_cmp_lg_u32 s101, 0
    s_cbranch_scc1 L_nok5
    s_sub_u32 s65, s65, 1
    s_cbranch_scc0 L_nl5
L_nok5:
    s_waitcnt lgkmcnt(12)
    v_mfma_f32_32x32x16_bf16 v[80:95], a[108:111], v[48:51], v[80:95]
    v_add_u32 v11, 0xfffe4000, v11
    ds_read_b64_tr_b16 v[48:49], v11 offset:0
    ds_read_b64_tr_b16 v[50:51], v11 offset:1024
    v_add_u32 v7, 0x8000, v7
    ds_read_b128 a[128:131], v7 offset:0
    v_mfma_f32_32x32x16_bf16 v[96:111], a[104:107], v[52:55], v[96:111]
    s_add_u32 m0, s74, 40960
    s_add_u32 s81, s4, 1351680
    buffer_load_dwordx4 v2, s[28:31], s81 offen lds
    v_mfma_f32_16x16x32_bf16 v[30:33], v[180:183], v[52:55], v[30:33]
    v_mfma_f32_32x32x16_bf16 v[112:127], a[108:111], v[52:55], v[112:127]
    v_add_u32 v12, 0xfffe4000, v12
    ds_read_b64_tr_b16 v[52:53], v12 offset:0
    ds_read_b64_tr_b16 v[54:55], v12 offset:1024
    ds_read_b128 a[132:135], v7 offset:4096
    s_add_u32 m0, s74, 45056
    s_add_u32 s81, s4, 1413120
    buffer_load_dwordx4 v2, s[28:31], s81 offen lds
    s_waitcnt lgkmcnt(15)
    v_mfma_f32_32x32x16_bf16 v[64:79], a[112:115], v[56:59], v[64:79]
    s_cmp_ge_u32 s23, 4
    s_cselect_b32 s4, s0, s70
    s_add_u32 m0, s74, 49152
    s_add_u32 s81, s4, 768
    buffer_load_dwordx4 v1, s[24:27], s81 offen lds
    v_mfma_f32_16x16x32_bf16 v[36:39], v[180:183], v[56:59], v[36:39]
    s_waitcnt lgkmcnt(12)
    v_mfma_f32_32x32x16_bf16 v[80:95], a[116:119], v[56:59], v[80:95]
    ds_read_b64_tr_b16 v[56:57], v11 offset:4096
    ds_read_b64_tr_b16 v[58:59], v11 offset:5120
    v_add_u32 v8, 0x8000, v8
    ds_read_b128 a[136:139], v8 offset:0
    s_add_u32 m0, s74, 53248
    s_add_u32 s81, s4, 41728
    buffer_load_dwordx4 v1, s[24:27], s81 offen lds
    v_mfma_f32_32x32x16_bf16 v[96:111], a[112:115], v[60:63], v[96:111]
    s_add_u32 m0, s74, 57344
    s_add_u32 s81, s4, 82688
    buffer_load_dwordx4 v1, s[24:27], s81 offen lds
    v_mfma_f32_16x16x32_bf16 v[30:33], v[180:183], v[60:63], v[30:33]
    v_mfma_f32_32x32x16_bf16 v[112:127], a[116:119], v[60:63], v[112:127]
    ds_read_b64_tr_b16 v[60:61], v12 offset:4096
    ds_read_b64_tr_b16 v[62:63], v12 offset:5120
    ds_read_b128 a[140:143], v8 offset:4096
    v_lshlrev_b32 v151, 4, v148
    v_lshl_add_u32 v151, v149, 25, v151
    s_lshl_b32 s9, s8, 4
    v_mov_b32 v186, s100
    v_mov_b32 v187, s101
    s_waitcnt lgkmcnt(15)
    v_mfma_f32_32x32x16_bf16 v[64:79], a[120:123], v[40:43], v[64:79]
    s_add_u32 m0, s74, 61440
    s_add_u32 s81, s4, 123648
    buffer_load_dwordx4 v1, s[24:27], s81 offen lds
    v_mfma_f32_16x16x32_bf16 v[36:39], v[180:183], v[40:43], v[36:39]
    s_waitcnt lgkmcnt(12)
    v_mfma_f32_32x32x16_bf16 v[80:95], a[124:127], v[40:43], v[80:95]
    ds_read_b64_tr_b16 v[40:41], v11 offset:8192
    ds_read_b64_tr_b16 v[42:43], v11 offset:9216
    v_add_u32 v9, 0x8000, v9
    ds_read_b128 a[144:147], v9 offset:0
    buffer_store_dwordx4 v[184:187], v151, s[40:43], s9 offen sc1
    v_mfma_f32_32x32x16_bf16 v[96:111], a[120:123], v[44:47], v[96:111]
    s_cmp_ge_u32 s23, 4
    s_cselect_b32 s4, s1, s71
    s_add_u32 m0, s74, 65536
    s_add_u32 s81, s4, 1474560
    buffer_load_dwordx4 v2, s[28:31], s81 offen lds
    v_mfma_f32_16x16x32_bf16 v[30:33], v[180:183], v[44:47], v[30:33]
    v_mfma_f32_32x32x16_bf16 v[112:127], a[124:127], v[44:47], v[112:127]
    ds_read_b64_tr_b16 v[44:45], v12 offset:8192
    ds_read_b64_tr_b16 v[46:47], v12 offset:9216
    ds_read_b128 a[148:151], v9 offset:4096
    s_waitcnt lgkmcnt(15)
    v_mfma_f32_32x32x16_bf16 v[64:79], a[128:131], v[48:51], v[64:79]
    s_add_u32 m0, s74, 69632
    s_add_u32 s81, s4, 1536000
    buffer_load_dwordx4 v2, s[28:31], s81 offen lds
    v_lshlrev_b32 v168, 16, v152
    v_mfma_f32_16x16x32_bf16 v[36:39], v[180:183], v[48:51], v[36:39]
    v_and_b32 v169, 0xffff0000, v152
    v_lshlrev_b32 v170, 16, v153
    s_waitcnt lgkmcnt(12)
    v_mfma_f32_32x32x16_bf16 v[80:95], a[132:135], v[48:51], v[80:95]
    ds_read_b64_tr_b16 v[48:49], v11 offset:12288
    ds_read_b64_tr_b16 v[50:51], v11 offset:13312
    v_add_u32 v10, 0x8000, v10
    ds_read_b128 a[152:155], v10 offset:0
    v_and_b32 v171, 0xffff0000, v153
    v_lshlrev_b32 v172, 16, v154
    v_mfma_f32_32x32x16_bf16 v[96:111], a[128:131], v[52:55], v[96:111]
    s_add_u32 m0, s74, 73728
    s_add_u32 s81, s4, 1597440
    buffer_load_dwordx4 v2, s[28:31], s81 offen lds
    v_and_b32 v173, 0xffff0000, v154
    v_lshlrev_b32 v174, 16, v155
    v_mfma_f32_16x16x32_bf16 v[30:33], v[180:183], v[52:55], v[30:33]
    v_and_b32 v175, 0xffff0000, v155
    v_lshlrev_b32 v178, 16, v156
    v_mfma_f32_32x32x16_bf16 v[112:127], a[132:135], v[52:55], v[112:127]
    ds_read_b64_tr_b16 v[52:53], v12 offset:12288
    ds_read_b64_tr_b16 v[54:55], v12 offset:13312
    ds_read_b128 a[156:159], v10 offset:4096
    v_and_b32 v156, 0xffff0000, v156
    v_add_f32 v168, v168, v178
    v_add_f32 v169, v169, v156
    s_waitcnt lgkmcnt(15)
    v_mfma_f32_32x32x16_bf16 v[64:79], a[136:139], v[56:59], v[64:79]
    s_waitcnt vmcnt(12)
    s_waitcnt vmcnt(8)
    s_barrier
    s_add_u32 m0, s74, 77824
    s_add_u32 s81, s4, 1658880
    buffer_load_dwordx4 v2, s[28:31], s81 offen lds
    v_mfma_f32_16x16x32_bf16 v[36:39], v[180:183], v[56:59], v[36:39]
    v_lshlrev_b32 v179, 16, v157
    v_and_b32 v157, 0xffff0000, v157
    s_waitcnt lgkmcnt(12)
    v_mfma_f32_32x32x16_bf16 v[80:95], a[140:143], v[56:59], v[80:95]
    v_add_u32 v11, 0x8000, v11
    ds_read_b64_tr_b16 v[56:57], v11 offset:0
    ds_read_b64_tr_b16 v[58:59], v11 offset:1024
    v_add_u32 v7, 0xfffe4000, v7
    ds_read_b128 a[160:163], v7 offset:0
    v_add_f32 v170, v170, v179
    v_mfma_f32_32x32x16_bf16 v[96:111], a[136:139], v[60:63], v[96:111]
    s_cmp_ge_u32 s23, 3
    s_cselect_b32 s4, s0, s70
    s_add_u32 m0, s74, 81920
    s_add_u32 s81, s4, 896
    buffer_load_dwordx4 v1, s[24:27], s81 offen lds
    v_mfma_f32_16x16x32_bf16 v[30:33], v[180:183], v[60:63], v[30:33]
    v_add_f32 v171, v171, v157
    v_lshlrev_b32 v178, 16, v158
    v_mfma_f32_32x32x16_bf16 v[112:127], a[140:143], v[60:63], v[112:127]
    v_add_u32 v12, 0x8000, v12
    ds_read_b64_tr_b16 v[60:61], v12 offset:0
    ds_read_b64_tr_b16 v[62:63], v12 offset:1024
    ds_read_b128 a[164:167], v7 offset:4096
    s_add_u32 m0, s74, 86016
    s_add_u32 s81, s4, 41856
    buffer_load_dwordx4 v1, s[24:27], s81 offen lds
    s_waitcnt lgkmcnt(15)
    v_mfma_f32_32x32x16_bf16 v[64:79], a[144:147], v[40:43], v[64:79]
    s_add_u32 m0, s74, 90112
    s_add_u32 s81, s4, 82816
    buffer_load_dwordx4 v1, s[24:27], s81 offen lds
    v_and_b32 v158, 0xffff0000, v158
    v_add_f32 v172, v172, v178
    v_mfma_f32_16x16x32_bf16 v[36:39], v[180:183], v[40:43], v[36:39]
    v_add_f32 v173, v173, v158
    v_lshlrev_b32 v179, 16, v159
    s_waitcnt lgkmcnt(12)
    v_mfma_f32_32x32x16_bf16 v[80:95], a[148:151], v[40:43], v[80:95]
    ds_read_b64_tr_b16 v[40:41], v11 offset:4096
    ds_read_b64_tr_b16 v[42:43], v11 offset:5120
    v_add_u32 v8, 0xfffe4000, v8
    ds_read_b128 a[168:171], v8 offset:0
    v_and_b32 v159, 0xffff0000, v159
    v_add_f32 v174, v174, v179
    v_mfma_f32_32x32x16_bf16 v[96:111], a[144:147], v[44:47], v[96:111]
    s_add_u32 m0, s74, 94208
    s_add_u32 s81, s4, 123776
    buffer_load_dwordx4 v1, s[24:27], s81 offen lds
    v_add_f32 v175, v175, v159
    v_lshlrev_b32 v178, 16, v160
    v_mfma_f32_16x16x32_bf16 v[30:33], v[180:183], v[44:47], v[30:33]
    v_and_b32 v160, 0xffff0000, v160
    v_add_f32 v168, v168, v178
    v_mfma_f32_32x32x16_bf16 v[112:127], a[148:151], v[44:47], v[112:127]
    ds_read_b64_tr_b16 v[44:45], v12 offset:4096
    ds_read_b64_tr_b16 v[46:47], v12 offset:5120
    ds_read_b128 a[172:175], v8 offset:4096
    v_add_f32 v169, v169, v160
    v_lshlrev_b32 v179, 16, v161
    v_and_b32 v161, 0xffff0000, v161
    s_waitcnt lgkmcnt(15)
    v_mfma_f32_32x32x16_bf16 v[64:79], a[152:155], v[48:51], v[64:79]
    s_cmp_ge_u32 s23, 3
    s_cselect_b32 s4, s1, s71
    s_add_u32 m0, s74, 98304
    s_add_u32 s81, s4, 1720320
    buffer_load_dwordx4 v2, s[28:31], s81 offen lds
    v_mfma_f32_16x16x32_bf16 v[36:39], v[180:183], v[48:51], v[36:39]
    v_add_f32 v170, v170, v179
    v_add_f32 v171, v171, v161
    s_waitcnt lgkmcnt(12)
    v_mfma_f32_32x32x16_bf16 v[80:95], a[156:159], v[48:51], v[80:95]
    ds_read_b64_tr_b16 v[48:49], v11 offset:8192
    ds_read_b64_tr_b16 v[50:51], v11 offset:9216
    v_add_u32 v9, 0xfffe4000, v9
    ds_read_b128 a[176:179], v9 offset:0
    v_lshlrev_b32 v178, 16, v162
    v_and_b32 v162, 0xffff0000, v162
    v_mfma_f32_32x32x16_bf16 v[96:111], a[152:155], v[52:55], v[96:111]
    s_add_u32 m0, s74, 102400
    s_add_u32 s81, s4, 1781760
    buffer_load_dwordx4 v2, s[28:31], s81 offen lds
    v_add_f32 v172, v172, v178
    v_add_f32 v173, v173, v162
    v_mfma_f32_16x16x32_bf16 v[30:33], v[180:183], v[52:55], v[30:33]
    v_lshlrev_b32 v179, 16, v163
    v_and_b32 v163, 0xffff0000, v163
    v_mfma_f32_32x32x16_bf16 v[112:127], a[156:159], v[52:55], v[112:127]
    ds_read_b64_tr_b16 v[52:53], v12 offset:8192
    ds_read_b64_tr_b16 v[54:55], v12 offset:9216
    ds_read_b128 a[180:183], v9 offset:4096
    v_add_f32 v174, v174, v179
    v_add_f32 v175, v175, v163
    v_lshlrev_b32 v178, 16, v164
    s_waitcnt lgkmcnt(15)
    v_mfma_f32_32x32x16_bf16 v[64:79], a[160:163], v[56:59], v[64:79]
    s_add_u32 m0, s74, 106496
    s_add_u32 s81, s4, 1843200
    buffer_load_dwordx4 v2, s[28:31], s81 offen lds
    v_and_b32 v164, 0xffff0000, v164
    v_add_f32 v168, v168, v178
    v_mfma_f32_16x16x32_bf16 v[36:39], v[180:183], v[56:59], v[36:39]
    v_add_f32 v169, v169, v164
    v_lshlrev_b32 v179, 16, v165
    s_waitcnt lgkmcnt(12)
    v_mfma_f32_32x32x16_bf16 v[80:95], a[164:167], v[56:59], v[80:95]
    ds_read_b64_tr_b16 v[56:57], v11 offset:12288
    ds_read_b64_tr_b16 v[58:59], v11 offset:13312
    v_add_u32 v10, 0xfffe4000, v10
    ds_read_b128 a[184:187], v10 offset:0
    v_and_b32 v165, 0xffff0000, v165
    v_add_f32 v170, v170, v179
    v_mfma_f32_32x32x16_bf16 v[96:111], a[160:163], v[60:63], v[96:111]
    s_add_u32 m0, s74, 110592
    s_add_u32 s81, s4, 1904640
    buffer_load_dwordx4 v2, s[28:31], s81 offen lds
    v_add_f32 v171, v171, v165
    v_lshlrev_b32 v178, 16, v166
    v_mfma_f32_16x16x32_bf16 v[30:33], v[180:183], v[60:63], v[30:33]
    v_and_b32 v166, 0xffff0000, v166
    v_add_f32 v172, v172, v178
    v_mfma_f32_32x32x16_bf16 v[112:127], a[164:167], v[60:63], v[112:127]
    ds_read_b64_tr_b16 v[60:61], v12 offset:12288
    ds_read_b64_tr_b16 v[62:63], v12 offset:13312
    ds_read_b128 a[188:191], v10 offset:4096
    v_add_f32 v173, v173, v166
    v_lshlrev_b32 v179, 16, v167
    v_and_b32 v167, 0xffff0000, v167
    s_waitcnt lgkmcnt(15)
    v_mfma_f32_32x32x16_bf16 v[64:79], a[168:171], v[40:43], v[64:79]
    s_waitcnt vmcnt(13)
    s_waitcnt vmcnt(8)
    s_barrier
    s_cmp_ge_u32 s23, 2
    s_cselect_b32 s4, s0, s70
    s_add_u32 m0, s74, 114688
    s_add_u32 s81, s4, 1024
    buffer_load_dwordx4 v1, s[24:27], s81 offen lds
    v_mfma_f32_16x16x32_bf16 v[36:39], v[180:183], v[40:43], v[36:39]
    v_add_f32 v174, v174, v179
    v_add_f32 v175, v175, v167
    s_waitcnt lgkmcnt(12)
    v_mfma_f32_32x32x16_bf16 v[80:95], a[172:175], v[40:43], v[80:95]
    v_add_u32 v11, 0x8000, v11
    ds_read_b64_tr_b16 v[40:41], v11 offset:0
    ds_read_b64_tr_b16 v[42:43], v11 offset:1024
    v_add_u32 v7, 0x8000, v7
    ds_read_b128 a[192:195], v7 offset:0
    v_add_f32_dpp v168, v168, v168 row_ror:8 row_mask:0xf bank_mask:0xf
    v_mfma_f32_32x32x16_bf16 v[96:111], a[168:171], v[44:47], v[96:111]
    s_add_u32 m0, s74, 118784
    s_add_u32 s81, s4, 41984
    buffer_load_dwordx4 v1, s[24:27], s81 offen lds
    v_add_f32_dpp v169, v169, v169 row_ror:8 row_mask:0xf bank_mask:0xf
    v_add_f32_dpp v170, v170, v170 row_ror:8 row_mask:0xf bank_mask:0xf
    v_mfma_f32_16x16x32_bf16 v[30:33], v[180:183], v[44:47], v[30:33]
    v_add_f32_dpp v171, v171, v171 row_ror:8 row_mask:0xf bank_mask:0xf
    v_add_f32_dpp v172, v172, v172 row_ror:8 row_mask:0xf bank_mask:0xf
    v_mfma_f32_32x32x16_bf16 v[112:127], a[172:175], v[44:47], v[112:127]
    v_add_u32 v12, 0x8000, v12
    ds_read_b64_tr_b16 v[44:45], v12 offset:0
    ds_read_b64_tr_b16 v[46:47], v12 offset:1024
    ds_read_b128 a[196:199], v7 offset:4096
    s_add_u32 m0, s74, 122880
    s_add_u32 s81, s4, 82944
    buffer_load_dwordx4 v1, s[24:27], s81 offen lds
    s_waitcnt lgkmcnt(15)
    v_mfma_f32_32x32x16_bf16 v[64:79], a[176:179], v[48:51], v[64:79]
    s_add_u32 m0, s74, 126976
    s_add_u32 s81, s4, 123904
    buffer_load_dwordx4 v1, s[24:27], s81 offen lds
    v_add_f32_dpp v173, v173, v173 row_ror:8 row_mask:0xf bank_mask:0xf
    v_add_f32_dpp v174, v174, v174 row_ror:8 row_mask:0xf bank_mask:0xf
    v_mfma_f32_16x16x32_bf16 v[36:39], v[180:183], v[48:51], v[36:39]
    v_add_f32_dpp v175, v175, v175 row_ror:8 row_mask:0xf bank_mask:0xf
    s_lshl_b32 s15, s64, 10
    s_waitcnt lgkmcnt(12)
    v_mfma_f32_32x32x16_bf16 v[80:95], a[180:183], v[48:51], v[80:95]
    ds_read_b64_tr_b16 v[48:49], v11 offset:4096
    ds_read_b64_tr_b16 v[50:51], v11 offset:5120
    v_add_u32 v8, 0x8000, v8
    ds_read_b128 a[200:203], v8 offset:0
    s_add_u32 s15, s15, 147456
    v_lshrrev_b32 v176, 4, v0
    v_mfma_f32_32x32x16_bf16 v[96:111], a[176:179], v[52:55], v[96:111]
    s_cmp_ge_u32 s23, 2
    s_cselect_b32 s4, s1, s71
    s_add_u32 m0, s74, 131072
    s_add_u32 s81, s4, 1966080
    buffer_load_dwordx4 v2, s[28:31], s81 offen lds
    v_mfma_f32_16x16x32_bf16 v[30:33], v[180:183], v[52:55], v[30:33]
    v_and_b32 v177, 7, v0
    v_lshlrev_b32 v176, 8, v176
    v_mfma_f32_32x32x16_bf16 v[112:127], a[180:183], v[52:55], v[112:127]
    ds_read_b64_tr_b16 v[52:53], v12 offset:4096
    ds_read_b64_tr_b16 v[54:55], v12 offset:5120
    ds_read_b128 a[204:207], v8 offset:4096
    v_lshl_add_u32 v176, v177, 5, v176
    v_add_u32 v176, s15, v176
    ds_write_b128 v176, v[168:171]
    s_waitcnt lgkmcnt(15)
    v_mfma_f32_32x32x16_bf16 v[64:79], a[184:187], v[56:59], v[64:79]
    s_add_u32 m0, s74, 135168
    s_add_u32 s81, s4, 2027520
    buffer_load_dwordx4 v2, s[28:31], s81 offen lds
    ds_write_b128 v176, v[172:175] offset:16
    v_mfma_f32_16x16x32_bf16 v[36:39], v[180:183], v[56:59], v[36:39]
    s_waitcnt lgkmcnt(14)
    v_mfma_f32_32x32x16_bf16 v[80:95], a[188:191], v[56:59], v[80:95]
    ds_read_b64_tr_b16 v[56:57], v11 offset:8192
    ds_read_b64_tr_b16 v[58:59], v11 offset:9216
    v_add_u32 v9, 0x8000, v9
    ds_read_b128 a[208:211], v9 offset:0
    v_mfma_f32_32x32x16_bf16 v[96:111], a[184:187], v[60:63], v[96:111]
    s_add_u32 m0, s74, 139264
    s_add_u32 s81, s4, 2088960
    buffer_load_dwordx4 v2, s[28:31], s81 offen lds
    v_mfma_f32_16x16x32_bf16 v[30:33], v[180:183], v[60:63], v[30:33]
    v_mfma_f32_32x32x16_bf16 v[112:127], a[188:191], v[60:63], v[112:127]
    ds_read_b64_tr_b16 v[60:61], v12 offset:8192
    ds_read_b64_tr_b16 v[62:63], v12 offset:9216
    ds_read_b128 a[212:215], v9 offset:4096
    s_waitcnt lgkmcnt(15)
    v_mfma_f32_32x32x16_bf16 v[64:79], a[192:195], v[40:43], v[64:79]
    s_add_u32 m0, s74, 143360
    s_add_u32 s81, s4, 2150400
    buffer_load_dwordx4 v2, s[28:31], s81 offen lds
    v_mfma_f32_16x16x32_bf16 v[36:39], v[180:183], v[40:43], v[36:39]
    s_waitcnt lgkmcnt(14)
    v_mfma_f32_32x32x16_bf16 v[80:95], a[196:199], v[40:43], v[80:95]
    ds_read_b64_tr_b16 v[40:41], v11 offset:12288
    ds_read_b64_tr_b16 v[42:43], v11 offset:13312
    v_add_u32 v10, 0x8000, v10
    ds_read_b128 a[216:219], v10 offset:0
    v_mfma_f32_32x32x16_bf16 v[96:111], a[192:195], v[44:47], v[96:111]
    s_cmp_ge_u32 s23, 1
    s_cselect_b32 s4, s0, s70
    s_add_u32 m0, s74, 0
    s_add_u32 s81, s4, 1152
    buffer_load_dwordx4 v1, s[24:27], s81 offen lds
    v_mfma_f32_16x16x32_bf16 v[30:33], v[180:183], v[44:47], v[30:33]
    v_mfma_f32_32x32x16_bf16 v[112:127], a[196:199], v[44:47], v[112:127]
    ds_read_b64_tr_b16 v[44:45], v12 offset:12288
    ds_read_b64_tr_b16 v[46:47], v12 offset:13312
    ds_read_b128 a[220:223], v10 offset:4096
    s_waitcnt lgkmcnt(15)
    v_mfma_f32_32x32x16_bf16 v[64:79], a[200:203], v[48:51], v[64:79]
    s_waitcnt vmcnt(13)
    s_waitcnt vmcnt(9)
    s_waitcnt lgkmcnt(12)
    s_barrier
    s_add_u32 m0, s74, 4096
    s_add_u32 s81, s4, 42112
    buffer_load_dwordx4 v1, s[24:27], s81 offen lds
    v_mfma_f32_16x16x32_bf16 v[36:39], v[180:183], v[48:51], v[36:39]
    v_lshlrev_b32 v176, 2, v0
    v_add_u32 v177, 147456, v176
    v_mfma_f32_32x32x16_bf16 v[80:95], a[204:207], v[48:51], v[80:95]
    v_add_u32 v11, 0x8000, v11
    ds_read_b64_tr_b16 v[48:49], v11 offset:0
    ds_read_b64_tr_b16 v[50:51], v11 offset:1024
    v_add_u32 v7, 0x8000, v7
    ds_read_b128 a[224:227], v7 offset:0
    ds_read_b32 v128, v177 offset:0
    v_mfma_f32_32x32x16_bf16 v[96:111], a[200:203], v[52:55], v[96:111]
    s_add_u32 m0, s74, 8192
    s_add_u32 s81, s4, 83072
    buffer_load_dwordx4 v1, s[24:27], s81 offen lds
    ds_read_b32 v129, v177 offset:256
    ds_read_b32 v130, v177 offset:512
    v_mfma_f32_16x16x32_bf16 v[30:33], v[180:183], v[52:55], v[30:33]
    ds_read_b32 v131, v177 offset:768
    ds_read_b32 v132, v177 offset:1024
    v_mfma_f32_32x32x16_bf16 v[112:127], a[204:207], v[52:55], v[112:127]
    v_add_u32 v12, 0x8000, v12
    ds_read_b64_tr_b16 v[52:53], v12 offset:0
    ds_read_b64_tr_b16 v[54:55], v12 offset:1024
    ds_read_b128 a[228:231], v7 offset:4096
    ds_read_b32 v133, v177 offset:1280
    ds_read_b32 v134, v177 offset:1536
    s_waitcnt lgkmcnt(15)
    v_mfma_f32_32x32x16_bf16 v[64:79], a[208:211], v[56:59], v[64:79]
    s_add_u32 m0, s74, 12288
    s_add_u32 s81, s4, 124032
    buffer_load_dwordx4 v1, s[24:27], s81 offen lds
    ds_read_b32 v135, v177 offset:1792
    ds_read_b32 v136, v177 offset:2048
    v_mfma_f32_16x16x32_bf16 v[36:39], v[180:183], v[56:59], v[36:39]
    ds_read_b32 v137, v177 offset:2304
    ds_read_b32 v138, v177 offset:2560
    v_mfma_f32_32x32x16_bf16 v[80:95], a[212:215], v[56:59], v[80:95]
    ds_read_b64_tr_b16 v[56:57], v11 offset:4096
    ds_read_b64_tr_b16 v[58:59], v11 offset:5120
    v_add_u32 v8, 0x8000, v8
    ds_read_b128 a[232:235], v8 offset:0
    ds_read_b32 v139, v177 offset:2816
    ds_read_b32 v140, v177 offset:3072
    v_mfma_f32_32x32x16_bf16 v[96:111], a[208:211], v[60:63], v[96:111]
    s_cmp_ge_u32 s23, 1
    s_cselect_b32 s4, s1, s71
    s_add_u32 m0, s74, 16384
    s_add_u32 s81, s4, 2211840
    buffer_load_dwordx4 v2, s[28:31], s81 offen lds
    v_mfma_f32_16x16x32_bf16 v[30:33], v[180:183], v[60:63], v[30:33]
    ds_read_b32 v141, v177 offset:3328
    ds_read_b32 v142, v177 offset:3584
    v_mfma_f32_32x32x16_bf16 v[112:127], a[212:215], v[60:63], v[112:127]
    ds_read_b64_tr_b16 v[60:61], v12 offset:4096
    ds_read_b64_tr_b16 v[62:63], v12 offset:5120
    ds_read_b128 a[236:239], v8 offset:4096
    ds_read_b32 v143, v177 offset:3840
    s_mul_i32 s14, s10, 24576
    s_lshl_b32 s15, s11, 9
    v_mfma_f32_32x32x16_bf16 v[64:79], a[216:219], v[40:43], v[64:79]
    s_add_u32 m0, s74, 20480
    s_add_u32 s81, s4, 2273280
    buffer_load_dwordx4 v2, s[28:31], s81 offen lds
    s_add_u32 s14, s14, s15
    s_add_u32 s14, s14, 131072
    v_mfma_f32_16x16x32_bf16 v[36:39], v[180:183], v[40:43], v[36:39]
    s_lshl_b32 s15, s64, 25
    s_add_u32 s14, s14, s15
    s_waitcnt lgkmcnt(15)
    v_mfma_f32_32x32x16_bf16 v[80:95], a[220:223], v[40:43], v[80:95]
    ds_read_b64_tr_b16 v[40:41], v11 offset:8192
    ds_read_b64_tr_b16 v[42:43], v11 offset:9216
    v_add_u32 v9, 0x8000, v9
    ds_read_b128 a[240:243], v9 offset:0
    v_lshlrev_b32 v176, 1, v176
    s_waitcnt lgkmcnt(15)
    v_add_f32 v128, v128, v136
    v_mfma_f32_32x32x16_bf16 v[96:111], a[216:219], v[44:47], v[96:111]
    s_add_u32 m0, s74, 24576
    s_add_u32 s81, s4, 2334720
    buffer_load_dwordx4 v2, s[28:31], s81 offen lds
    v_add_f32 v129, v129, v137
    v_mfma_f32_16x16x32_bf16 v[30:33], v[180:183], v[44:47], v[30:33]
    s_waitcnt lgkmcnt(14)
    v_add_f32 v130, v130, v138
    s_waitcnt lgkmcnt(10)
    v_add_f32 v131, v131, v139
    v_mfma_f32_32x32x16_bf16 v[112:127], a[220:223], v[44:47], v[112:127]
    ds_read_b64_tr_b16 v[44:45], v12 offset:8192
    ds_read_b64_tr_b16 v[46:47], v12 offset:9216
    ds_read_b128 a[244:247], v9 offset:4096
    s_waitcnt lgkmcnt(12)
    v_add_f32 v132, v132, v140
    s_waitcnt lgkmcnt(11)
    v_add_f32 v133, v133, v141
    v_mfma_f32_32x32x16_bf16 v[64:79], a[224:227], v[48:51], v[64:79]
    s_add_u32 m0, s74, 28672
    s_add_u32 s81, s4, 2396160
    buffer_load_dwordx4 v2, s[28:31], s81 offen lds
    s_waitcnt lgkmcnt(10)
    v_add_f32 v134, v134, v142
    v_mfma_f32_16x16x32_bf16 v[36:39], v[180:183], v[48:51], v[36:39]
    s_waitcnt lgkmcnt(6)
    v_add_f32 v135, v135, v143
    v_add_f32 v128, v128, v132
    v_mfma_f32_32x32x16_bf16 v[80:95], a[228:231], v[48:51], v[80:95]
    ds_read_b64_tr_b16 v[48:49], v11 offset:12288
    ds_read_b64_tr_b16 v[50:51], v11 offset:13312
    v_add_u32 v10, 0x8000, v10
    ds_read_b128 a[248:251], v10 offset:0
    v_add_f32 v129, v129, v133
    v_add_f32 v130, v130, v134
    v_mfma_f32_32x32x16_bf16 v[96:111], a[224:227], v[52:55], v[96:111]
    s_mov_b32 s4, s72
    s_add_u32 m0, s74, 32768
    s_add_u32 s81, s4, 0
    buffer_load_dwordx4 v3, s[32:35], s81 offen lds
    v_add_f32 v131, v131, v135
    v_mfma_f32_16x16x32_bf16 v[30:33], v[180:183], v[52:55], v[30:33]
    v_add_f32 v128, v128, v130
    v_add_f32 v129, v129, v131
    v_mfma_f32_32x32x16_bf16 v[112:127], a[228:231], v[52:55], v[112:127]
    ds_read_b64_tr_b16 v[52:53], v12 offset:12288
    ds_read_b64_tr_b16 v[54:55], v12 offset:13312
    ds_read_b128 a[252:255], v10 offset:4096
    v_add_f32 v128, v128, v129
    v_mov_b32 v129, s100
    v_mfma_f32_32x32x16_bf16 v[64:79], a[232:235], v[56:59], v[64:79]
    s_waitcnt vmcnt(13)
    s_waitcnt vmcnt(9)
    s_barrier
    s_add_u32 m0, s74, 36864
    s_add_u32 s81, s4, 98304
    buffer_load_dwordx4 v3, s[32:35], s81 offen lds
    v_mfma_f32_16x16x32_bf16 v[36:39], v[180:183], v[56:59], v[36:39]
    buffer_store_dwordx2 v[128:129], v176, s[40:43], s14 offen sc1
    v_mfma_f32_32x32x16_bf16 v[80:95], a[236:239], v[56:59], v[80:95]
    v_add_u32 v11, 0x8000, v11
    ds_read_b64_tr_b16 v[56:57], v11 offset:0
    ds_read_b64_tr_b16 v[58:59], v11 offset:1024
    v_add_u32 v7, 0x8000, v7
    ds_read_b128 v[192:195], v7 offset:0
    v_mfma_f32_32x32x16_bf16 v[96:111], a[232:235], v[60:63], v[96:111]
    s_add_u32 m0, s74, 40960
    s_add_u32 s81, s4, 0
    buffer_load_dwordx4 v4, s[36:39], s81 offen lds
    v_mfma_f32_16x16x32_bf16 v[30:33], v[180:183], v[60:63], v[30:33]
    v_mfma_f32_32x32x16_bf16 v[112:127], a[236:239], v[60:63], v[112:127]
    v_add_u32 v12, 0x8000, v12
    ds_read_b64_tr_b16 v[60:61], v12 offset:0
    ds_read_b64_tr_b16 v[62:63], v12 offset:1024
    ds_read_b128 v[196:199], v7 offset:4096
    s_waitcnt lgkmcnt(15)
    v_mfma_f32_32x32x16_bf16 v[64:79], a[240:243], v[40:43], v[64:79]
    s_add_u32 m0, s74, 45056
    s_add_u32 s81, s4, 98304
    buffer_load_dwordx4 v4, s[36:39], s81 offen lds
    v_and_b32 v161, 31, v0
    v_lshlrev_b32 v161, 4, v161
    v_mfma_f32_16x16x32_bf16 v[36:39], v[180:183], v[40:43], v[36:39]
    s_lshl_b32 s76, s80, 4
    buffer_load_dwordx4 v[152:155], v161, s[40:43], s76 offen offset:0
    s_waitcnt lgkmcnt(12)
    v_mfma_f32_32x32x16_bf16 v[80:95], a[244:247], v[40:43], v[80:95]
    ds_read_b64_tr_b16 v[40:41], v11 offset:4096
    ds_read_b64_tr_b16 v[42:43], v11 offset:5120
    v_add_u32 v8, 0x8000, v8
    ds_read_b128 v[200:203], v8 offset:0
    buffer_load_dwordx4 v[156:159], v161, s[40:43], s76 offen offset:512
    v_mfma_f32_32x32x16_bf16 v[96:111], a[240:243], v[44:47], v[96:111]
    v_mfma_f32_16x16x32_bf16 v[30:33], v[180:183], v[44:47], v[30:33]
    v_mfma_f32_32x32x16_bf16 v[112:127], a[244:247], v[44:47], v[112:127]
    ds_read_b64_tr_b16 v[44:45], v12 offset:4096
    ds_read_b64_tr_b16 v[46:47], v12 offset:5120
    ds_read_b128 v[204:207], v8 offset:4096
    s_waitcnt lgkmcnt(15)
    v_mfma_f32_32x32x16_bf16 v[64:79], a[248:251], v[48:51], v[64:79]
    s_cmp_ge_u32 s23, 9
    s_cselect_b32 s4, s21, s72
    s_add_u32 m0, s74, 49152
    s_add_u32 s81, s4, 196608
    buffer_load_dwordx4 v3, s[32:35], s81 offen lds
    v_mfma_f32_16x16x32_bf16 v[36:39], v[180:183], v[48:51], v[36:39]
    s_waitcnt lgkmcnt(12)
    v_mfma_f32_32x32x16_bf16 v[80:95], a[252:255], v[48:51], v[80:95]
    ds_read_b64_tr_b16 v[48:49], v11 offset:8192
    ds_read_b64_tr_b16 v[50:51], v11 offset:9216
    v_add_u32 v9, 0x8000, v9
    ds_read_b128 v[208:211], v9 offset:0
    v_mfma_f32_32x32x16_bf16 v[96:111], a[248:251], v[52:55], v[96:111]
    s_add_u32 m0, s74, 53248
    s_add_u32 s81, s4, 294912
    buffer_load_dwordx4 v3, s[32:35], s81 offen lds
    v_mfma_f32_16x16x32_bf16 v[30:33], v[180:183], v[52:55], v[30:33]
    v_mfma_f32_32x32x16_bf16 v[112:127], a[252:255], v[52:55], v[112:127]
    ds_read_b64_tr_b16 v[52:53], v12 offset:8192
    ds_read_b64_tr_b16 v[54:55], v12 offset:9216
    ds_read_b128 v[212:215], v9 offset:4096
    s_waitcnt lgkmcnt(15)
    v_mfma_f32_32x32x16_bf16 v[64:79], v[192:195], v[56:59], v[64:79]
    s_add_u32 m0, s74, 57344
    s_add_u32 s81, s4, 196608
    buffer_load_dwordx4 v4, s[36:39], s81 offen lds
    v_mfma_f32_16x16x32_bf16 v[36:39], v[180:183], v[56:59], v[36:39]
    s_waitcnt lgkmcnt(12)
    v_mfma_f32_32x32x16_bf16 v[80:95], v[196:199], v[56:59], v[80:95]
    ds_read_b64_tr_b16 v[56:57], v11 offset:12288
    ds_read_b64_tr_b16 v[58:59], v11 offset:13312
    v_add_u32 v10, 0x8000, v10
    ds_read_b128 v[216:219], v10 offset:0
    v_mfma_f32_32x32x16_bf16 v[96:111], v[192:195], v[60:63], v[96:111]
    s_add_u32 m0, s74, 61440
    s_add_u32 s81, s4, 294912
    buffer_load_dwordx4 v4, s[36:39], s81 offen lds
    v_mfma_f32_16x16x32_bf16 v[30:33], v[180:183], v[60:63], v[30:33]
    v_mfma_f32_32x32x16_bf16 v[112:127], v[196:199], v[60:63], v[112:127]
    ds_read_b64_tr_b16 v[60:61], v12 offset:12288
    ds_read_b64_tr_b16 v[62:63], v12 offset:13312
    ds_read_b128 v[220:223], v10 offset:4096
    s_waitcnt lgkmcnt(15)
    v_mfma_f32_32x32x16_bf16 v[64:79], v[200:203], v[40:43], v[64:79]
    s_waitcnt vmcnt(15)
    s_waitcnt vmcnt(11)
    s_barrier
    s_cmp_ge_u32 s23, 8
    s_cselect_b32 s4, s21, s72
    s_add_u32 m0, s74, 65536
    s_add_u32 s81, s4, 393216
    buffer_load_dwordx4 v3, s[32:35], s81 offen lds
    v_mfma_f32_16x16x32_bf16 v[36:39], v[180:183], v[40:43], v[36:39]
    s_waitcnt lgkmcnt(12)
    v_mfma_f32_32x32x16_bf16 v[80:95], v[204:207], v[40:43], v[80:95]
    v_add_u32 v11, 0xfffe4000, v11
    ds_read_b64_tr_b16 v[40:41], v11 offset:0
    ds_read_b64_tr_b16 v[42:43], v11 offset:1024
    v_add_u32 v7, 0xfffe4000, v7
    ds_read_b128 v[224:227], v7 offset:0
    v_mfma_f32_32x32x16_bf16 v[96:111], v[200:203], v[44:47], v[96:111]
    s_add_u32 m0, s74, 69632
    s_add_u32 s81, s4, 491520
    buffer_load_dwordx4 v3, s[32:35], s81 offen lds
    v_mfma_f32_16x16x32_bf16 v[30:33], v[180:183], v[44:47], v[30:33]
    v_mfma_f32_32x32x16_bf16 v[112:127], v[204:207], v[44:47], v[112:127]
    v_add_u32 v12, 0xfffe4000, v12
    ds_read_b64_tr_b16 v[44:45], v12 offset:0
    ds_read_b64_tr_b16 v[46:47], v12 offset:1024
    ds_read_b128 v[228:231], v7 offset:4096
    s_add_u32 m0, s74, 73728
    s_add_u32 s81, s4, 393216
    buffer_load_dwordx4 v4, s[36:39], s81 offen lds
    s_waitcnt lgkmcnt(15)
    v_mfma_f32_32x32x16_bf16 v[64:79], v[208:211], v[48:51], v[64:79]
    s_add_u32 m0, s74, 77824
    s_add_u32 s81, s4, 491520
    buffer_load_dwordx4 v4, s[36:39], s81 offen lds
    v_mfma_f32_16x16x32_bf16 v[36:39], v[180:183], v[48:51], v[36:39]
    s_waitcnt lgkmcnt(12)
    v_mfma_f32_32x32x16_bf16 v[80:95], v[212:215], v[48:51], v[80:95]
    ds_read_b64_tr_b16 v[48:49], v11 offset:4096
    ds_read_b64_tr_b16 v[50:51], v11 offset:5120
    v_add_u32 v8, 0xfffe4000, v8
    ds_read_b128 v[232:235], v8 offset:0
    v_mfma_f32_32x32x16_bf16 v[96:111], v[208:211], v[52:55], v[96:111]
    s_cmp_ge_u32 s23, 7
    s_cselect_b32 s4, s21, s72
    s_add_u32 m0, s74, 81920
    s_add_u32 s81, s4, 589824
    buffer_load_dwordx4 v3, s[32:35], s81 offen lds
    v_mfma_f32_16x16x32_bf16 v[30:33], v[180:183], v[52:55], v[30:33]
    v_mfma_f32_32x32x16_bf16 v[112:127], v[212:215], v[52:55], v[112:127]
    ds_read_b64_tr_b16 v[52:53], v12 offset:4096
    ds_read_b64_tr_b16 v[54:55], v12 offset:5120
    ds_read_b128 v[236:239], v8 offset:4096
    s_waitcnt lgkmcnt(15)
    v_mfma_f32_32x32x16_bf16 v[64:79], v[216:219], v[56:59], v[64:79]
    s_add_u32 m0, s74, 86016
    s_add_u32 s81, s4, 688128
    buffer_load_dwordx4 v3, s[32:35], s81 offen lds
    v_mfma_f32_16x16x32_bf16 v[36:39], v[180:183], v[56:59], v[36:39]
    s_waitcnt lgkmcnt(12)
    v_mfma_f32_32x32x16_bf16 v[80:95], v[220:223], v[56:59], v[80:95]
    ds_read_b64_tr_b16 v[56:57], v11 offset:8192
    ds_read_b64_tr_b16 v[58:59], v11 offset:9216
    v_add_u32 v9, 0xfffe4000, v9
    ds_read_b128 v[240:243], v9 offset:0
    v_mfma_f32_32x32x16_bf16 v[96:111], v[216:219], v[60:63], v[96:111]
    s_add_u32 m0, s74, 90112
    s_add_u32 s81, s4, 589824
    buffer_load_dwordx4 v4, s[36:39], s81 offen lds
    v_mfma_f32_16x16x32_bf16 v[30:33], v[180:183], v[60:63], v[30:33]
    v_mfma_f32_32x32x16_bf16 v[112:127], v[220:223], v[60:63], v[112:127]
    ds_read_b64_tr_b16 v[60:61], v12 offset:8192
    ds_read_b64_tr_b16 v[62:63], v12 offset:9216
    ds_read_b128 v[244:247], v9 offset:4096
    s_waitcnt lgkmcnt(15)
    v_mfma_f32_32x32x16_bf16 v[64:79], v[224:227], v[40:43], v[64:79]
    s_add_u32 m0, s74, 94208
    s_add_u32 s81, s4, 688128
    buffer_load_dwordx4 v4, s[36:39], s81 offen lds
    s_waitcnt vmcnt(12)
    v_xor_b32 v160, s100, v154
    v_mfma_f32_16x16x32_bf16 v[36:39], v[180:183], v[40:43], v[36:39]
    v_bitop3_b32 v160, v160, v158, s100 bitop3:0xf6
    v_bitop3_b32 v160, v160, v155, s101 bitop3:0xf6
    s_waitcnt lgkmcnt(12)
    v_mfma_f32_32x32x16_bf16 v[80:95], v[228:231], v[40:43], v[80:95]
    ds_read_b64_tr_b16 v[40:41], v11 offset:12288
    ds_read_b64_tr_b16 v[42:43], v11 offset:13312
    v_add_u32 v10, 0xfffe4000, v10
    ds_read_b128 v[248:251], v10 offset:0
    v_bitop3_b32 v160, v160, v159, s101 bitop3:0xf6
    v_cmp_ne_u32 vcc, 0, v160
    s_nop 0
    s_and_b64 vcc, vcc, exec
    s_cbranch_scc0 L_sok6
    s_mov_b32 s65, 0x40000
L_sl6:
    s_sleep 2
    v_and_b32 v161, 31, v0
    v_lshlrev_b32 v161, 4, v161
    s_lshl_b32 s76, s80, 4
    buffer_load_dwordx4 v[152:155], v161, s[40:43], s76 offen offset:0 sc1
    buffer_load_dwordx4 v[156:159], v161, s[40:43], s76 offen offset:512 sc1
    s_waitcnt vmcnt(0)
    v_xor_b32 v160, s100, v154
    v_bitop3_b32 v160, v160, v158, s100 bitop3:0xf6
    v_bitop3_b32 v160, v160, v155, s101 bitop3:0xf6
    v_bitop3_b32 v160, v160, v159, s101 bitop3:0xf6
    v_cmp_ne_u32 vcc, 0, v160
    s_nop 0
    s_and_b64 vcc, vcc, exec
    s_cbranch_scc0 L_sok6
    s_sub_u32 s65, s65, 1
    s_cbranch_scc0 L_sl6
L_sok6:
    v_mfma_f32_32x32x16_bf16 v[96:111], v[224:227], v[44:47], v[96:111]
    s_cmp_ge_u32 s23, 6
    s_cselect_b32 s4, s21, s72
    s_add_u32 m0, s74, 98304
    s_add_u32 s81, s4, 786432
    buffer_load_dwordx4 v3, s[32:35], s81 offen lds
    v_mfma_f32_16x16x32_bf16 v[30:33], v[180:183], v[44:47], v[30:33]
    v_mfma_f32_32x32x16_bf16 v[112:127], v[228:231], v[44:47], v[112:127]
    ds_read_b64_tr_b16 v[44:45], v12 offset:12288
    ds_read_b64_tr_b16 v[46:47], v12 offset:13312
    ds_read_b128 v[252:255], v10 offset:4096
    v_cmp_gt_u32 vcc, 32, v0
    s_cmp_lt_u32 s67, 5
    s_cselect_b32 s76, 1051011932, 1.0
    v_cndmask_b32 v22, 0, v152, vcc
    v_cndmask_b32 v24, 0, v156, vcc
    v_mul_f32 v20, s76, v153
    v_mul_f32 v21, s76, v157
    s_waitcnt lgkmcnt(15)
    v_mfma_f32_32x32x16_bf16 v[64:79], v[232:235], v[48:51], v[64:79]
    s_barrier
    s_add_u32 m0, s74, 102400
    s_add_u32 s81, s4, 884736
    buffer_load_dwordx4 v3, s[32:35], s81 offen lds
    v_mfma_f32_16x16x32_bf16 v[36:39], v[180:183], v[48:51], v[36:39]
    v_and_b32 v23, 0xffff, v22
    v_mov_b32 v18, v153
    s_waitcnt lgkmcnt(12)
    v_mfma_f32_32x32x16_bf16 v[80:95], v[236:239], v[48:51], v[80:95]
    v_add_u32 v13, 0x8000, v13
    ds_read_b64_tr_b16 v[48:49], v13 offset:0
    ds_read_b64_tr_b16 v[50:51], v13 offset:512
    s_add_u32 m0, s74, 106496
    s_add_u32 s81, s4, 786432
    buffer_load_dwordx4 v4, s[36:39], s81 offen lds
    v_mfma_f32_32x32x16_bf16 v[96:111], v[232:235], v[52:55], v[96:111]
    s_add_u32 m0, s74, 110592
    s_add_u32 s81, s4, 884736
    buffer_load_dwordx4 v4, s[36:39], s81 offen lds
    v_and_b32 v25, 0xffff, v24
    v_mov_b32 v19, v157
    v_mfma_f32_16x16x32_bf16 v[30:33], v[180:183], v[52:55], v[30:33]
    v_mfma_f32_32x32x16_bf16 v[112:127], v[236:239], v[52:55], v[112:127]
    v_add_u32 v14, 0x8000, v14
    ds_read_b64_tr_b16 v[52:53], v14 offset:0
    ds_read_b64_tr_b16 v[54:55], v14 offset:512
    s_waitcnt lgkmcnt(14)
    s_waitcnt lgkmcnt(13)
    v_mfma_f32_32x32x16_bf16 v[64:79], v[240:243], v[56:59], v[64:79]
    s_cmp_ge_u32 s23, 5
    s_cselect_b32 s4, s21, s72
    s_add_u32 m0, s74, 114688
    s_add_u32 s81, s4, 983040
    buffer_load_dwordx4 v3, s[32:35], s81 offen lds
    v_mfma_f32_16x16x32_bf16 v[36:39], v[180:183], v[56:59], v[36:39]
    s_waitcnt lgkmcnt(10)
    v_mfma_f32_32x32x16_bf16 v[80:95], v[244:247], v[56:59], v[80:95]
    ds_read_b64_tr_b16 v[56:57], v13 offset:2048
    ds_read_b64_tr_b16 v[58:59], v13 offset:2560
    v_mfma_f32_32x32x16_bf16 v[96:111], v[240:243], v[60:63], v[96:111]
    s_add_u32 m0, s74, 118784
    s_add_u32 s81, s4, 1081344
    buffer_load_dwordx4 v3, s[32:35], s81 offen lds
    v_mfma_f32_16x16x32_bf16 v[30:33], v[180:183], v[60:63], v[30:33]
    v_mfma_f32_32x32x16_bf16 v[112:127], v[244:247], v[60:63], v[112:127]
    ds_read_b64_tr_b16 v[60:61], v14 offset:2048
    ds_read_b64_tr_b16 v[62:63], v14 offset:2560
    s_waitcnt lgkmcnt(12)
    s_waitcnt lgkmcnt(11)
    v_mfma_f32_32x32x16_bf16 v[64:79], v[248:251], v[40:43], v[64:79]
    s_add_u32 m0, s74, 122880
    s_add_u32 s81, s4, 983040
    buffer_load_dwordx4 v4, s[36:39], s81 offen lds
    v_mfma_f32_16x16x32_bf16 v[36:39], v[180:183], v[40:43], v[36:39]
    s_waitcnt lgkmcnt(8)
    v_mfma_f32_32x32x16_bf16 v[80:95], v[252:255], v[40:43], v[80:95]
    ds_read_b64_tr_b16 v[40:41], v13 offset:4096
    ds_read_b64_tr_b16 v[42:43], v13 offset:4608
    v_mfma_f32_32x32x16_bf16 v[96:111], v[248:251], v[44:47], v[96:111]
    s_add_u32 m0, s74, 126976
    s_add_u32 s81, s4, 1081344
    buffer_load_dwordx4 v4, s[36:39], s81 offen lds
    v_mfma_f32_16x16x32_bf16 v[30:33], v[180:183], v[44:47], v[30:33]
    v_mfma_f32_32x32x16_bf16 v[112:127], v[252:255], v[44:47], v[112:127]
    ds_read_b64_tr_b16 v[44:45], v14 offset:4096
    ds_read_b64_tr_b16 v[46:47], v14 offset:4608
    s_waitcnt lgkmcnt(10)
    v_mfma_f32_32x32x16_bf16 v[128:143], v[48:51], a[0:3], 0
    s_cmp_ge_u32 s23, 4
    s_cselect_b32 s4, s21, s72
    s_add_u32 m0, s74, 131072
    s_add_u32 s81, s4, 1179648
    buffer_load_dwordx4 v3, s[32:35], s81 offen lds
    v_mfma_f32_32x32x16_bf16 v[144:159], v[48:51], a[4:7], 0
    ds_read_b64_tr_b16 v[48:49], v13 offset:6144
    ds_read_b64_tr_b16 v[50:51], v13 offset:6656
    s_add_u32 m0, s74, 135168
    s_add_u32 s81, s4, 1277952
    buffer_load_dwordx4 v3, s[32:35], s81 offen lds
    s_waitcnt lgkmcnt(10)
    v_mfma_f32_32x32x16_bf16 v[160:175], v[52:55], a[0:3], 0
    s_add_u32 m0, s74, 139264
    s_add_u32 s81, s4, 1179648
    buffer_load_dwordx4 v4, s[36:39], s81 offen lds
    v_cvt_pk_bf16_f32 v37, v36, v36
    v_and_b32 v37, 0xffff0000, v37
    v_mfma_f32_32x32x16_bf16 v[176:191], v[52:55], a[4:7], 0
    ds_read_b64_tr_b16 v[52:53], v14 offset:6144
    ds_read_b64_tr_b16 v[54:55], v14 offset:6656
    s_add_u32 m0, s74, 143360
    s_add_u32 s81, s4, 1277952
    buffer_load_dwordx4 v4, s[36:39], s81 offen lds
    s_waitcnt lgkmcnt(10)
    v_mfma_f32_32x32x16_bf16 v[128:143], v[56:59], a[8:11], v[128:143]
    s_waitcnt vmcnt(20)
    s_barrier
    v_sub_f32 v37, v36, v37
    v_cvt_pk_bf16_f32 v26, v36, v37
    v_and_b32 v38, 0xffff0000, v26
    v_sub_f32 v37, v37, v38
    v_mfma_f32_32x32x16_bf16 v[144:159], v[56:59], a[12:15], v[144:159]
    v_add_u32 v13, 0x4000, v13
    ds_read_b64_tr_b16 v[56:57], v13 offset:0
    ds_read_b64_tr_b16 v[58:59], v13 offset:512
    s_cmp_ge_u32 s23, 3
    s_cselect_b32 s4, s21, s72
    s_add_u32 m0, s74, 0
    s_add_u32 s81, s4, 1376256
    buffer_load_dwordx4 v3, s[32:35], s81 offen lds
    s_waitcnt lgkmcnt(10)
    v_mfma_f32_32x32x16_bf16 v[160:175], v[60:63], a[8:11], v[160:175]
    v_cvt_pk_bf16_f32 v27, v37, 0
    v_cvt_pk_bf16_f32 v31, v30, v30
    v_and_b32 v31, 0xffff0000, v31
    v_sub_f32 v31, v30, v31
    v_cvt_pk_bf16_f32 v28, v30, v31
    v_mfma_f32_32x32x16_bf16 v[176:191], v[60:63], a[12:15], v[176:191]
    v_add_u32 v14, 0x4000, v14
    ds_read_b64_tr_b16 v[60:61], v14 offset:0
    ds_read_b64_tr_b16 v[62:63], v14 offset:512
    s_add_u32 m0, s74, 4096
    s_add_u32 s81, s4, 1474560
    buffer_load_dwordx4 v3, s[32:35], s81 offen lds
    s_waitcnt lgkmcnt(10)
    v_mfma_f32_32x32x16_bf16 v[128:143], v[40:43], a[16:19], v[128:143]
    v_and_b32 v32, 0xffff0000, v28
    v_sub_f32 v31, v31, v32
    v_cvt_pk_bf16_f32 v29, v31, 0
    v_mfma_f32_32x32x8_bf16 v[64:79], v[22:23], v[26:27], v[64:79]
    v_mfma_f32_32x32x8_bf16 v[80:95], v[24:25], v[26:27], v[80:95]
    v_mfma_f32_32x32x8_bf16 v[96:111], v[22:23], v[28:29], v[96:111]
    v_mfma_f32_32x32x8_bf16 v[112:127], v[24:25], v[28:29], v[112:127]
    s_lshr_b32 s77, s80, 5
    s_mul_i32 s77, s77, 41472
    s_sub_u32 s76, s67, 10
    s_lshl_b32 s76, s76, 11
    s_add_u32 s77, s77, s76
    s_lshl_b32 s76, s69, 10
    v_mfma_f32_32x32x16_bf16 v[144:159], v[40:43], a[20:23], v[144:159]
    ds_read_b64_tr_b16 v[40:41], v13 offset:2048
    ds_read_b64_tr_b16 v[42:43], v13 offset:2560
    s_add_u32 m0, s74, 8192
    s_add_u32 s81, s4, 1376256
    buffer_load_dwordx4 v4, s[36:39], s81 offen lds
    s_waitcnt lgkmcnt(10)
    v_mfma_f32_32x32x16_bf16 v[160:175], v[44:47], a[16:19], v[160:175]
    s_add_u32 m0, s74, 12288
    s_add_u32 s81, s4, 1474560
    buffer_load_dwordx4 v4, s[36:39], s81 offen lds
    s_add_u32 s77, s77, s76
    s_add_u32 s77, s77, 8388608
    v_mfma_f32_32x32x16_bf16 v[176:191], v[44:47], a[20:23], v[176:191]
    ds_read_b64_tr_b16 v[44:45], v14 offset:2048
    ds_read_b64_tr_b16 v[46:47], v14 offset:2560
    s_cmp_ge_u32 s23, 2
    s_cselect_b32 s4, s21, s72
    s_add_u32 m0, s74, 16384
    s_add_u32 s81, s4, 1572864
    buffer_load_dwordx4 v3, s[32:35], s81 offen lds
    s_waitcnt lgkmcnt(10)
    v_mfma_f32_32x32x16_bf16 v[128:143], v[48:51], a[24:27], v[128:143]
    s_add_u32 m0, s74, 20480
    s_add_u32 s81, s4, 1671168
    buffer_load_dwordx4 v3, s[32:35], s81 offen lds
    s_cmp_eq_u32 s67, 15
    s_cselect_b32 s77, 0x7f000000, s77
    v_mfma_f32_32x32x16_bf16 v[144:159], v[48:51], a[28:31], v[144:159]
    ds_read_b64_tr_b16 v[48:49], v13 offset:4096
    ds_read_b64_tr_b16 v[50:51], v13 offset:4608
    s_lshl_b32 s79, s64, 12
    s_add_u32 s79, s79, 147456
    v_and_b32 v2, 31, v0
    v_lshl_add_u32 v2, v2, 2, s79
    s_waitcnt lgkmcnt(10)
    v_mfma_f32_32x32x16_bf16 v[160:175], v[52:55], a[24:27], v[160:175]
    s_add_u32 m0, s74, 24576
    s_add_u32 s81, s4, 1572864
    buffer_load_dwordx4 v4, s[36:39], s81 offen lds
    ds_write_b32 v2, v18
    ds_write_b32 v2, v19 offset:128
    v_mfma_f32_32x32x16_bf16 v[176:191], v[52:55], a[28:31], v[176:191]
    ds_read_b64_tr_b16 v[52:53], v14 offset:4096
    ds_read_b64_tr_b16 v[54:55], v14 offset:4608
    v_lshrrev_b32 v12, 5, v0
    v_lshl_add_u32 v12, v12, 4, s79
    ds_read_b128 v[8:11], v12 offset:0
    ds_read_b128 v[36:39], v12 offset:32
    s_waitcnt lgkmcnt(14)
    v_mfma_f32_32x32x16_bf16 v[128:143], v[56:59], a[32:35], v[128:143]
    s_add_u32 m0, s74, 28672
    s_add_u32 s81, s4, 1671168
    buffer_load_dwordx4 v4, s[36:39], s81 offen lds
    s_waitcnt lgkmcnt(1)
    v_mul_f32 v64, v64, v8
    v_mfma_f32_32x32x16_bf16 v[144:159], v[56:59], a[36:39], v[144:159]
    ds_read_b64_tr_b16 v[56:57], v13 offset:6144
    ds_read_b64_tr_b16 v[58:59], v13 offset:6656
    v_mul_f32 v65, v65, v9
    v_mul_f32 v66, v66, v10
    v_mul_f32 v67, v67, v11
    v_mul_f32 v96, v96, v8
    v_mfma_f32_32x32x16_bf16 v[160:175], v[60:63], a[32:35], v[160:175]
    v_mul_f32 v97, v97, v9
    v_mul_f32 v98, v98, v10
    v_mul_f32 v99, v99, v11
    ds_read_b128 v[8:11], v12 offset:64
    s_waitcnt lgkmcnt(3)
    v_mul_f32 v68, v68, v36
    v_mfma_f32_32x32x16_bf16 v[176:191], v[60:63], a[36:39], v[176:191]
    ds_read_b64_tr_b16 v[60:61], v14 offset:6144
    ds_read_b64_tr_b16 v[62:63], v14 offset:6656
    v_mul_f32 v69, v69, v37
    v_mul_f32 v70, v70, v38
    v_mul_f32 v71, v71, v39
    v_mul_f32 v100, v100, v36
    v_mfma_f32_32x32x16_bf16 v[128:143], v[40:43], a[40:43], v[128:143]
    s_waitcnt vmcnt(24)
    s_barrier
    s_cmp_ge_u32 s23, 1
    s_cselect_b32 s4, s21, s72
    s_add_u32 m0, s74, 32768
    s_add_u32 s81, s4, 1769472
    buffer_load_dwordx4 v3, s[32:35], s81 offen lds
    v_mfma_f32_32x32x16_bf16 v[144:159], v[40:43], a[44:47], v[144:159]
    v_add_u32 v13, 0x4000, v13
    ds_read_b64_tr_b16 v[40:41], v13 offset:0
    ds_read_b64_tr_b16 v[42:43], v13 offset:512
    s_add_u32 m0, s74, 36864
    s_add_u32 s81, s4, 1867776
    buffer_load_dwordx4 v3, s[32:35], s81 offen lds
    v_mfma_f32_32x32x16_bf16 v[160:175], v[44:47], a[40:43], v[160:175]
    s_add_u32 m0, s74, 40960
    s_add_u32 s81, s4, 1769472
    buffer_load_dwordx4 v4, s[36:39], s81 offen lds
    v_mul_f32 v101, v101, v37
    v_mul_f32 v102, v102, v38
    v_mfma_f32_32x32x16_bf16 v[176:191], v[44:47], a[44:47], v[176:191]
    v_add_u32 v14, 0x4000, v14
    ds_read_b64_tr_b16 v[44:45], v14 offset:0
    ds_read_b64_tr_b16 v[46:47], v14 offset:512
    s_add_u32 m0, s74, 45056
    s_add_u32 s81, s4, 1867776
    buffer_load_dwordx4 v4, s[36:39], s81 offen lds
    v_mfma_f32_32x32x16_bf16 v[128:143], v[48:51], a[48:51], v[128:143]
    v_mul_f32 v103, v103, v39
    ds_read_b128 v[36:39], v12 offset:96
    v_cvt_pk_bf16_f32 v64, v64, v65
    v_cvt_pk_bf16_f32 v65, v66, v67
    v_cvt_pk_bf16_f32 v66, v68, v69
    v_mfma_f32_32x32x16_bf16 v[144:159], v[48:51], a[52:55], v[144:159]
    ds_read_b64_tr_b16 v[48:49], v13 offset:2048
    ds_read_b64_tr_b16 v[50:51], v13 offset:2560
    v_cvt_pk_bf16_f32 v67, v70, v71
    v_cvt_pk_bf16_f32 v96, v96, v97
    v_cvt_pk_bf16_f32 v97, v98, v99
    v_mfma_f32_32x32x16_bf16 v[160:175], v[52:55], a[48:51], v[160:175]
    s_add_u32 s5, s77, 0
    buffer_store_dwordx4 v[64:67], v17, s[40:43], s5 offen offset:0 sc1
    v_cvt_pk_bf16_f32 v98, v100, v101
    v_cvt_pk_bf16_f32 v99, v102, v103
    v_mfma_f32_32x32x16_bf16 v[176:191], v[52:55], a[52:55], v[176:191]
    ds_read_b64_tr_b16 v[52:53], v14 offset:2048
    ds_read_b64_tr_b16 v[54:55], v14 offset:2560
    s_waitcnt lgkmcnt(11)
    v_mul_f32 v72, v72, v8
    v_mul_f32 v73, v73, v9
    v_mul_f32 v74, v74, v10
    v_mfma_f32_32x32x16_bf16 v[128:143], v[56:59], a[56:59], v[128:143]
    v_mul_f32 v75, v75, v11
    v_mul_f32 v104, v104, v8
    v_mul_f32 v105, v105, v9
    v_mul_f32 v106, v106, v10
    v_mul_f32 v107, v107, v11
    ds_read_b128 v[8:11], v12 offset:128
    v_mfma_f32_32x32x16_bf16 v[144:159], v[56:59], a[60:63], v[144:159]
    ds_read_b64_tr_b16 v[56:57], v13 offset:4096
    ds_read_b64_tr_b16 v[58:59], v13 offset:4608
    s_waitcnt lgkmcnt(7)
    v_mul_f32 v76, v76, v36
    v_mul_f32 v77, v77, v37
    v_mul_f32 v78, v78, v38
    v_mfma_f32_32x32x16_bf16 v[160:175], v[60:63], a[56:59], v[160:175]
    v_mul_f32 v79, v79, v39
    v_mul_f32 v108, v108, v36
    v_mul_f32 v109, v109, v37
    v_mul_f32 v110, v110, v38
    v_mul_f32 v111, v111, v39
    ds_read_b128 v[36:39], v12 offset:160
    v_mfma_f32_32x32x16_bf16 v[176:191], v[60:63], a[60:63], v[176:191]
    ds_read_b64_tr_b16 v[60:61], v14 offset:4096
    ds_read_b64_tr_b16 v[62:63], v14 offset:4608
    v_cvt_pk_bf16_f32 v72, v72, v73
    v_cvt_pk_bf16_f32 v73, v74, v75
    v_cvt_pk_bf16_f32 v74, v76, v77
    v_mfma_f32_32x32x16_bf16 v[128:143], v[40:43], a[64:67], v[128:143]
    v_cvt_pk_bf16_f32 v75, v78, v79
    v_cvt_pk_bf16_f32 v104, v104, v105
    v_cvt_pk_bf16_f32 v105, v106, v107
    v_cvt_pk_bf16_f32 v106, v108, v109
    v_cvt_pk_bf16_f32 v107, v110, v111
    v_mfma_f32_32x32x16_bf16 v[144:159], v[40:43], a[68:71], v[144:159]
    ds_read_b64_tr_b16 v[40:41], v13 offset:6144
    ds_read_b64_tr_b16 v[42:43], v13 offset:6656
    s_add_u32 s5, s77, 0
    buffer_store_dwordx4 v[96:99], v17, s[40:43], s5 offen offset:512 sc1
    s_waitcnt lgkmcnt(7)
    v_mul_f32 v80, v80, v8
    v_mfma_f32_32x32x16_bf16 v[160:175], v[44:47], a[64:67], v[160:175]
    v_mul_f32 v81, v81, v9
    v_mul_f32 v82, v82, v10
    v_mul_f32 v83, v83, v11
    v_mul_f32 v112, v112, v8
    v_mul_f32 v113, v113, v9
    v_mul_f32 v114, v114, v10
    v_mfma_f32_32x32x16_bf16 v[176:191], v[44:47], a[68:71], v[176:191]
    ds_read_b64_tr_b16 v[44:45], v14 offset:6144
    ds_read_b64_tr_b16 v[46:47], v14 offset:6656
    v_mul_f32 v115, v115, v11
    ds_read_b128 v[8:11], v12 offset:192
    s_waitcnt lgkmcnt(7)
    v_mul_f32 v84, v84, v36
    v_mfma_f32_32x32x16_bf16 v[128:143], v[48:51], a[72:75], v[128:143]
    s_waitcnt vmcnt(26)
    s_barrier
    s_mov_b32 s4, s73
    s_add_u32 m0, s74, 49152
    s_add_u32 s81, s4, 0
    buffer_load_dwordx4 v5, s[32:35], s81 offen lds
    v_mfma_f32_32x32x16_bf16 v[144:159], v[48:51], a[76:79], v[144:159]
    v_add_u32 v13, 0x4000, v13
    ds_read_b64_tr_b16 v[48:49], v13 offset:0
    ds_read_b64_tr_b16 v[50:51], v13 offset:512
    s_add_u32 m0, s74, 57344
    s_add_u32 s81, s4, 0
    buffer_load_dwordx4 v6, s[36:39], s81 offen lds
    v_mfma_f32_32x32x16_bf16 v[160:175], v[52:55], a[72:75], v[160:175]
    s_cmp_ge_u32 s23, 9
    s_cselect_b32 s4, s22, s73
    s_add_u32 m0, s74, 53248
    s_add_u32 s81, s4, 196608
    buffer_load_dwordx4 v5, s[32:35], s81 offen lds
    v_mfma_f32_32x32x16_bf16 v[176:191], v[52:55], a[76:79], v[176:191]
    v_add_u32 v14, 0x4000, v14
    ds_read_b64_tr_b16 v[52:53], v14 offset:0
    ds_read_b64_tr_b16 v[54:55], v14 offset:512
    s_add_u32 m0, s74, 61440
    s_add_u32 s81, s4, 196608
    buffer_load_dwordx4 v6, s[36:39], s81 offen lds
    v_mfma_f32_32x32x16_bf16 v[128:143], v[56:59], a[80:83], v[128:143]
    s_add_u32 s5, s77, 20736
    buffer_store_dwordx4 v[72:75], v17, s[40:43], s5 offen offset:0 sc1
    v_mul_f32 v85, v85, v37
    v_mul_f32 v86, v86, v38
    v_mul_f32 v87, v87, v39
    v_mfma_f32_32x32x16_bf16 v[144:159], v[56:59], a[84:87], v[144:159]
    ds_read_b64_tr_b16 v[56:57], v13 offset:2048
    ds_read_b64_tr_b16 v[58:59], v13 offset:2560
    v_mul_f32 v116, v116, v36
    v_mul_f32 v117, v117, v37
    v_mul_f32 v118, v118, v38
    v_mul_f32 v119, v119, v39
    s_waitcnt lgkmcnt(11)
    v_mfma_f32_32x32x16_bf16 v[160:175], v[60:63], a[80:83], v[160:175]
    ds_read_b128 v[36:39], v12 offset:224
    v_cvt_pk_bf16_f32 v80, v80, v81
    v_cvt_pk_bf16_f32 v81, v82, v83
    v_cvt_pk_bf16_f32 v82, v84, v85
    v_cvt_pk_bf16_f32 v83, v86, v87
    v_mfma_f32_32x32x16_bf16 v[176:191], v[60:63], a[84:87], v[176:191]
    ds_read_b64_tr_b16 v[60:61], v14 offset:2048
    ds_read_b64_tr_b16 v[62:63], v14 offset:2560
    v_cvt_pk_bf16_f32 v112, v112, v113
    v_cvt_pk_bf16_f32 v113, v114, v115
    v_cvt_pk_bf16_f32 v114, v116, v117
    s_waitcnt lgkmcnt(12)
    v_mfma_f32_32x32x16_bf16 v[128:143], v[40:43], a[88:91], v[128:143]
    v_cvt_pk_bf16_f32 v115, v118, v119
    s_waitcnt lgkmcnt(9)
    v_mul_f32 v88, v88, v8
    v_mul_f32 v89, v89, v9
    v_mul_f32 v90, v90, v10
    v_mul_f32 v91, v91, v11
    v_mfma_f32_32x32x16_bf16 v[144:159], v[40:43], a[92:95], v[144:159]
    ds_read_b64_tr_b16 v[40:41], v13 offset:4096
    ds_read_b64_tr_b16 v[42:43], v13 offset:4608
    v_mul_f32 v120, v120, v8
    v_mul_f32 v121, v121, v9
    v_mul_f32 v122, v122, v10
    v_mul_f32 v123, v123, v11
    v_mfma_f32_32x32x16_bf16 v[160:175], v[44:47], a[88:91], v[160:175]
    s_waitcnt lgkmcnt(4)
    v_mul_f32 v92, v92, v36
    v_mul_f32 v93, v93, v37
    v_mul_f32 v94, v94, v38
    v_mul_f32 v95, v95, v39
    v_mul_f32 v124, v124, v36
    v_mfma_f32_32x32x16_bf16 v[176:191], v[44:47], a[92:95], v[176:191]
    ds_read_b64_tr_b16 v[44:45], v14 offset:4096
    ds_read_b64_tr_b16 v[46:47], v14 offset:4608
    s_add_u32 s5, s77, 20736
    buffer_store_dwordx4 v[104:107], v17, s[40:43], s5 offen offset:512 sc1
    v_mul_f32 v125, v125, v37
    v_mfma_f32_32x32x16_bf16 v[128:143], v[48:51], a[96:99], v[128:143]
    v_mul_f32 v126, v126, v38
    v_mul_f32 v127, v127, v39
    v_cvt_pk_bf16_f32 v88, v88, v89
    v_cvt_pk_bf16_f32 v89, v90, v91
    v_cvt_pk_bf16_f32 v90, v92, v93
    v_mfma_f32_32x32x16_bf16 v[144:159], v[48:51], a[100:103], v[144:159]
    ds_read_b64_tr_b16 v[48:49], v13 offset:6144
    ds_read_b64_tr_b16 v[50:51], v13 offset:6656
    v_cvt_pk_bf16_f32 v91, v94, v95
    v_cvt_pk_bf16_f32 v120, v120, v121
    v_cvt_pk_bf16_f32 v121, v122, v123
    v_mfma_f32_32x32x16_bf16 v[160:175], v[52:55], a[96:99], v[160:175]
    v_cvt_pk_bf16_f32 v122, v124, v125
    v_cvt_pk_bf16_f32 v123, v126, v127
    v_mov_b32 v8, 0x3f803f80
    v_mov_b32 v9, 0x3f803f80
    v_mov_b32 v10, 0x3f803f80
    v_mfma_f32_32x32x16_bf16 v[176:191], v[52:55], a[100:103], v[176:191]
    ds_read_b64_tr_b16 v[52:53], v14 offset:6144
    ds_read_b64_tr_b16 v[54:55], v14 offset:6656
    v_mov_b32 v11, 0x3f803f80
    v_lshrrev_b32 v12, 3, v0
    v_mul_u32_u24 v2, 10368, v0
    v_lshl_add_u32 v2, v12, 25, v2
    v_mfma_f32_32x32x16_bf16 v[128:143], v[56:59], a[104:107], v[128:143]
    s_waitcnt vmcnt(28)
    s_barrier
    s_cmp_ge_u32 s23, 8
    s_cselect_b32 s4, s22, s73
    s_add_u32 m0, s74, 65536
    s_add_u32 s81, s4, 393216
    buffer_load_dwordx4 v5, s[32:35], s81 offen lds
    v_mfma_f32_32x32x16_bf16 v[144:159], v[56:59], a[108:111], v[144:159]
    v_add_u32 v13, 0x4000, v13
    ds_read_b64_tr_b16 v[56:57], v13 offset:0
    ds_read_b64_tr_b16 v[58:59], v13 offset:512
    s_add_u32 m0, s74, 73728
    s_add_u32 s81, s4, 393216
    buffer_load_dwordx4 v6, s[36:39], s81 offen lds
    s_waitcnt lgkmcnt(10)
    v_mfma_f32_32x32x16_bf16 v[160:175], v[60:63], a[104:107], v[160:175]
    s_add_u32 s5, s77, 41472
    buffer_store_dwordx4 v[80:83], v17, s[40:43], s5 offen offset:0 sc1
    s_cmp_ge_u32 s23, 7
    s_cselect_b32 s4, s22, s73
    s_add_u32 m0, s74, 69632
    s_add_u32 s81, s4, 589824
    buffer_load_dwordx4 v5, s[32:35], s81 offen lds
    v_mfma_f32_32x32x16_bf16 v[176:191], v[60:63], a[108:111], v[176:191]
    v_add_u32 v14, 0x4000, v14
    ds_read_b64_tr_b16 v[60:61], v14 offset:0
    ds_read_b64_tr_b16 v[62:63], v14 offset:512
    s_lshr_b32 s76, s80, 5
    s_mul_i32 s76, s76, 41472
    s_add_u32 s76, s76, 8398848
    s_waitcnt lgkmcnt(10)
    v_mfma_f32_32x32x16_bf16 v[128:143], v[40:43], a[112:115], v[128:143]
    s_add_u32 m0, s74, 77824
    s_add_u32 s81, s4, 589824
    buffer_load_dwordx4 v6, s[36:39], s81 offen lds
    s_sub_u32 s79, 15, s67
    s_or_b32 s79, s79, s69
    v_mfma_f32_32x32x16_bf16 v[144:159], v[40:43], a[116:119], v[144:159]
    ds_read_b64_tr_b16 v[40:41], v13 offset:2048
    ds_read_b64_tr_b16 v[42:43], v13 offset:2560
    s_lshl_b32 s79, s79, 25
    s_add_u32 s76, s76, s79
    s_waitcnt lgkmcnt(10)
    v_mfma_f32_32x32x16_bf16 v[160:175], v[44:47], a[112:115], v[160:175]
    buffer_store_dwordx4 v[8:11], v2, s[40:43], s76 offen sc1
    s_lshl_b32 s75, s66, 4
    s_add_u32 s75, s75, s67
    s_min_u32 s76, s75, 169
    s_mul_i32 s79, s76, 241
    v_mfma_f32_32x32x16_bf16 v[176:191], v[44:47], a[116:119], v[176:191]
    ds_read_b64_tr_b16 v[44:45], v14 offset:2048
    ds_read_b64_tr_b16 v[46:47], v14 offset:2560
    s_lshr_b32 s79, s79, 12
    s_mul_i32 s20, s79, 17
    s_sub_u32 s76, s76, s20
    s_lshl_b32 s76, s76, 2
    s_waitcnt lgkmcnt(10)
    v_mfma_f32_32x32x16_bf16 v[128:143], v[48:51], a[120:123], v[128:143]
    s_add_u32 s76, s76, s64
    s_mul_i32 s20, s79, 272
    s_add_u32 s20, s20, s76
    s_lshl_b32 s20, s20, 10
    s_add_u32 s20, s20, 22020096
    v_mfma_f32_32x32x16_bf16 v[144:159], v[48:51], a[124:127], v[144:159]
    ds_read_b64_tr_b16 v[48:49], v13 offset:4096
    ds_read_b64_tr_b16 v[50:51], v13 offset:4608
    s_add_u32 s5, s77, 41472
    buffer_store_dwordx4 v[112:115], v17, s[40:43], s5 offen offset:512 sc1
    s_waitcnt lgkmcnt(10)
    v_mfma_f32_32x32x16_bf16 v[160:175], v[52:55], a[120:123], v[160:175]
    s_cmp_gt_u32 s75, 169
    s_cselect_b32 s20, 0x7f000000, s20
    s_cmp_lt_u32 s76, 48
    s_cselect_b32 s60, s48, s44
    s_cselect_b32 s61, s49, s45
    s_cselect_b32 s62, s50, s46
    s_cselect_b32 s75, 0, 48
    v_mfma_f32_32x32x16_bf16 v[176:191], v[52:55], a[124:127], v[176:191]
    ds_read_b64_tr_b16 v[52:53], v14 offset:4096
    ds_read_b64_tr_b16 v[54:55], v14 offset:4608
    s_mov_b32 s63, 0x20000
    s_sub_u32 s76, s76, s75
    s_mul_i32 s76, s76, 40960
    s_lshl_b32 s79, s79, 7
    s_waitcnt lgkmcnt(10)
    v_mfma_f32_32x32x16_bf16 v[128:143], v[56:59], a[128:131], v[128:143]
    s_add_u32 s76, s76, s79
    v_lshrrev_b32 v1, 3, v0
    v_and_b32 v2, 7, v0
    v_mul_u32_u24 v1, 1280, v1
    v_lshl_add_u32 v1, v2, 4, v1
    s_lshl_b32 s79, s64, 12
    v_mfma_f32_32x32x16_bf16 v[144:159], v[56:59], a[132:135], v[144:159]
    ds_read_b64_tr_b16 v[56:57], v13 offset:6144
    ds_read_b64_tr_b16 v[58:59], v13 offset:6656
    s_add_u32 s79, s79, 147456
    s_add_u32 m0, s79, 0
    s_add_u32 s75, s76, 0
    buffer_load_dwordx4 v1, s[60:63], s75 offen lds
    s_waitcnt lgkmcnt(10)
    v_mfma_f32_32x32x16_bf16 v[160:175], v[60:63], a[128:131], v[160:175]
    s_add_u32 m0, s79, 1024
    s_add_u32 s75, s76, 10240
    buffer_load_dwordx4 v1, s[60:63], s75 offen lds
    v_mfma_f32_32x32x16_bf16 v[176:191], v[60:63], a[132:135], v[176:191]
    ds_read_b64_tr_b16 v[60:61], v14 offset:6144
    ds_read_b64_tr_b16 v[62:63], v14 offset:6656
    s_add_u32 m0, s79, 2048
    s_add_u32 s75, s76, 20480
    buffer_load_dwordx4 v1, s[60:63], s75 offen lds
    s_waitcnt lgkmcnt(10)
    v_mfma_f32_32x32x16_bf16 v[128:143], v[40:43], a[136:139], v[128:143]
    s_waitcnt vmcnt(34)
    s_barrier
    s_add_u32 s5, s77, 62208
    buffer_store_dwordx4 v[88:91], v17, s[40:43], s5 offen offset:0 sc1
    v_mfma_f32_32x32x16_bf16 v[144:159], v[40:43], a[140:143], v[144:159]
    v_add_u32 v13, 0x4000, v13
    ds_read_b64_tr_b16 v[40:41], v13 offset:0
    ds_read_b64_tr_b16 v[42:43], v13 offset:512
    s_cmp_ge_u32 s23, 6
    s_cselect_b32 s4, s22, s73
    s_add_u32 m0, s74, 81920
    s_add_u32 s81, s4, 786432
    buffer_load_dwordx4 v5, s[32:35], s81 offen lds
    s_waitcnt lgkmcnt(10)
    v_mfma_f32_32x32x16_bf16 v[160:175], v[44:47], a[136:139], v[160:175]
    v_mfma_f32_32x32x16_bf16 v[176:191], v[44:47], a[140:143], v[176:191]
    v_add_u32 v14, 0x4000, v14
    ds_read_b64_tr_b16 v[44:45], v14 offset:0
    ds_read_b64_tr_b16 v[46:47], v14 offset:512
    s_add_u32 m0, s74, 90112
    s_add_u32 s81, s4, 786432
    buffer_load_dwordx4 v6, s[36:39], s81 offen lds
    s_waitcnt lgkmcnt(10)
    v_mfma_f32_32x32x16_bf16 v[128:143], v[48:51], a[144:147], v[128:143]
    v_mfma_f32_32x32x16_bf16 v[144:159], v[48:51], a[148:151], v[144:159]
    ds_read_b64_tr_b16 v[48:49], v13 offset:2048
    ds_read_b64_tr_b16 v[50:51], v13 offset:2560
    s_cmp_ge_u32 s23, 5
    s_cselect_b32 s4, s22, s73
    s_add_u32 m0, s74, 86016
    s_add_u32 s81, s4, 983040
    buffer_load_dwordx4 v5, s[32:35], s81 offen lds
    s_waitcnt lgkmcnt(10)
    v_mfma_f32_32x32x16_bf16 v[160:175], v[52:55], a[144:147], v[160:175]
    v_mfma_f32_32x32x16_bf16 v[176:191], v[52:55], a[148:151], v[176:191]
    ds_read_b64_tr_b16 v[52:53], v14 offset:2048
    ds_read_b64_tr_b16 v[54:55], v14 offset:2560
    s_add_u32 s5, s77, 62208
    buffer_store_dwordx4 v[120:123], v17, s[40:43], s5 offen offset:512 sc1
    s_waitcnt lgkmcnt(10)
    v_mfma_f32_32x32x16_bf16 v[128:143], v[56:59], a[152:155], v[128:143]
    s_add_u32 m0, s74, 94208
    s_add_u32 s81, s4, 983040
    buffer_load_dwordx4 v6, s[36:39], s81 offen lds
    v_mfma_f32_32x32x16_bf16 v[144:159], v[56:59], a[156:159], v[144:159]
    ds_read_b64_tr_b16 v[56:57], v13 offset:4096
    ds_read_b64_tr_b16 v[58:59], v13 offset:4608
    s_waitcnt lgkmcnt(10)
    v_mfma_f32_32x32x16_bf16 v[160:175], v[60:63], a[152:155], v[160:175]
    s_add_u32 m0, s79, 3072
    s_add_u32 s75, s76, 30720
    buffer_load_dwordx4 v1, s[60:63], s75 offen lds
    v_lshrrev_b32 v1, 4, v0
    v_bfe_u32 v2, v0, 2, 2
    v_mfma_f32_32x32x16_bf16 v[176:191], v[60:63], a[156:159], v[176:191]
    ds_read_b64_tr_b16 v[60:61], v14 offset:4096
    ds_read_b64_tr_b16 v[62:63], v14 offset:4608
    v_lshl_add_u32 v1, v1, 3, v2
    v_lshlrev_b32 v1, 7, v1
    v_and_b32 v2, 3, v0
    v_lshl_add_u32 v1, v2, 3, v1
    s_waitcnt lgkmcnt(10)
    v_mfma_f32_32x32x16_bf16 v[128:143], v[40:43], a[160:163], v[128:143]
    v_add_u32 v7, s79, v1
    s_mul_i32 s79, s67, 768
    s_add_u32 s76, s69, s3
    s_lshl_b32 s76, s76, 8
    s_add_u32 s79, s79, s76
    s_add_u32 s79, s79, 131072
    v_mfma_f32_32x32x16_bf16 v[144:159], v[40:43], a[164:167], v[144:159]
    ds_read_b64_tr_b16 v[40:41], v13 offset:6144
    ds_read_b64_tr_b16 v[42:43], v13 offset:6656
    s_add_u32 s76, s79, 0
    buffer_load_dwordx2 v[68:69], v35, s[40:43], s76 offen offset:0
    s_add_u32 s76, s79, 49152
    s_waitcnt lgkmcnt(10)
    v_mfma_f32_32x32x16_bf16 v[160:175], v[44:47], a[160:163], v[160:175]
    buffer_load_dwordx2 v[70:71], v35, s[40:43], s76 offen offset:0
    s_add_u32 s76, s79, 98304
    buffer_load_dwordx2 v[76:77], v34, s[40:43], s76 offen offset:0
    s_add_u32 s76, s79, 0
    v_mfma_f32_32x32x16_bf16 v[176:191], v[44:47], a[164:167], v[176:191]
    ds_read_b64_tr_b16 v[44:45], v14 offset:6144
    ds_read_b64_tr_b16 v[46:47], v14 offset:6656
    buffer_load_dwordx2 v[78:79], v35, s[40:43], s76 offen offset:128
    s_add_u32 s76, s79, 49152
    s_waitcnt lgkmcnt(10)
    v_mfma_f32_32x32x16_bf16 v[128:143], v[48:51], a[168:171], v[128:143]
    s_waitcnt vmcnt(41)
    s_barrier
    s_cmp_ge_u32 s23, 4
    s_cselect_b32 s4, s22, s73
    s_add_u32 m0, s74, 98304
    s_add_u32 s81, s4, 1179648
    buffer_load_dwordx4 v5, s[32:35], s81 offen lds
    v_mfma_f32_32x32x16_bf16 v[144:159], v[48:51], a[172:175], v[144:159]
    v_add_u32 v13, 0x4000, v13
    ds_read_b64_tr_b16 v[48:49], v13 offset:0
    ds_read_b64_tr_b16 v[50:51], v13 offset:512
    s_add_u32 m0, s74, 106496
    s_add_u32 s81, s4, 1179648
    buffer_load_dwordx4 v6, s[36:39], s81 offen lds
    s_waitcnt lgkmcnt(10)
    v_mfma_f32_32x32x16_bf16 v[160:175], v[52:55], a[168:171], v[160:175]
    v_mfma_f32_32x32x16_bf16 v[176:191], v[52:55], a[172:175], v[176:191]
    v_add_u32 v14, 0x4000, v14
    ds_read_b64_tr_b16 v[52:53], v14 offset:0
    ds_read_b64_tr_b16 v[54:55], v14 offset:512
    s_cmp_ge_u32 s23, 3
    s_cselect_b32 s4, s22, s73
    s_add_u32 m0, s74, 102400
    s_add_u32 s81, s4, 1376256
    buffer_load_dwordx4 v5, s[32:35], s81 offen lds
    s_waitcnt lgkmcnt(10)
    v_mfma_f32_32x32x16_bf16 v[128:143], v[56:59], a[176:179], v[128:143]
    v_mfma_f32_32x32x16_bf16 v[144:159], v[56:59], a[180:183], v[144:159]
    ds_read_b64_tr_b16 v[56:57], v13 offset:2048
    ds_read_b64_tr_b16 v[58:59], v13 offset:2560
    s_add_u32 m0, s74, 110592
    s_add_u32 s81, s4, 1376256
    buffer_load_dwordx4 v6, s[36:39], s81 offen lds
    s_waitcnt lgkmcnt(10)
    v_mfma_f32_32x32x16_bf16 v[160:175], v[60:63], a[176:179], v[160:175]
    buffer_load_dwordx2 v[84:85], v35, s[40:43], s76 offen offset:128
    s_add_u32 s76, s79, 98304
    v_mfma_f32_32x32x16_bf16 v[176:191], v[60:63], a[180:183], v[176:191]
    ds_read_b64_tr_b16 v[60:61], v14 offset:2048
    ds_read_b64_tr_b16 v[62:63], v14 offset:2560
    buffer_load_dwordx2 v[86:87], v34, s[40:43], s76 offen offset:128
    s_mul_i32 s79, s67, 768
    s_lshl_b32 s76, s69, 7
    s_waitcnt lgkmcnt(10)
    v_mfma_f32_32x32x16_bf16 v[128:143], v[40:43], a[184:187], v[128:143]
    s_add_u32 s79, s79, s76
    s_lshl_b32 s76, s3, 9
    s_sub_u32 s79, s79, s76
    s_add_u32 s79, s79, 131584
    s_add_u32 s76, s79, 0
    v_mfma_f32_32x32x16_bf16 v[144:159], v[40:43], a[188:191], v[144:159]
    ds_read_b64_tr_b16 v[40:41], v13 offset:4096
    ds_read_b64_tr_b16 v[42:43], v13 offset:4608
    buffer_load_dwordx2 v[92:93], v35, s[40:43], s76 offen offset:0
    s_add_u32 s76, s79, 49152
    s_waitcnt lgkmcnt(10)
    v_mfma_f32_32x32x16_bf16 v[160:175], v[44:47], a[184:187], v[160:175]
    buffer_load_dwordx2 v[94:95], v35, s[40:43], s76 offen offset:0
    s_add_u32 s76, s79, 98304
    buffer_load_dwordx2 v[100:101], v34, s[40:43], s76 offen offset:0
    v_mfma_f32_32x32x16_bf16 v[176:191], v[44:47], a[188:191], v[176:191]
    ds_read_b64_tr_b16 v[44:45], v14 offset:4096
    ds_read_b64_tr_b16 v[46:47], v14 offset:4608
    s_waitcnt lgkmcnt(10)
    v_mfma_f32_32x32x16_bf16 v[128:143], v[48:51], a[192:195], v[128:143]
    v_mfma_f32_32x32x16_bf16 v[144:159], v[48:51], a[196:199], v[144:159]
    ds_read_b64_tr_b16 v[48:49], v13 offset:6144
    ds_read_b64_tr_b16 v[50:51], v13 offset:6656
    s_waitcnt lgkmcnt(10)
    v_mfma_f32_32x32x16_bf16 v[160:175], v[52:55], a[192:195], v[160:175]
    v_mfma_f32_32x32x16_bf16 v[176:191], v[52:55], a[196:199], v[176:191]
    ds_read_b64_tr_b16 v[52:53], v14 offset:6144
    ds_read_b64_tr_b16 v[54:55], v14 offset:6656
    s_waitcnt lgkmcnt(10)
    v_mfma_f32_32x32x16_bf16 v[128:143], v[56:59], a[200:203], v[128:143]
    s_waitcnt vmcnt(46)
    s_barrier
    s_cmp_ge_u32 s23, 2
    s_cselect_b32 s4, s22, s73
    s_add_u32 m0, s74, 114688
    s_add_u32 s81, s4, 1572864
    buffer_load_dwordx4 v5, s[32:35], s81 offen lds
    v_mfma_f32_32x32x16_bf16 v[144:159], v[56:59], a[204:207], v[144:159]
    v_add_u32 v13, 0xfffe0000, v13
    ds_read_b64_tr_b16 v[56:57], v13 offset:0
    ds_read_b64_tr_b16 v[58:59], v13 offset:512
    s_add_u32 m0, s74, 122880
    s_add_u32 s81, s4, 1572864
    buffer_load_dwordx4 v6, s[36:39], s81 offen lds
    s_waitcnt lgkmcnt(10)
    v_mfma_f32_32x32x16_bf16 v[160:175], v[60:63], a[200:203], v[160:175]
    s_cmp_ge_u32 s23, 1
    s_cselect_b32 s4, s22, s73
    s_add_u32 m0, s74, 118784
    s_add_u32 s81, s4, 1769472
    buffer_load_dwordx4 v5, s[32:35], s81 offen lds
    v_mfma_f32_32x32x16_bf16 v[176:191], v[60:63], a[204:207], v[176:191]
    v_add_u32 v14, 0xfffe0000, v14
    ds_read_b64_tr_b16 v[60:61], v14 offset:0
    ds_read_b64_tr_b16 v[62:63], v14 offset:512
    s_add_u32 m0, s74, 126976
    s_add_u32 s81, s4, 1769472
    buffer_load_dwordx4 v6, s[36:39], s81 offen lds
    s_waitcnt lgkmcnt(10)
    v_mfma_f32_32x32x16_bf16 v[128:143], v[40:43], a[208:211], v[128:143]
    v_mfma_f32_32x32x16_bf16 v[144:159], v[40:43], a[212:215], v[144:159]
    ds_read_b64_tr_b16 v[40:41], v13 offset:2048
    ds_read_b64_tr_b16 v[42:43], v13 offset:2560
    s_waitcnt lgkmcnt(10)
    v_mfma_f32_32x32x16_bf16 v[160:175], v[44:47], a[208:211], v[160:175]
    v_mfma_f32_32x32x16_bf16 v[176:191], v[44:47], a[212:215], v[176:191]
    ds_read_b64_tr_b16 v[44:45], v14 offset:2048
    ds_read_b64_tr_b16 v[46:47], v14 offset:2560
    s_waitcnt lgkmcnt(10)
    v_mfma_f32_32x32x16_bf16 v[128:143], v[48:51], a[216:219], v[128:143]
    v_mfma_f32_32x32x16_bf16 v[144:159], v[48:51], a[220:223], v[144:159]
    ds_read_b64_tr_b16 v[48:49], v13 offset:4096
    ds_read_b64_tr_b16 v[50:51], v13 offset:4608
    s_waitcnt vmcnt(17)
    ds_read_b64_tr_b16 v[64:65], v7 offset:0
    ds_read_b64_tr_b16 v[66:67], v7 offset:512
    ds_read_b64_tr_b16 v[96:97], v7 offset:32
    s_waitcnt lgkmcnt(13)
    v_mfma_f32_32x32x16_bf16 v[160:175], v[52:55], a[216:219], v[160:175]
    ds_read_b64_tr_b16 v[98:99], v7 offset:544
    ds_read_b64_tr_b16 v[72:73], v7 offset:64
    ds_read_b64_tr_b16 v[74:75], v7 offset:576
    ds_read_b64_tr_b16 v[104:105], v7 offset:96
    ds_read_b64_tr_b16 v[106:107], v7 offset:608
    v_mul_f32 v20, 0xbfb8aa3b, v18
    v_mfma_f32_32x32x16_bf16 v[176:191], v[52:55], a[220:223], v[176:191]
    ds_read_b64_tr_b16 v[52:53], v14 offset:4096
    ds_read_b64_tr_b16 v[54:55], v14 offset:4608
    s_add_u32 s5, s20, 0
    s_waitcnt lgkmcnt(8)
    buffer_store_dwordx4 v[64:67], v16, s[40:43], s5 offen sc1
    v_mfma_f32_32x32x16_bf16 v[128:143], v[56:59], a[224:227], v[128:143]
    v_mul_f32 v21, 0xbfb8aa3b, v19
    s_mul_i32 s78, s67, 6144
    s_lshr_b32 s76, s80, 5
    s_mul_i32 s76, s76, 139264
    s_add_u32 s78, s78, s76
    s_add_u32 s78, s78, 12582912
    v_mfma_f32_32x32x16_bf16 v[144:159], v[56:59], a[228:231], v[144:159]
    ds_read_b64_tr_b16 v[56:57], v13 offset:6144
    ds_read_b64_tr_b16 v[58:59], v13 offset:6656
    v_mfma_f32_32x32x16_bf16 v[160:175], v[60:63], a[224:227], v[160:175]
    v_mfma_f32_32x32x16_bf16 v[176:191], v[60:63], a[228:231], v[176:191]
    ds_read_b64_tr_b16 v[60:61], v14 offset:6144
    ds_read_b64_tr_b16 v[62:63], v14 offset:6656
    v_mfma_f32_32x32x16_bf16 v[128:143], v[40:43], a[232:235], v[128:143]
    s_barrier
    s_or_b32 s65, s100, 2
    v_mov_b32 v36, s65
    v_mov_b32 v37, s101
    s_lshl_b32 s65, s64, 25
    s_add_u32 s65, s65, s7
    v_lshlrev_b32 v38, 25, v0
    buffer_store_dwordx2 v[36:37], v38, s[40:43], s65 offen sc1
    v_mfma_f32_32x32x16_bf16 v[144:159], v[40:43], a[236:239], v[144:159]
    v_add_u32 v13, 0x4000, v13
    ds_read_b64_tr_b16 v[40:41], v13 offset:0
    ds_read_b64_tr_b16 v[42:43], v13 offset:512
    v_mfma_f32_32x32x16_bf16 v[160:175], v[44:47], a[232:235], v[160:175]
    s_add_u32 s5, s20, 69632
    s_waitcnt lgkmcnt(12)
    buffer_store_dwordx4 v[96:99], v16, s[40:43], s5 offen sc1
    v_mfma_f32_32x32x16_bf16 v[176:191], v[44:47], a[236:239], v[176:191]
    v_add_u32 v14, 0x4000, v14
    ds_read_b64_tr_b16 v[44:45], v14 offset:0
    ds_read_b64_tr_b16 v[46:47], v14 offset:512
    v_mfma_f32_32x32x16_bf16 v[128:143], v[48:51], a[240:243], v[128:143]
    v_mfma_f32_32x32x16_bf16 v[144:159], v[48:51], a[244:247], v[144:159]
    ds_read_b64_tr_b16 v[48:49], v13 offset:2048
    ds_read_b64_tr_b16 v[50:51], v13 offset:2560
    s_waitcnt lgkmcnt(10)
    v_mfma_f32_32x32x16_bf16 v[160:175], v[52:55], a[240:243], v[160:175]
    v_mfma_f32_32x32x16_bf16 v[176:191], v[52:55], a[244:247], v[176:191]
    ds_read_b64_tr_b16 v[52:53], v14 offset:2048
    ds_read_b64_tr_b16 v[54:55], v14 offset:2560
    s_waitcnt lgkmcnt(10)
    v_mfma_f32_32x32x16_bf16 v[128:143], v[56:59], a[248:251], v[128:143]
    v_mfma_f32_32x32x16_bf16 v[144:159], v[56:59], a[252:255], v[144:159]
    ds_read_b64_tr_b16 v[56:57], v13 offset:4096
    ds_read_b64_tr_b16 v[58:59], v13 offset:4608
    s_add_u32 s5, s20, 139264
    buffer_store_dwordx4 v[72:75], v16, s[40:43], s5 offen sc1
    s_waitcnt lgkmcnt(10)
    v_mfma_f32_32x32x16_bf16 v[160:175], v[60:63], a[248:251], v[160:175]
    s_waitcnt vmcnt(8)
    v_xor_b32 v102, s100, v69
    v_bitop3_b32 v102, v102, v71, s100 bitop3:0xf6
    v_bitop3_b32 v102, v102, v77, s100 bitop3:0xf6
    v_bitop3_b32 v102, v102, v79, s100 bitop3:0xf6
    v_bitop3_b32 v102, v102, v85, s100 bitop3:0xf6
    v_mfma_f32_32x32x16_bf16 v[176:191], v[60:63], a[252:255], v[176:191]
    ds_read_b64_tr_b16 v[60:61], v14 offset:4096
    ds_read_b64_tr_b16 v[62:63], v14 offset:4608
    v_bitop3_b32 v102, v102, v87, s100 bitop3:0xf6
    v_bitop3_b32 v102, v102, v93, s100 bitop3:0xf6
    v_bitop3_b32 v102, v102, v95, s100 bitop3:0xf6
    v_bitop3_b32 v102, v102, v101, s100 bitop3:0xf6
    s_waitcnt lgkmcnt(10)
    v_mfma_f32_32x32x16_bf16 v[128:143], v[40:43], v[192:195], v[128:143]
    v_cmp_ne_u32 vcc, 0, v102
    s_nop 0
    s_and_b64 vcc, vcc, exec
    s_cbranch_scc0 L_sok7
    s_mov_b32 s65, 0x40000
L_sl7:
    s_sleep 2
    s_mul_i32 s79, s67, 768
    s_add_u32 s76, s69, s3
    s_lshl_b32 s76, s76, 8
    s_add_u32 s79, s79, s76
    s_add_u32 s79, s79, 131072
    s_add_u32 s76, s79, 0
    buffer_load_dwordx2 v[68:69], v35, s[40:43], s76 offen offset:0 sc1
    s_add_u32 s76, s79, 49152
    buffer_load_dwordx2 v[70:71], v35, s[40:43], s76 offen offset:0 sc1
    s_add_u32 s76, s79, 98304
    buffer_load_dwordx2 v[76:77], v34, s[40:43], s76 offen offset:0 sc1
    s_add_u32 s76, s79, 0
    buffer_load_dwordx2 v[78:79], v35, s[40:43], s76 offen offset:128 sc1
    s_add_u32 s76, s79, 49152
    buffer_load_dwordx2 v[84:85], v35, s[40:43], s76 offen offset:128 sc1
    s_add_u32 s76, s79, 98304
    buffer_load_dwordx2 v[86:87], v34, s[40:43], s76 offen offset:128 sc1
    s_mul_i32 s79, s67, 768
    s_lshl_b32 s76, s69, 7
    s_add_u32 s79, s79, s76
    s_lshl_b32 s76, s3, 9
    s_sub_u32 s79, s79, s76
    s_add_u32 s79, s79, 131584
    s_add_u32 s76, s79, 0
    buffer_load_dwordx2 v[92:93], v35, s[40:43], s76 offen offset:0 sc1
    s_add_u32 s76, s79, 49152
    buffer_load_dwordx2 v[94:95], v35, s[40:43], s76 offen offset:0 sc1
    s_add_u32 s76, s79, 98304
    buffer_load_dwordx2 v[100:101], v34, s[40:43], s76 offen offset:0 sc1
    s_waitcnt vmcnt(0)
    v_xor_b32 v102, s100, v69
    v_bitop3_b32 v102, v102, v71, s100 bitop3:0xf6
    v_bitop3_b32 v102, v102, v77, s100 bitop3:0xf6
    v_bitop3_b32 v102, v102, v79, s100 bitop3:0xf6
    v_bitop3_b32 v102, v102, v85, s100 bitop3:0xf6
    v_bitop3_b32 v102, v102, v87, s100 bitop3:0xf6
    v_bitop3_b32 v102, v102, v93, s100 bitop3:0xf6
    v_bitop3_b32 v102, v102, v95, s100 bitop3:0xf6
    v_bitop3_b32 v102, v102, v101, s100 bitop3:0xf6
    v_cmp_ne_u32 vcc, 0, v102
    s_nop 0
    s_and_b64 vcc, vcc, exec
    s_cbranch_scc0 L_sok7
    s_sub_u32 s65, s65, 1
    s_cbranch_scc0 L_sl7
L_sok7:
    v_add_f32 v68, v68, v70
    v_mov_b32 v70, v68
    v_mfma_f32_32x32x16_bf16 v[144:159], v[40:43], v[196:199], v[144:159]
    ds_read_b64_tr_b16 v[40:41], v13 offset:6144
    ds_read_b64_tr_b16 v[42:43], v13 offset:6656
    v_permlane32_swap_b32 v68, v70
    v_add_f32 v68, v68, v70
    v_add_f32 v68, v68, v76
    v_cvt_pk_bf16_f32 v69, v68, v68
    s_waitcnt lgkmcnt(10)
    v_mfma_f32_32x32x16_bf16 v[160:175], v[44:47], v[192:195], v[160:175]
    v_and_b32 v69, 0xffff0000, v69
    v_sub_f32 v69, v68, v69
    v_cvt_pk_bf16_f32 v30, v68, v69
    v_and_b32 v70, 0xffff0000, v30
    v_sub_f32 v69, v69, v70
    v_cvt_pk_bf16_f32 v31, v69, 0
    v_mfma_f32_32x32x16_bf16 v[176:191], v[44:47], v[196:199], v[176:191]
    ds_read_b64_tr_b16 v[44:45], v14 offset:6144
    ds_read_b64_tr_b16 v[46:47], v14 offset:6656
    v_add_f32 v78, v78, v84
    v_mov_b32 v84, v78
    s_nop 1
    v_permlane32_swap_b32 v78, v84
    v_add_f32 v78, v78, v84
    s_waitcnt lgkmcnt(10)
    v_mfma_f32_32x32x16_bf16 v[128:143], v[48:51], v[200:203], v[128:143]
    s_barrier
    s_add_u32 s5, s20, 208896
    buffer_store_dwordx4 v[104:107], v16, s[40:43], s5 offen sc1
    v_mfma_f32_32x32x16_bf16 v[144:159], v[48:51], v[204:207], v[144:159]
    v_add_u32 v13, 0x4000, v13
    ds_read_b64_tr_b16 v[48:49], v13 offset:0
    ds_read_b64_tr_b16 v[50:51], v13 offset:512
    v_add_f32 v78, v78, v86
    v_cvt_pk_bf16_f32 v79, v78, v78
    v_and_b32 v79, 0xffff0000, v79
    s_waitcnt lgkmcnt(10)
    v_mfma_f32_32x32x16_bf16 v[160:175], v[52:55], v[200:203], v[160:175]
    v_sub_f32 v79, v78, v79
    v_cvt_pk_bf16_f32 v32, v78, v79
    v_and_b32 v84, 0xffff0000, v32
    v_sub_f32 v79, v79, v84
    v_cvt_pk_bf16_f32 v33, v79, 0
    v_mfma_f32_32x32x16_bf16 v[176:191], v[52:55], v[204:207], v[176:191]
    v_add_u32 v14, 0x4000, v14
    ds_read_b64_tr_b16 v[52:53], v14 offset:0
    ds_read_b64_tr_b16 v[54:55], v14 offset:512
    v_add_f32 v92, v92, v94
    v_mov_b32 v94, v92
    s_nop 1
    v_permlane32_swap_b32 v92, v94
    s_waitcnt lgkmcnt(10)
    v_mfma_f32_32x32x16_bf16 v[128:143], v[56:59], v[208:211], v[128:143]
    v_add_f32 v92, v92, v94
    v_add_f32 v92, v92, v100
    v_cvt_pk_bf16_f32 v93, v92, v92
    v_and_b32 v93, 0xffff0000, v93
    v_sub_f32 v93, v92, v93
    v_cvt_pk_bf16_f32 v34, v92, v93
    v_mfma_f32_32x32x16_bf16 v[144:159], v[56:59], v[212:215], v[144:159]
    ds_read_b64_tr_b16 v[56:57], v13 offset:2048
    ds_read_b64_tr_b16 v[58:59], v13 offset:2560
    v_and_b32 v94, 0xffff0000, v34
    v_sub_f32 v93, v93, v94
    v_cvt_pk_bf16_f32 v35, v93, 0
    s_and_b32 s4, s2, 7
    s_waitcnt lgkmcnt(10)
    v_mfma_f32_32x32x16_bf16 v[160:175], v[60:63], v[208:211], v[160:175]
    s_lshl_b32 s4, s4, 2
    s_add_u32 s4, s4, s64
    s_lshr_b32 s5, s2, 3
    s_mul_i32 s6, s4, 5
    s_add_u32 s6, s6, 1
    s_lshr_b32 s6, s6, 1
    v_mfma_f32_32x32x16_bf16 v[176:191], v[60:63], v[212:215], v[176:191]
    ds_read_b64_tr_b16 v[60:61], v14 offset:2048
    ds_read_b64_tr_b16 v[62:63], v14 offset:2560
    s_lshl_b32 s11, s6, 9
    s_and_b32 s10, s4, 1
    s_movk_i32 s8, 1024
    s_waitcnt lgkmcnt(10)
    v_mfma_f32_32x32x16_bf16 v[128:143], v[40:43], v[216:219], v[128:143]
    s_cmp_eq_u32 s10, 1
    s_cselect_b32 s8, 0xfffffe08, s8
    s_add_u32 s12, s11, s8
    s_lshl_b32 s9, s5, 1
    s_sub_u32 s9, s9, 8
    v_and_b32 v1, 31, v0
    v_mfma_f32_32x32x16_bf16 v[144:159], v[40:43], v[220:223], v[144:159]
    ds_read_b64_tr_b16 v[40:41], v13 offset:4096
    ds_read_b64_tr_b16 v[42:43], v13 offset:4608
    v_lshrrev_b32 v2, 5, v0
    v_lshlrev_b32 v3, 4, v1
    v_lshlrev_b32 v4, 4, v0
    v_bfe_u32 v5, v0, 2, 1
    s_waitcnt lgkmcnt(10)
    v_mfma_f32_32x32x16_bf16 v[160:175], v[44:47], v[216:219], v[160:175]
    v_bfe_u32 v6, v0, 3, 1
    v_lshl_or_b32 v5, v5, 1, v6
    v_and_b32 v6, 3, v0
    v_lshl_add_u32 v5, v5, 2, v6
    s_lshl_b32 s6, s10, 2
    v_add_u32 v5, s6, v5
    v_mfma_f32_32x32x16_bf16 v[176:191], v[44:47], v[220:223], v[176:191]
    ds_read_b64_tr_b16 v[44:45], v14 offset:4096
    ds_read_b64_tr_b16 v[46:47], v14 offset:4608
    s_lshl_b32 s6, s10, 4
    v_subrev_u32 v6, s6, v1
    v_cmp_gt_u32 vcc, 16, v1
    s_nop 1
    v_cndmask_b32 v5, v6, v5, vcc
    s_waitcnt lgkmcnt(10)
    v_mfma_f32_32x32x16_bf16 v[128:143], v[48:51], v[224:227], v[128:143]
    s_mul_i32 s13, s4, 20
    s_sub_u32 s6, 640, s13
    v_mov_b32 v6, s6
    v_cmp_gt_u32 vcc, 20, v1
    s_nop 1
    v_cndmask_b32 v5, v6, v5, vcc
    v_mul_u32_u24 v6, 10368, v2
    v_mfma_f32_32x32x16_bf16 v[144:159], v[48:51], v[228:231], v[144:159]
    ds_read_b64_tr_b16 v[48:49], v13 offset:6144
    ds_read_b64_tr_b16 v[50:51], v13 offset:6656
    v_lshl_add_u32 v5, v5, 4, v6
    s_lshl_b32 s13, s13, 4
    s_add_u32 s13, s13, 8388608
    v_and_b32 v6, 3, v0
    s_waitcnt lgkmcnt(10)
    v_mfma_f32_32x32x16_bf16 v[160:175], v[52:55], v[224:227], v[160:175]
    v_min_u32 v6, 2, v6
    s_lshr_b32 s6, s5, 1
    v_sub_u32 v6, s6, v6
    v_max_i32 v6, 0, v6
    s_and_b32 s6, s2, 7
    s_mul_i32 s6, s6, 80
    v_mfma_f32_32x32x16_bf16 v[176:191], v[52:55], v[228:231], v[176:191]
    ds_read_b64_tr_b16 v[52:53], v14 offset:6144
    ds_read_b64_tr_b16 v[54:55], v14 offset:6656
    v_bfe_u32 v8, v0, 2, 1
    v_mul_u32_u24 v8, 79, v8
    v_add_u32 v8, s6, v8
    v_lshrrev_b32 v8, 7, v8
    s_waitcnt lgkmcnt(10)
    v_mfma_f32_32x32x16_bf16 v[128:143], v[56:59], v[232:235], v[128:143]
    s_barrier
    v_bfe_u32 v9, v0, 3, 2
    v_mad_u32_u24 v8, v9, 5, v8
    v_min_u32 v8, 15, v8
    v_lshl_add_u32 v6, v6, 4, v8
    v_mfma_f32_32x32x16_bf16 v[144:159], v[56:59], v[236:239], v[144:159]
    v_add_u32 v15, 0xc000, v15
    ds_read_b64_tr_b16 v[56:57], v15 offset:0
    ds_read_b64_tr_b16 v[58:59], v15 offset:256
    v_lshlrev_b32 v7, 7, v6
    v_add_u32 v7, 32768, v7
    s_waitcnt lgkmcnt(10)
    v_mfma_f32_32x32x16_bf16 v[160:175], v[60:63], v[232:235], v[160:175]
    v_mfma_f32_32x32x16_bf16 v[176:191], v[60:63], v[236:239], v[176:191]
    ds_read_b64_tr_b16 v[60:61], v15 offset:1024
    ds_read_b64_tr_b16 v[62:63], v15 offset:1280
    s_waitcnt lgkmcnt(10)
    v_mfma_f32_32x32x16_bf16 v[128:143], v[40:43], v[240:243], v[128:143]
    v_mfma_f32_32x32x16_bf16 v[144:159], v[40:43], v[244:247], v[144:159]
    ds_read_b64_tr_b16 v[40:41], v15 offset:2048
    ds_read_b64_tr_b16 v[42:43], v15 offset:2304
    s_waitcnt lgkmcnt(10)
    v_mfma_f32_32x32x16_bf16 v[160:175], v[44:47], v[240:243], v[160:175]
    v_mfma_f32_32x32x16_bf16 v[176:191], v[44:47], v[244:247], v[176:191]
    ds_read_b64_tr_b16 v[44:45], v15 offset:3072
    ds_read_b64_tr_b16 v[46:47], v15 offset:3328
    s_waitcnt lgkmcnt(10)
    v_mfma_f32_32x32x16_bf16 v[128:143], v[48:51], v[248:251], v[128:143]
    v_mfma_f32_32x32x16_bf16 v[144:159], v[48:51], v[252:255], v[144:159]
    ds_read_b64_tr_b16 v[48:49], v15 offset:4096
    ds_read_b64_tr_b16 v[50:51], v15 offset:4352
    s_waitcnt lgkmcnt(10)
    v_mfma_f32_32x32x16_bf16 v[160:175], v[52:55], v[248:251], v[160:175]
    v_mfma_f32_32x32x16_bf16 v[176:191], v[52:55], v[252:255], v[176:191]
    ds_read_b64_tr_b16 v[52:53], v15 offset:5120
    ds_read_b64_tr_b16 v[54:55], v15 offset:5376
    s_waitcnt lgkmcnt(10)
    v_mfma_f32_32x32x16_bf16 v[64:79], v[56:59], a[0:3], 0
    v_mfma_f32_32x32x8_bf16 v[128:143], v[30:31], v[22:23], v[128:143]
    v_mfma_f32_32x32x8_bf16 v[144:159], v[30:31], v[24:25], v[144:159]
    v_mfma_f32_32x32x8_bf16 v[160:175], v[32:33], v[22:23], v[160:175]
    v_mfma_f32_32x32x8_bf16 v[176:191], v[32:33], v[24:25], v[176:191]
    s_add_u32 s76, s69, s3
    s_lshl_b32 s76, s76, 11
    s_add_u32 s78, s78, s76
    s_nop 5
    v_mul_f32 v128, v128, v20
    v_mul_f32 v129, v129, v20
    v_mul_f32 v130, v130, v20
    v_mfma_f32_32x32x16_bf16 v[80:95], v[56:59], a[4:7], 0
    ds_read_b64_tr_b16 v[56:57], v15 offset:6144
    ds_read_b64_tr_b16 v[58:59], v15 offset:6400
    v_mul_f32 v131, v131, v20
    v_exp_f32 v128, v128
    s_waitcnt lgkmcnt(10)
    v_mfma_f32_32x32x16_bf16 v[64:79], v[60:63], a[8:11], v[64:79]
    v_exp_f32 v129, v129
    v_exp_f32 v130, v130
    v_exp_f32 v131, v131
    v_mfma_f32_32x32x16_bf16 v[80:95], v[60:63], a[12:15], v[80:95]
    ds_read_b64_tr_b16 v[60:61], v15 offset:7168
    ds_read_b64_tr_b16 v[62:63], v15 offset:7424
    v_mul_f32 v136, v136, v18
    v_mul_f32 v137, v137, v18
    v_mul_f32 v138, v138, v18
    v_mul_f32 v139, v139, v18
    s_waitcnt lgkmcnt(10)
    v_mfma_f32_32x32x16_bf16 v[64:79], v[40:43], a[16:19], v[64:79]
    s_barrier
    v_add_f32 v128, 1.0, v128
    v_add_f32 v129, 1.0, v129
    v_add_f32 v130, 1.0, v130
    v_add_f32 v131, 1.0, v131
    v_mfma_f32_32x32x16_bf16 v[80:95], v[40:43], a[20:23], v[80:95]
    v_add_u32 v15, 0x4000, v15
    ds_read_b64_tr_b16 v[40:41], v15 offset:0
    ds_read_b64_tr_b16 v[42:43], v15 offset:256
    v_rcp_f32 v128, v128
    s_waitcnt lgkmcnt(10)
    v_mfma_f32_32x32x16_bf16 v[64:79], v[44:47], a[24:27], v[64:79]
    v_rcp_f32 v129, v129
    v_rcp_f32 v130, v130
    v_rcp_f32 v131, v131
    v_mfma_f32_32x32x16_bf16 v[80:95], v[44:47], a[28:31], v[80:95]
    ds_read_b64_tr_b16 v[44:45], v15 offset:1024
    ds_read_b64_tr_b16 v[46:47], v15 offset:1280
    s_nop 0
    v_mul_f32 v128, v128, v136
    v_mul_f32 v129, v129, v137
    v_mul_f32 v130, v130, v138
    s_waitcnt lgkmcnt(10)
    v_mfma_f32_32x32x16_bf16 v[64:79], v[48:51], a[32:35], v[64:79]
    v_mul_f32 v131, v131, v139
    v_mul_f32 v132, v132, v20
    v_mul_f32 v133, v133, v20
    v_mul_f32 v134, v134, v20
    v_mul_f32 v135, v135, v20
    v_mfma_f32_32x32x16_bf16 v[80:95], v[48:51], a[36:39], v[80:95]
    ds_read_b64_tr_b16 v[48:49], v15 offset:2048
    ds_read_b64_tr_b16 v[50:51], v15 offset:2304
    v_exp_f32 v132, v132
    v_exp_f32 v133, v133
    s_waitcnt lgkmcnt(10)
    v_mfma_f32_32x32x16_bf16 v[64:79], v[52:55], a[40:43], v[64:79]
    v_exp_f32 v134, v134
    v_exp_f32 v135, v135
    v_mul_f32 v140, v140, v18
    v_mul_f32 v141, v141, v18
    v_mfma_f32_32x32x16_bf16 v[80:95], v[52:55], a[44:47], v[80:95]
    ds_read_b64_tr_b16 v[52:53], v15 offset:3072
    ds_read_b64_tr_b16 v[54:55], v15 offset:3328
    v_mul_f32 v142, v142, v18
    v_mul_f32 v143, v143, v18
    v_add_f32 v132, 1.0, v132
    v_add_f32 v133, 1.0, v133
    s_waitcnt lgkmcnt(10)
    v_mfma_f32_32x32x16_bf16 v[64:79], v[56:59], a[48:51], v[64:79]
    v_add_f32 v134, 1.0, v134
    v_add_f32 v135, 1.0, v135
    v_rcp_f32 v132, v132
    v_rcp_f32 v133, v133
    v_mfma_f32_32x32x16_bf16 v[80:95], v[56:59], a[52:55], v[80:95]
    ds_read_b64_tr_b16 v[56:57], v15 offset:4096
    ds_read_b64_tr_b16 v[58:59], v15 offset:4352
    v_rcp_f32 v134, v134
    v_rcp_f32 v135, v135
    s_waitcnt lgkmcnt(10)
    v_mfma_f32_32x32x16_bf16 v[64:79], v[60:63], a[56:59], v[64:79]
    s_nop 0
    v_mul_f32 v132, v132, v140
    v_mul_f32 v133, v133, v141
    v_mul_f32 v134, v134, v142
    v_mul_f32 v135, v135, v143
    v_cvt_pk_bf16_f32 v128, v128, v129
    v_mfma_f32_32x32x16_bf16 v[80:95], v[60:63], a[60:63], v[80:95]
    ds_read_b64_tr_b16 v[60:61], v15 offset:5120
    ds_read_b64_tr_b16 v[62:63], v15 offset:5376
    v_cvt_pk_bf16_f32 v129, v130, v131
    v_cvt_pk_bf16_f32 v130, v132, v133
    v_cvt_pk_bf16_f32 v131, v134, v135
    s_waitcnt lgkmcnt(10)
    v_mfma_f32_32x32x16_bf16 v[64:79], v[40:43], a[64:67], v[64:79]
    s_add_u32 s76, s78, 0
    buffer_store_dwordx4 v[128:131], v16, s[40:43], s76 offen sc1
    buffer_load_dwordx2 v[10:11], v7, s[40:43], 0 offen sc1
    v_mul_f32 v144, v144, v21
    v_mfma_f32_32x32x16_bf16 v[80:95], v[40:43], a[68:71], v[80:95]
    ds_read_b64_tr_b16 v[40:41], v15 offset:6144
    ds_read_b64_tr_b16 v[42:43], v15 offset:6400
    v_mul_f32 v145, v145, v21
    v_mul_f32 v146, v146, v21
    v_mul_f32 v147, v147, v21
    s_waitcnt lgkmcnt(10)
    v_mfma_f32_32x32x16_bf16 v[64:79], v[44:47], a[72:75], v[64:79]
    v_exp_f32 v144, v144
    v_exp_f32 v145, v145
    v_exp_f32 v146, v146
    v_mfma_f32_32x32x16_bf16 v[80:95], v[44:47], a[76:79], v[80:95]
    ds_read_b64_tr_b16 v[44:45], v15 offset:7168
    ds_read_b64_tr_b16 v[46:47], v15 offset:7424
    v_exp_f32 v147, v147
    v_mul_f32 v152, v152, v19
    v_mul_f32 v153, v153, v19
    s_waitcnt lgkmcnt(10)
    v_mfma_f32_32x32x16_bf16 v[64:79], v[48:51], a[80:83], v[64:79]
    s_waitcnt vmcnt(2)
    s_barrier
    s_or_b32 s65, s100, 3
    v_mov_b32 v36, s65
    v_mov_b32 v37, s101
    s_lshl_b32 s65, s64, 25
    s_add_u32 s65, s65, s7
    v_lshlrev_b32 v38, 25, v0
    buffer_store_dwordx2 v[36:37], v38, s[40:43], s65 offen sc1
    v_mfma_f32_32x32x16_bf16 v[80:95], v[48:51], a[84:87], v[80:95]
    v_add_u32 v15, 0x4000, v15
    ds_read_b64_tr_b16 v[48:49], v15 offset:0
    ds_read_b64_tr_b16 v[50:51], v15 offset:256
    v_mul_f32 v154, v154, v19
    v_mul_f32 v155, v155, v19
    v_add_f32 v144, 1.0, v144
    s_waitcnt lgkmcnt(10)
    v_mfma_f32_32x32x16_bf16 v[64:79], v[52:55], a[88:91], v[64:79]
    v_add_f32 v145, 1.0, v145
    v_add_f32 v146, 1.0, v146
    v_add_f32 v147, 1.0, v147
    v_rcp_f32 v144, v144
    v_mfma_f32_32x32x16_bf16 v[80:95], v[52:55], a[92:95], v[80:95]
    ds_read_b64_tr_b16 v[52:53], v15 offset:1024
    ds_read_b64_tr_b16 v[54:55], v15 offset:1280
    v_rcp_f32 v145, v145
    v_rcp_f32 v146, v146
    s_waitcnt lgkmcnt(10)
    v_mfma_f32_32x32x16_bf16 v[64:79], v[56:59], a[96:99], v[64:79]
    v_rcp_f32 v147, v147
    s_nop 0
    v_mul_f32 v144, v144, v152
    v_mul_f32 v145, v145, v153
    v_mul_f32 v146, v146, v154
    v_mfma_f32_32x32x16_bf16 v[80:95], v[56:59], a[100:103], v[80:95]
    ds_read_b64_tr_b16 v[56:57], v15 offset:2048
    ds_read_b64_tr_b16 v[58:59], v15 offset:2304
    v_mul_f32 v147, v147, v155
    v_mul_f32 v148, v148, v21
    v_mul_f32 v149, v149, v21
    v_mul_f32 v150, v150, v21
    s_waitcnt lgkmcnt(10)
    v_mfma_f32_32x32x16_bf16 v[64:79], v[60:63], a[104:107], v[64:79]
    v_mul_f32 v151, v151, v21
    v_exp_f32 v148, v148
    v_exp_f32 v149, v149
    v_mfma_f32_32x32x16_bf16 v[80:95], v[60:63], a[108:111], v[80:95]
    ds_read_b64_tr_b16 v[60:61], v15 offset:3072
    ds_read_b64_tr_b16 v[62:63], v15 offset:3328
    v_exp_f32 v150, v150
    v_exp_f32 v151, v151
    s_waitcnt lgkmcnt(10)
    v_mfma_f32_32x32x16_bf16 v[64:79], v[40:43], a[112:115], v[64:79]
    v_mul_f32 v156, v156, v19
    v_mul_f32 v157, v157, v19
    v_mul_f32 v158, v158, v19
    v_mul_f32 v159, v159, v19
    v_add_f32 v148, 1.0, v148
    v_add_f32 v149, 1.0, v149
    v_mfma_f32_32x32x16_bf16 v[80:95], v[40:43], a[116:119], v[80:95]
    ds_read_b64_tr_b16 v[40:41], v15 offset:4096
    ds_read_b64_tr_b16 v[42:43], v15 offset:4352
    v_add_f32 v150, 1.0, v150
    v_add_f32 v151, 1.0, v151
    v_rcp_f32 v148, v148
    s_waitcnt lgkmcnt(10)
    v_mfma_f32_32x32x16_bf16 v[64:79], v[44:47], a[120:123], v[64:79]
    v_rcp_f32 v149, v149
    v_rcp_f32 v150, v150
    v_rcp_f32 v151, v151
    v_mfma_f32_32x32x16_bf16 v[80:95], v[44:47], a[124:127], v[80:95]
    ds_read_b64_tr_b16 v[44:45], v15 offset:5120
    ds_read_b64_tr_b16 v[46:47], v15 offset:5376
    s_nop 0
    v_mul_f32 v148, v148, v156
    v_mul_f32 v149, v149, v157
    v_mul_f32 v150, v150, v158
    s_waitcnt lgkmcnt(10)
    v_mfma_f32_32x32x16_bf16 v[64:79], v[48:51], a[128:131], v[64:79]
    v_mul_f32 v151, v151, v159
    v_cvt_pk_bf16_f32 v144, v144, v145
    v_cvt_pk_bf16_f32 v145, v146, v147
    v_cvt_pk_bf16_f32 v146, v148, v149
    v_cvt_pk_bf16_f32 v147, v150, v151
    v_mfma_f32_32x32x16_bf16 v[80:95], v[48:51], a[132:135], v[80:95]
    ds_read_b64_tr_b16 v[48:49], v15 offset:6144
    ds_read_b64_tr_b16 v[50:51], v15 offset:6400
    s_add_u32 s76, s78, 139264
    buffer_store_dwordx4 v[144:147], v16, s[40:43], s76 offen sc1
    s_waitcnt vmcnt(2)
    v_subrev_u32 v10, s100, v10
    v_subrev_u32 v10, 2, v10
    v_cmp_ne_u32 s[62:63], s101, v11
    v_cmp_lt_u32 vcc, 5, v10
    s_nop 0
    s_or_b64 vcc, vcc, s[62:63]
    s_cbranch_scc0 L_pok8
    s_mov_b32 s65, 0x80000
L_pl8:
    s_sleep 2
    buffer_load_dwordx2 v[10:11], v7, s[40:43], 0 offen sc1
    s_waitcnt vmcnt(0)
    v_subrev_u32 v10, s100, v10
    v_subrev_u32 v10, 2, v10
    v_cmp_ne_u32 s[62:63], s101, v11
    v_cmp_lt_u32 vcc, 5, v10
    s_nop 0
    s_or_b64 vcc, vcc, s[62:63]
    s_cbranch_scc0 L_pok8
    s_sub_u32 s65, s65, 1
    s_cbranch_scc0 L_pl8
L_pok8:
    s_waitcnt lgkmcnt(10)
    v_mfma_f32_32x32x16_bf16 v[64:79], v[52:55], a[136:139], v[64:79]
    s_sub_u32 s6, s12, s11
    s_add_u32 s6, s6, 512
    v_add_u32 v6, s6, v3
    v_mov_b32 v148, 0x3f80
    v_mov_b32 v149, 0
    v_mov_b32 v150, 0x3f80
    v_mfma_f32_32x32x16_bf16 v[80:95], v[52:55], a[140:143], v[80:95]
    ds_read_b64_tr_b16 v[52:53], v15 offset:7168
    ds_read_b64_tr_b16 v[54:55], v15 offset:7424
    v_mov_b32 v151, 0
    s_cmp_lt_i32 s9, 0
    s_cselect_b32 s6, 61769, 0
    v_mov_b32 v128, s6
    s_waitcnt lgkmcnt(10)
    v_mfma_f32_32x32x16_bf16 v[64:79], v[56:59], a[144:147], v[64:79]
    s_barrier
    v_mov_b32 v129, 0
    s_cmp_lt_i32 s9, -1
    s_cselect_b32 s6, 61769, 0
    v_mov_b32 v130, s6
    v_mfma_f32_32x32x16_bf16 v[80:95], v[56:59], a[148:151], v[80:95]
    v_add_u32 v15, 0x4000, v15
    ds_read_b64_tr_b16 v[56:57], v15 offset:0
    ds_read_b64_tr_b16 v[58:59], v15 offset:256
    v_mov_b32 v131, 0
    s_waitcnt lgkmcnt(10)
    v_mfma_f32_32x32x16_bf16 v[64:79], v[60:63], a[152:155], v[64:79]
    s_cmp_lt_i32 s9, -2
    s_cselect_b32 s6, 61769, 0
    v_mov_b32 v132, s6
    v_mov_b32 v133, 0
    v_mfma_f32_32x32x16_bf16 v[80:95], v[60:63], a[156:159], v[80:95]
    ds_read_b64_tr_b16 v[60:61], v15 offset:1024
    ds_read_b64_tr_b16 v[62:63], v15 offset:1280
    s_cmp_lt_i32 s9, -3
    s_cselect_b32 s6, 61769, 0
    v_mov_b32 v134, s6
    v_mov_b32 v135, 0
    s_waitcnt lgkmcnt(10)
    v_mfma_f32_32x32x16_bf16 v[64:79], v[40:43], a[160:163], v[64:79]
    s_cmp_lt_i32 s9, -4
    s_cselect_b32 s6, 61769, 0
    v_mov_b32 v136, s6
    v_mov_b32 v137, 0
    v_mfma_f32_32x32x16_bf16 v[80:95], v[40:43], a[164:167], v[80:95]
    ds_read_b64_tr_b16 v[40:41], v15 offset:2048
    ds_read_b64_tr_b16 v[42:43], v15 offset:2304
    s_cmp_lt_i32 s9, -5
    s_cselect_b32 s6, 61769, 0
    v_mov_b32 v138, s6
    v_mov_b32 v139, 0
    s_waitcnt lgkmcnt(10)
    v_mfma_f32_32x32x16_bf16 v[64:79], v[44:47], a[168:171], v[64:79]
    s_cmp_lt_i32 s9, -6
    s_cselect_b32 s6, 61769, 0
    v_mov_b32 v140, s6
    v_mov_b32 v141, 0
    v_mfma_f32_32x32x16_bf16 v[80:95], v[44:47], a[172:175], v[80:95]
    ds_read_b64_tr_b16 v[44:45], v15 offset:3072
    ds_read_b64_tr_b16 v[46:47], v15 offset:3328
    s_cmp_lt_i32 s9, -7
    s_cselect_b32 s6, 61769, 0
    v_mov_b32 v142, s6
    v_mov_b32 v143, 0
    s_waitcnt lgkmcnt(10)
    v_mfma_f32_32x32x16_bf16 v[64:79], v[48:51], a[176:179], v[64:79]
    v_mov_b32 v144, 0
    v_mov_b32 v145, 0
    v_mov_b32 v146, 0
    v_mov_b32 v147, 0
    v_mul_f32 v160, v160, v20
    v_mul_f32 v161, v161, v20
    v_mfma_f32_32x32x16_bf16 v[80:95], v[48:51], a[180:183], v[80:95]
    ds_read_b64_tr_b16 v[48:49], v15 offset:4096
    ds_read_b64_tr_b16 v[50:51], v15 offset:4352
    s_mul_i32 s14, s9, 81920
    s_add_u32 s8, s11, 1089536
    s_max_i32 s6, s14, 0
    s_add_u32 s70, s6, s8
    buffer_load_dwordx4 a[0:3], v4, s[40:43], s70 offen
    s_waitcnt lgkmcnt(10)
    v_mfma_f32_32x32x16_bf16 v[64:79], v[52:55], a[184:187], v[64:79]
    s_add_u32 s14, s14, 81920
    s_max_i32 s6, s14, 0
    s_add_u32 s71, s6, s8
    buffer_load_dwordx4 a[4:7], v4, s[40:43], s71 offen
    v_mul_f32 v162, v162, v20
    v_mfma_f32_32x32x16_bf16 v[80:95], v[52:55], a[188:191], v[80:95]
    ds_read_b64_tr_b16 v[52:53], v15 offset:5120
    ds_read_b64_tr_b16 v[54:55], v15 offset:5376
    s_add_u32 s14, s14, 81920
    s_max_i32 s6, s14, 0
    s_add_u32 s72, s6, s8
    buffer_load_dwordx4 a[8:11], v4, s[40:43], s72 offen
    s_waitcnt lgkmcnt(10)
    v_mfma_f32_32x32x16_bf16 v[64:79], v[56:59], a[192:195], v[64:79]
    s_add_u32 s14, s14, 81920
    s_max_i32 s6, s14, 0
    s_add_u32 s73, s6, s8
    buffer_load_dwordx4 a[12:15], v4, s[40:43], s73 offen
    v_mul_f32 v163, v163, v20
    v_mfma_f32_32x32x16_bf16 v[80:95], v[56:59], a[196:199], v[80:95]
    ds_read_b64_tr_b16 v[56:57], v15 offset:6144
    ds_read_b64_tr_b16 v[58:59], v15 offset:6400
    v_exp_f32 v160, v160
    v_exp_f32 v161, v161
    s_waitcnt lgkmcnt(10)
    v_mfma_f32_32x32x16_bf16 v[64:79], v[60:63], a[200:203], v[64:79]
    s_add_u32 s14, s14, 81920
    s_max_i32 s6, s14, 0
    s_add_u32 s0, s6, s8
    buffer_load_dwordx4 a[16:19], v4, s[40:43], s0 offen
    v_mfma_f32_32x32x16_bf16 v[80:95], v[60:63], a[204:207], v[80:95]
    ds_read_b64_tr_b16 v[60:61], v15 offset:7168
    ds_read_b64_tr_b16 v[62:63], v15 offset:7424
    v_exp_f32 v162, v162
    v_exp_f32 v163, v163
    s_waitcnt lgkmcnt(10)
    v_mfma_f32_32x32x16_bf16 v[64:79], v[40:43], a[208:211], v[64:79]
    s_barrier
    s_add_u32 s14, s14, 81920
    s_max_i32 s6, s14, 0
    s_add_u32 s1, s6, s8
    buffer_load_dwordx4 a[20:23], v4, s[40:43], s1 offen
    v_mfma_f32_32x32x16_bf16 v[80:95], v[40:43], a[212:215], v[80:95]
    v_add_u32 v15, 0x4000, v15
    ds_read_b64_tr_b16 v[40:41], v15 offset:0
    ds_read_b64_tr_b16 v[42:43], v15 offset:256
    v_mul_f32 v168, v168, v18
    v_mul_f32 v169, v169, v18
    v_mul_f32 v170, v170, v18
    s_waitcnt lgkmcnt(10)
    v_mfma_f32_32x32x16_bf16 v[64:79], v[44:47], a[216:219], v[64:79]
    s_add_u32 s14, s14, 81920
    s_max_i32 s6, s14, 0
    s_add_u32 s20, s6, s8
    buffer_load_dwordx4 a[24:27], v4, s[40:43], s20 offen
    v_mul_f32 v171, v171, v18
    v_mfma_f32_32x32x16_bf16 v[80:95], v[44:47], a[220:223], v[80:95]
    ds_read_b64_tr_b16 v[44:45], v15 offset:1024
    ds_read_b64_tr_b16 v[46:47], v15 offset:1280
    v_add_f32 v160, 1.0, v160
    v_add_f32 v161, 1.0, v161
    v_add_f32 v162, 1.0, v162
    v_add_f32 v163, 1.0, v163
    s_waitcnt lgkmcnt(10)
    v_mfma_f32_32x32x16_bf16 v[64:79], v[48:51], a[224:227], v[64:79]
    s_add_u32 s14, s14, 81920
    s_max_i32 s6, s14, 0
    s_add_u32 s21, s6, s8
    buffer_load_dwordx4 a[28:31], v4, s[40:43], s21 offen
    v_mfma_f32_32x32x16_bf16 v[80:95], v[48:51], a[228:231], v[80:95]
    ds_read_b64_tr_b16 v[48:49], v15 offset:2048
    ds_read_b64_tr_b16 v[50:51], v15 offset:2304
    s_add_u32 s14, s14, 81920
    s_max_i32 s6, s14, 0
    s_add_u32 s22, s6, s8
    buffer_load_dwordx4 a[32:35], v4, s[40:43], s22 offen
    s_waitcnt lgkmcnt(10)
    v_mfma_f32_32x32x16_bf16 v[64:79], v[52:55], a[232:235], v[64:79]
    v_rcp_f32 v160, v160
    v_rcp_f32 v161, v161
    v_rcp_f32 v162, v162
    v_mfma_f32_32x32x16_bf16 v[80:95], v[52:55], a[236:239], v[80:95]
    ds_read_b64_tr_b16 v[52:53], v15 offset:3072
    ds_read_b64_tr_b16 v[54:55], v15 offset:3328
    s_sub_u32 s6, s22, 40960
    buffer_load_dwordx4 a[120:123], v4, s[40:43], s6 offen
    s_waitcnt lgkmcnt(10)
    v_mfma_f32_32x32x16_bf16 v[64:79], v[56:59], a[240:243], v[64:79]
    v_rcp_f32 v163, v163
    s_nop 0
    v_mul_f32 v160, v160, v168
    v_mul_f32 v161, v161, v169
    v_mul_f32 v162, v162, v170
    v_mfma_f32_32x32x16_bf16 v[80:95], v[56:59], a[244:247], v[80:95]
    ds_read_b64_tr_b16 v[56:57], v15 offset:4096
    ds_read_b64_tr_b16 v[58:59], v15 offset:4352
    s_add_u32 s14, s14, 81920
    s_max_i32 s6, s14, 0
    s_add_u32 s23, s6, s8
    buffer_load_dwordx4 a[36:39], v4, s[40:43], s23 offen
    s_waitcnt lgkmcnt(10)
    v_mfma_f32_32x32x16_bf16 v[64:79], v[60:63], a[248:251], v[64:79]
    v_mul_f32 v163, v163, v171
    v_mul_f32 v164, v164, v20
    v_mul_f32 v165, v165, v20
    v_mul_f32 v166, v166, v20
    v_mul_f32 v167, v167, v20
    v_mfma_f32_32x32x16_bf16 v[80:95], v[60:63], a[252:255], v[80:95]
    ds_read_b64_tr_b16 v[60:61], v15 offset:5120
    ds_read_b64_tr_b16 v[62:63], v15 offset:5376
    s_sub_u32 s6, s23, 40960
    buffer_load_dwordx4 a[124:127], v4, s[40:43], s6 offen
    s_waitcnt lgkmcnt(10)
    v_mfma_f32_32x32x16_bf16 v[64:79], v[40:43], v[192:195], v[64:79]
    v_exp_f32 v164, v164
    v_exp_f32 v165, v165
    v_exp_f32 v166, v166
    v_mfma_f32_32x32x16_bf16 v[80:95], v[40:43], v[196:199], v[80:95]
    ds_read_b64_tr_b16 v[40:41], v15 offset:6144
    ds_read_b64_tr_b16 v[42:43], v15 offset:6400
    s_sub_u32 s6, s70, 512
    s_mov_b32 exec_hi, 0
    buffer_load_dwordx2 v[128:129], v6, s[40:43], s6 offen
    s_mov_b32 exec_hi, -1
    s_waitcnt lgkmcnt(10)
    v_mfma_f32_32x32x16_bf16 v[64:79], v[44:47], v[200:203], v[64:79]
    s_sub_u32 s6, s71, 512
    s_mov_b32 exec_hi, 0
    buffer_load_dwordx2 v[130:131], v6, s[40:43], s6 offen
    s_mov_b32 exec_hi, -1
    v_mfma_f32_32x32x16_bf16 v[80:95], v[44:47], v[204:207], v[80:95]
    ds_read_b64_tr_b16 v[44:45], v15 offset:7168
    ds_read_b64_tr_b16 v[46:47], v15 offset:7424
    s_sub_u32 s6, s72, 512
    s_mov_b32 exec_hi, 0
    buffer_load_dwordx2 v[132:133], v6, s[40:43], s6 offen
    s_mov_b32 exec_hi, -1
    s_waitcnt lgkmcnt(10)
    v_mfma_f32_32x32x16_bf16 v[64:79], v[48:51], v[208:211], v[64:79]
    s_sub_u32 s6, s73, 512
    s_mov_b32 exec_hi, 0
    buffer_load_dwordx2 v[134:135], v6, s[40:43], s6 offen
    s_mov_b32 exec_hi, -1
    v_mfma_f32_32x32x16_bf16 v[80:95], v[48:51], v[212:215], v[80:95]
    s_sub_u32 s6, s0, 512
    s_mov_b32 exec_hi, 0
    buffer_load_dwordx2 v[136:137], v6, s[40:43], s6 offen
    s_mov_b32 exec_hi, -1
    s_waitcnt lgkmcnt(8)
    v_mfma_f32_32x32x16_bf16 v[64:79], v[52:55], v[216:219], v[64:79]
    s_sub_u32 s6, s1, 512
    s_mov_b32 exec_hi, 0
    buffer_load_dwordx2 v[138:139], v6, s[40:43], s6 offen
    s_mov_b32 exec_hi, -1
    v_mfma_f32_32x32x16_bf16 v[80:95], v[52:55], v[220:223], v[80:95]
    s_sub_u32 s6, s20, 512
    s_mov_b32 exec_hi, 0
    buffer_load_dwordx2 v[140:141], v6, s[40:43], s6 offen
    s_mov_b32 exec_hi, -1
    s_waitcnt lgkmcnt(6)
    v_mfma_f32_32x32x16_bf16 v[64:79], v[56:59], v[224:227], v[64:79]
    s_sub_u32 s6, s21, 512
    s_mov_b32 exec_hi, 0
    buffer_load_dwordx2 v[142:143], v6, s[40:43], s6 offen
    s_mov_b32 exec_hi, -1
    v_mfma_f32_32x32x16_bf16 v[80:95], v[56:59], v[228:231], v[80:95]
    s_sub_u32 s6, s22, 512
    s_mov_b32 exec_hi, 0
    buffer_load_dwordx2 v[144:145], v6, s[40:43], s6 offen
    s_sub_u32 s6, s6, 40960
    buffer_load_dwordx2 v[148:149], v6, s[40:43], s6 offen
    s_mov_b32 exec_hi, -1
    s_waitcnt lgkmcnt(4)
    v_mfma_f32_32x32x16_bf16 v[64:79], v[60:63], v[232:235], v[64:79]
    s_sub_u32 s6, s23, 512
    s_mov_b32 exec_hi, 0
    buffer_load_dwordx2 v[146:147], v6, s[40:43], s6 offen
    s_sub_u32 s6, s6, 40960
    buffer_load_dwordx2 v[150:151], v6, s[40:43], s6 offen
    s_mov_b32 exec_hi, -1
    v_mfma_f32_32x32x16_bf16 v[80:95], v[60:63], v[236:239], v[80:95]
    s_mul_i32 s15, s9, 41472
    s_max_i32 s6, s15, 0
    s_add_u32 s6, s6, s13
    buffer_load_dwordx4 a[40:43], v5, s[40:43], s6 offen
    s_waitcnt lgkmcnt(2)
    v_mfma_f32_32x32x16_bf16 v[64:79], v[40:43], v[240:243], v[64:79]
    v_exp_f32 v167, v167
    v_mul_f32 v172, v172, v18
    v_mul_f32 v173, v173, v18
    v_mul_f32 v174, v174, v18
    v_mul_f32 v175, v175, v18
    v_mfma_f32_32x32x16_bf16 v[80:95], v[40:43], v[244:247], v[80:95]
    s_add_u32 s6, s6, 20736
    buffer_load_dwordx4 a[44:47], v5, s[40:43], s6 offen
    v_add_f32 v164, 1.0, v164
    v_add_f32 v165, 1.0, v165
    v_add_f32 v166, 1.0, v166
    s_waitcnt lgkmcnt(0)
    v_mfma_f32_32x32x16_bf16 v[64:79], v[44:47], v[248:251], v[64:79]
    v_add_f32 v167, 1.0, v167
    v_rcp_f32 v164, v164
    v_rcp_f32 v165, v165
    v_mfma_f32_32x32x16_bf16 v[80:95], v[44:47], v[252:255], v[80:95]
    s_add_u32 s15, s15, 41472
    s_max_i32 s6, s15, 0
    s_add_u32 s6, s6, s13
    buffer_load_dwordx4 a[48:51], v5, s[40:43], s6 offen
    v_rcp_f32 v166, v166
    v_rcp_f32 v167, v167
    s_nop 0
    v_mul_f32 v164, v164, v172
    v_mul_f32 v165, v165, v173
    v_mul_f32 v166, v166, v174
    v_mul_f32 v167, v167, v175
    v_cvt_pk_bf16_f32 v160, v160, v161
    v_cvt_pk_bf16_f32 v161, v162, v163
    v_cvt_pk_bf16_f32 v162, v164, v165
    v_cvt_pk_bf16_f32 v163, v166, v167
    s_add_u32 s76, s78, 1024
    buffer_store_dwordx4 v[160:163], v16, s[40:43], s76 offen sc1
    v_mul_f32 v176, v176, v21
    v_mul_f32 v177, v177, v21
    v_mul_f32 v178, v178, v21
    v_mul_f32 v179, v179, v21
    v_exp_f32 v176, v176
    v_exp_f32 v177, v177
    v_exp_f32 v178, v178
    v_exp_f32 v179, v179
    v_mul_f32 v184, v184, v19
    v_mul_f32 v185, v185, v19
    v_mul_f32 v186, v186, v19
    v_mul_f32 v187, v187, v19
    v_add_f32 v176, 1.0, v176
    v_add_f32 v177, 1.0, v177
    v_add_f32 v178, 1.0, v178
    v_add_f32 v179, 1.0, v179
    v_rcp_f32 v176, v176
    v_rcp_f32 v177, v177
    v_rcp_f32 v178, v178
    v_rcp_f32 v179, v179
    s_nop 0
    v_mul_f32 v176, v176, v184
    v_mul_f32 v177, v177, v185
    v_mul_f32 v178, v178, v186
    v_mul_f32 v179, v179, v187
    v_mul_f32 v180, v180, v21
    v_mul_f32 v181, v181, v21
    v_mul_f32 v182, v182, v21
    v_mul_f32 v183, v183, v21
    v_exp_f32 v180, v180
    v_exp_f32 v181, v181
    v_exp_f32 v182, v182
    v_exp_f32 v183, v183
    v_mul_f32 v188, v188, v19
    v_mul_f32 v189, v189, v19
    v_mul_f32 v190, v190, v19
    v_mul_f32 v191, v191, v19
    v_add_f32 v180, 1.0, v180
    v_add_f32 v181, 1.0, v181
    v_add_f32 v182, 1.0, v182
    v_add_f32 v183, 1.0, v183
    v_rcp_f32 v180, v180
    v_rcp_f32 v181, v181
    v_rcp_f32 v182, v182
    v_rcp_f32 v183, v183
    s_nop 0
    v_mul_f32 v180, v180, v188
    v_mul_f32 v181, v181, v189
    v_mul_f32 v182, v182, v190
    v_mul_f32 v183, v183, v191
    v_cvt_pk_bf16_f32 v176, v176, v177
    v_cvt_pk_bf16_f32 v177, v178, v179
    v_cvt_pk_bf16_f32 v178, v180, v181
    v_cvt_pk_bf16_f32 v179, v182, v183
    s_add_u32 s76, s78, 140288
    buffer_store_dwordx4 v[176:179], v16, s[40:43], s76 offen sc1
    s_lshl_b32 s76, s69, 10
    s_sub_u32 s78, s78, s76
    s_mul_i32 s76, s3, 6144
    s_sub_u32 s78, s78, s76
    v_mfma_f32_32x32x8_bf16 v[64:79], v[34:35], v[22:23], v[64:79]
    v_mfma_f32_32x32x8_bf16 v[80:95], v[34:35], v[24:25], v[80:95]
    s_add_u32 s6, s6, 20736
    buffer_load_dwordx4 a[52:55], v5, s[40:43], s6 offen
    s_add_u32 s15, s15, 41472
    s_max_i32 s6, s15, 0
    s_add_u32 s6, s6, s13
    buffer_load_dwordx4 a[56:59], v5, s[40:43], s6 offen
    s_add_u32 s6, s6, 20736
    buffer_load_dwordx4 a[60:63], v5, s[40:43], s6 offen
    s_add_u32 s15, s15, 41472
    s_max_i32 s6, s15, 0
    s_add_u32 s6, s6, s13
    buffer_load_dwordx4 a[64:67], v5, s[40:43], s6 offen
    s_add_u32 s6, s6, 20736
    buffer_load_dwordx4 a[68:71], v5, s[40:43], s6 offen
    s_add_u32 s15, s15, 41472
    s_max_i32 s6, s15, 0
    s_add_u32 s6, s6, s13
    buffer_load_dwordx4 a[72:75], v5, s[40:43], s6 offen
    s_add_u32 s6, s6, 20736
    buffer_load_dwordx4 a[76:79], v5, s[40:43], s6 offen
    s_add_u32 s15, s15, 41472
    s_max_i32 s6, s15, 0
    s_add_u32 s6, s6, s13
    buffer_load_dwordx4 a[80:83], v5, s[40:43], s6 offen
    s_add_u32 s6, s6, 20736
    buffer_load_dwordx4 a[84:87], v5, s[40:43], s6 offen
    s_add_u32 s15, s15, 41472
    s_max_i32 s6, s15, 0
    s_add_u32 s6, s6, s13
    buffer_load_dwordx4 a[88:91], v5, s[40:43], s6 offen
    s_add_u32 s6, s6, 20736
    buffer_load_dwordx4 a[92:95], v5, s[40:43], s6 offen
    s_add_u32 s15, s15, 41472
    s_max_i32 s6, s15, 0
    s_add_u32 s6, s6, s13
    buffer_load_dwordx4 a[96:99], v5, s[40:43], s6 offen
    s_add_u32 s6, s6, 20736
    buffer_load_dwordx4 a[100:103], v5, s[40:43], s6 offen
    s_add_u32 s15, s15, 41472
    s_max_i32 s6, s15, 0
    s_add_u32 s6, s6, s13
    buffer_load_dwordx4 a[104:107], v5, s[40:43], s6 offen
    s_add_u32 s6, s6, 20736
    buffer_load_dwordx4 a[108:111], v5, s[40:43], s6 offen
    s_add_u32 s15, s15, 41472
    s_max_i32 s6, s15, 0
    s_add_u32 s6, s6, s13
    buffer_load_dwordx4 a[112:115], v5, s[40:43], s6 offen
    s_add_u32 s6, s6, 20736
    buffer_load_dwordx4 a[116:119], v5, s[40:43], s6 offen
    s_bfe_u32 s18, s2, 0x20001
    s_lshl_b32 s18, s18, 3
    s_bfe_u32 s19, s2, 0x30003
    s_add_u32 s16, s18, s19
    s_and_b32 s18, s2, 1
    s_lshl_b32 s18, s18, 2
    s_lshr_b32 s19, s2, 6
    s_add_u32 s17, s18, s19
    s_mul_i32 s18, s17, 80
    v_lshrrev_b32 v12, 5, v0
    v_mul_u32_u24 v12, 79, v12
    v_add_u32 v12, s18, v12
    v_lshrrev_b32 v12, 6, v12
    v_and_b32 v13, 31, v0
    v_min_u32 v13, 16, v13
    v_mad_u32_u24 v12, v12, 17, v13
    v_lshlrev_b32 v188, 7, v12
    v_add_u32 v188, 32768, v188
    v_lshlrev_b32 v184, 4, v0
    s_mul_i32 s18, s17, 348160
    s_add_u32 s18, s18, 22020096
    s_mul_i32 s21, s64, 12288
    s_add_u32 s21, s21, s18
    s_mul_i32 s22, s64, 5120
    s_add_u32 s22, s22, s18
    s_add_u32 s22, s22, 49152
    s_mul_i32 s23, s64, 40960
    v_add_u32 v186, s23, v184
    v_and_b32 v12, 15, v0
    v_lshrrev_b32 v13, 4, v0
    v_lshlrev_b32 v185, 9, v13
    v_lshl_add_u32 v185, v12, 4, v185
    s_mul_i32 s20, s16, 278528
    s_add_u32 s20, s20, 12582912
    s_and_b32 s71, s17, 3
    s_mul_i32 s71, s71, 3
    s_and_b32 s18, s16, 7
    s_add_u32 s71, s71, s18
    s_cmp_ge_u32 s71, 12
    s_cselect_b32 s18, 12, 0
    s_sub_u32 s71, s71, s18
    s_lshl_b32 s18, s71, 10
    s_add_u32 s21, s21, s18
    s_sub_u32 s67, s21, 12288
    s_mul_i32 s68, s64, 24576
    s_add_u32 s68, s68, s20
    s_lshl_b32 s18, s71, 11
    s_add_u32 s68, s68, s18
    s_sub_u32 s69, s68, 24576
    s_mul_i32 s70, s64, 10240
    s_add_u32 s70, s70, s20
    s_add_u32 s70, s70, 98304
    s_lshr_b32 s18, s16, 1
    s_lshl_b32 s18, s18, 11
    s_add_u32 s18, s18, 32768
    v_lshl_add_u32 v187, v12, 7, s18
    buffer_load_dwordx2 v[12:13], v188, s[40:43], 0 offen sc1
    v_mul_f32 v64, v64, v20
    v_mul_f32 v65, v65, v20
    v_mul_f32 v66, v66, v20
    v_mul_f32 v67, v67, v20
    v_exp_f32 v64, v64
    v_exp_f32 v65, v65
    v_exp_f32 v66, v66
    v_exp_f32 v67, v67
    v_mul_f32 v72, v72, v18
    v_mul_f32 v73, v73, v18
    v_mul_f32 v74, v74, v18
    v_mul_f32 v75, v75, v18
    v_add_f32 v64, 1.0, v64
    v_add_f32 v65, 1.0, v65
    v_add_f32 v66, 1.0, v66
    v_add_f32 v67, 1.0, v67
    v_rcp_f32 v64, v64
    v_rcp_f32 v65, v65
    v_rcp_f32 v66, v66
    v_rcp_f32 v67, v67
    s_nop 0
    v_mul_f32 v64, v64, v72
    v_mul_f32 v65, v65, v73
    v_mul_f32 v66, v66, v74
    v_mul_f32 v67, v67, v75
    v_mul_f32 v68, v68, v20
    v_mul_f32 v69, v69, v20
    v_mul_f32 v70, v70, v20
    v_mul_f32 v71, v71, v20
    v_exp_f32 v68, v68
    v_exp_f32 v69, v69
    v_exp_f32 v70, v70
    v_exp_f32 v71, v71
    v_mul_f32 v76, v76, v18
    v_mul_f32 v77, v77, v18
    v_mul_f32 v78, v78, v18
    v_mul_f32 v79, v79, v18
    v_add_f32 v68, 1.0, v68
    v_add_f32 v69, 1.0, v69
    v_add_f32 v70, 1.0, v70
    v_add_f32 v71, 1.0, v71
    v_rcp_f32 v68, v68
    v_rcp_f32 v69, v69
    v_rcp_f32 v70, v70
    v_rcp_f32 v71, v71
    s_nop 0
    v_mul_f32 v68, v68, v76
    v_mul_f32 v69, v69, v77
    v_mul_f32 v70, v70, v78
    v_mul_f32 v71, v71, v79
    v_cvt_pk_bf16_f32 v64, v64, v65
    v_cvt_pk_bf16_f32 v65, v66, v67
    v_cvt_pk_bf16_f32 v66, v68, v69
    v_cvt_pk_bf16_f32 v67, v70, v71
    s_add_u32 s76, s78, 4096
    buffer_store_dwordx4 v[64:67], v16, s[40:43], s76 offen sc1
    v_mul_f32 v80, v80, v21
    v_mul_f32 v81, v81, v21
    v_mul_f32 v82, v82, v21
    v_mul_f32 v83, v83, v21
    v_exp_f32 v80, v80
    v_exp_f32 v81, v81
    v_exp_f32 v82, v82
    v_exp_f32 v83, v83
    v_mul_f32 v88, v88, v19
    v_mul_f32 v89, v89, v19
    v_mul_f32 v90, v90, v19
    v_mul_f32 v91, v91, v19
    v_add_f32 v80, 1.0, v80
    v_add_f32 v81, 1.0, v81
    v_add_f32 v82, 1.0, v82
    v_add_f32 v83, 1.0, v83
    v_rcp_f32 v80, v80
    v_rcp_f32 v81, v81
    v_rcp_f32 v82, v82
    v_rcp_f32 v83, v83
    s_nop 0
    v_mul_f32 v80, v80, v88
    v_mul_f32 v81, v81, v89
    v_mul_f32 v82, v82, v90
    v_mul_f32 v83, v83, v91
    v_mul_f32 v84, v84, v21
    v_mul_f32 v85, v85, v21
    v_mul_f32 v86, v86, v21
    v_mul_f32 v87, v87, v21
    v_exp_f32 v84, v84
    v_exp_f32 v85, v85
    v_exp_f32 v86, v86
    v_exp_f32 v87, v87
    v_mul_f32 v92, v92, v19
    v_mul_f32 v93, v93, v19
    v_mul_f32 v94, v94, v19
    v_mul_f32 v95, v95, v19
    v_add_f32 v84, 1.0, v84
    v_add_f32 v85, 1.0, v85
    v_add_f32 v86, 1.0, v86
    v_add_f32 v87, 1.0, v87
    v_rcp_f32 v84, v84
    v_rcp_f32 v85, v85
    v_rcp_f32 v86, v86
    v_rcp_f32 v87, v87
    s_nop 0
    v_mul_f32 v84, v84, v92
    v_mul_f32 v85, v85, v93
    v_mul_f32 v86, v86, v94
    v_mul_f32 v87, v87, v95
    v_cvt_pk_bf16_f32 v80, v80, v81
    v_cvt_pk_bf16_f32 v81, v82, v83
    v_cvt_pk_bf16_f32 v82, v84, v85
    v_cvt_pk_bf16_f32 v83, v86, v87
    s_add_u32 s76, s78, 143360
    buffer_store_dwordx4 v[80:83], v16, s[40:43], s76 offen sc1
L_g1_join:
    v_lshlrev_b32 v6, 2, v2
    v_sub_u32 v6, v1, v6
    v_mov_b32 v7, 0xf149f2ca
    v_cmp_le_i32 vcc, 0, v6
    v_cmp_le_i32 s[14:15], 1, v6
    s_nop 0
    v_cndmask_b32 v152, v7, 0, vcc
    v_cndmask_b32 v168, 0, v7, vcc
    v_cndmask_b32 v153, v7, 0, s[14:15]
    v_cndmask_b32 v169, 0, v7, s[14:15]
    v_cmp_le_i32 vcc, 2, v6
    v_cmp_le_i32 s[14:15], 3, v6
    s_nop 0
    v_cndmask_b32 v154, v7, 0, vcc
    v_cndmask_b32 v170, 0, v7, vcc
    v_cndmask_b32 v155, v7, 0, s[14:15]
    v_cndmask_b32 v171, 0, v7, s[14:15]
    s_waitcnt vmcnt(25)
    v_mfma_f32_32x32x16_bf16 v[64:79], a[4:7], a[120:123], 0
    v_cmp_le_i32 vcc, 8, v6
    v_cmp_le_i32 s[14:15], 9, v6
    s_nop 0
    v_cndmask_b32 v156, v7, 0, vcc
    v_cndmask_b32 v172, 0, v7, vcc
    v_cndmask_b32 v157, v7, 0, s[14:15]
    v_cndmask_b32 v173, 0, v7, s[14:15]
    v_mfma_f32_32x32x8_bf16 v[64:79], v[130:131], v[148:149], v[64:79]
    v_cmp_le_i32 vcc, 10, v6
    v_cmp_le_i32 s[14:15], 11, v6
    s_nop 0
    v_cndmask_b32 v158, v7, 0, vcc
    v_cndmask_b32 v174, 0, v7, vcc
    v_cndmask_b32 v159, v7, 0, s[14:15]
    v_cndmask_b32 v175, 0, v7, s[14:15]
    v_mfma_f32_32x32x16_bf16 v[80:95], a[8:11], a[120:123], 0
    v_cmp_le_i32 vcc, 16, v6
    v_cmp_le_i32 s[14:15], 17, v6
    s_nop 0
    v_cndmask_b32 v160, v7, 0, vcc
    v_cndmask_b32 v176, 0, v7, vcc
    v_cndmask_b32 v161, v7, 0, s[14:15]
    v_cndmask_b32 v177, 0, v7, s[14:15]
    v_mfma_f32_32x32x8_bf16 v[80:95], v[132:133], v[148:149], v[80:95]
    v_cmp_le_i32 vcc, 18, v6
    v_cmp_le_i32 s[14:15], 19, v6
    s_nop 0
    v_cndmask_b32 v162, v7, 0, vcc
    v_cndmask_b32 v178, 0, v7, vcc
    v_cndmask_b32 v163, v7, 0, s[14:15]
    v_cndmask_b32 v179, 0, v7, s[14:15]
    v_mfma_f32_32x32x16_bf16 v[96:111], a[12:15], a[120:123], 0
    v_cmp_le_i32 vcc, 24, v6
    v_cmp_le_i32 s[14:15], 25, v6
    s_nop 0
    v_cndmask_b32 v164, v7, 0, vcc
    v_cndmask_b32 v180, 0, v7, vcc
    v_cndmask_b32 v165, v7, 0, s[14:15]
    v_cndmask_b32 v181, 0, v7, s[14:15]
    v_mfma_f32_32x32x8_bf16 v[96:111], v[134:135], v[148:149], v[96:111]
    v_cmp_le_i32 vcc, 26, v6
    v_cmp_le_i32 s[14:15], 27, v6
    s_nop 0
    v_cndmask_b32 v166, v7, 0, vcc
    v_cndmask_b32 v182, 0, v7, vcc
    v_cndmask_b32 v167, v7, 0, s[14:15]
    v_cndmask_b32 v183, 0, v7, s[14:15]
    v_max3_f32 v8, v64, v65, v66
    v_max_f32 v8, v8, v67
    v_max3_f32 v8, v8, v68, v69
    v_max3_f32 v8, v8, v70, v71
    v_max3_f32 v8, v8, v72, v73
    v_max3_f32 v8, v8, v74, v75
    v_max3_f32 v8, v8, v76, v77
    v_max3_f32 v8, v8, v78, v79
    v_mfma_f32_32x32x16_bf16 v[112:127], a[16:19], a[120:123], 0
    s_barrier
    s_waitcnt vmcnt(2)
    v_subrev_u32 v12, s100, v12
    v_subrev_u32 v12, 3, v12
    v_cmp_ne_u32 s[62:63], s101, v13
    v_cmp_lt_u32 vcc, 4, v12
    s_nop 0
    s_or_b64 vcc, vcc, s[62:63]
    s_cbranch_scc0 L_pok9
    s_mov_b32 s65, 0x80000
L_pl9:
    s_sleep 2
    buffer_load_dwordx2 v[12:13], v188, s[40:43], 0 offen sc1
    s_waitcnt vmcnt(0)
    v_subrev_u32 v12, s100, v12
    v_subrev_u32 v12, 3, v12
    v_cmp_ne_u32 s[62:63], s101, v13
    v_cmp_lt_u32 vcc, 4, v12
    s_nop 0
    s_or_b64 vcc, vcc, s[62:63]
    s_cbranch_scc0 L_pok9
    s_sub_u32 s65, s65, 1
    s_cbranch_scc0 L_pl9
L_pok9:
    s_mov_b32 s72, s21
    s_add_u32 m0, s23, 0
    s_add_u32 s18, s72, 0
    buffer_load_dwordx4 v184, s[40:43], s18 offen lds
    v_max3_f32 v8, v8, v80, v81
    v_max3_f32 v8, v8, v82, v83
    v_max3_f32 v8, v8, v84, v85
    v_max3_f32 v8, v8, v86, v87
    v_mfma_f32_32x32x8_bf16 v[112:127], v[136:137], v[148:149], v[112:127]
    v_max3_f32 v8, v8, v88, v89
    v_max3_f32 v8, v8, v90, v91
    v_max3_f32 v8, v8, v92, v93
    v_max3_f32 v8, v8, v94, v95
    v_mfma_f32_32x32x16_bf16 v[64:79], a[20:23], a[120:123], 0
    v_max3_f32 v8, v8, v96, v97
    v_max3_f32 v8, v8, v98, v99
    v_max3_f32 v8, v8, v100, v101
    v_max3_f32 v8, v8, v102, v103
    s_add_u32 m0, s23, 1024
    s_add_u32 s18, s72, 69632
    buffer_load_dwordx4 v184, s[40:43], s18 offen lds
    v_mfma_f32_32x32x8_bf16 v[64:79], v[138:139], v[148:149], v[64:79]
    v_max3_f32 v8, v8, v104, v105
    v_max3_f32 v8, v8, v106, v107
    v_max3_f32 v8, v8, v108, v109
    v_max3_f32 v8, v8, v110, v111
    v_mfma_f32_32x32x16_bf16 v[80:95], a[24:27], a[120:123], 0
    v_max3_f32 v8, v8, v112, v113
    v_max3_f32 v8, v8, v114, v115
    v_max3_f32 v8, v8, v116, v117
    v_max3_f32 v8, v8, v118, v119
    v_mfma_f32_32x32x8_bf16 v[80:95], v[140:141], v[148:149], v[80:95]
    v_max3_f32 v8, v8, v120, v121
    v_max3_f32 v8, v8, v122, v123
    s_add_u32 m0, s23, 2048
    s_add_u32 s18, s72, 139264
    buffer_load_dwordx4 v184, s[40:43], s18 offen lds
    v_max3_f32 v8, v8, v124, v125
    v_max3_f32 v8, v8, v126, v127
    v_mfma_f32_32x32x16_bf16 v[96:111], a[28:31], a[120:123], 0
    v_max3_f32 v8, v8, v64, v65
    v_max3_f32 v8, v8, v66, v67
    v_max3_f32 v8, v8, v68, v69
    v_max3_f32 v8, v8, v70, v71
    v_mfma_f32_32x32x8_bf16 v[96:111], v[142:143], v[148:149], v[96:111]
    v_max3_f32 v8, v8, v72, v73
    v_max3_f32 v8, v8, v74, v75
    v_max3_f32 v8, v8, v76, v77
    v_max3_f32 v8, v8, v78, v79
    v_mfma_f32_32x32x16_bf16 v[112:127], a[0:3], a[120:123], v[168:183]
    s_add_u32 m0, s23, 3072
    s_add_u32 s18, s72, 208896
    buffer_load_dwordx4 v184, s[40:43], s18 offen lds
    v_max3_f32 v8, v8, v80, v81
    v_max3_f32 v8, v8, v82, v83
    v_max3_f32 v8, v8, v84, v85
    v_max3_f32 v8, v8, v86, v87
    v_mfma_f32_32x32x8_bf16 v[112:127], v[128:129], v[148:149], v[112:127]
    v_max3_f32 v8, v8, v88, v89
    v_max3_f32 v8, v8, v90, v91
    v_max3_f32 v8, v8, v92, v93
    v_max3_f32 v8, v8, v94, v95
    v_mfma_f32_32x32x16_bf16 v[64:79], a[32:35], a[120:123], v[152:167]
    v_max3_f32 v8, v8, v96, v97
    v_max3_f32 v8, v8, v98, v99
    v_max3_f32 v8, v8, v100, v101
    v_max3_f32 v8, v8, v102, v103
    s_add_u32 m0, s23, 4096
    s_add_u32 s18, s72, 278528
    buffer_load_dwordx4 v184, s[40:43], s18 offen lds
    v_mfma_f32_32x32x8_bf16 v[64:79], v[144:145], v[148:149], v[64:79]
    v_max3_f32 v8, v8, v104, v105
    v_max3_f32 v8, v8, v106, v107
    v_max3_f32 v8, v8, v108, v109
    v_max3_f32 v8, v8, v110, v111
    v_mfma_f32_32x32x16_bf16 v[80:95], a[4:7], a[124:127], v[168:183]
    v_max3_f32 v8, v8, v112, v113
    v_max3_f32 v8, v8, v114, v115
    v_max3_f32 v8, v8, v116, v117
    v_max3_f32 v8, v8, v118, v119
    v_mfma_f32_32x32x8_bf16 v[80:95], v[130:131], v[150:151], v[80:95]
    v_max3_f32 v8, v8, v120, v121
    v_max3_f32 v8, v8, v122, v123
    s_cmp_ge_u32 s71, 11
    s_cselect_b32 s72, s67, s21
    s_add_u32 m0, s23, 5120
    s_add_u32 s18, s72, 1024
    buffer_load_dwordx4 v184, s[40:43], s18 offen lds
    v_max3_f32 v8, v8, v124, v125
    v_max3_f32 v8, v8, v126, v127
    v_mfma_f32_32x32x16_bf16 v[96:111], a[8:11], a[124:127], 0
    v_max3_f32 v8, v8, v64, v65
    v_max3_f32 v8, v8, v66, v67
    v_max3_f32 v8, v8, v68, v69
    v_max3_f32 v8, v8, v70, v71
    v_mfma_f32_32x32x8_bf16 v[96:111], v[132:133], v[150:151], v[96:111]
    v_max3_f32 v8, v8, v72, v73
    v_max3_f32 v8, v8, v74, v75
    v_max3_f32 v8, v8, v76, v77
    v_max3_f32 v8, v8, v78, v79
    v_mfma_f32_32x32x16_bf16 v[112:127], a[12:15], a[124:127], 0
    s_add_u32 m0, s23, 6144
    s_add_u32 s18, s72, 70656
    buffer_load_dwordx4 v184, s[40:43], s18 offen lds
    v_max3_f32 v9, v80, v81, v82
    v_max_f32 v9, v9, v83
    v_max3_f32 v9, v9, v84, v85
    v_max3_f32 v9, v9, v86, v87
    v_max3_f32 v9, v9, v88, v89
    v_mfma_f32_32x32x8_bf16 v[112:127], v[134:135], v[150:151], v[112:127]
    v_max3_f32 v9, v9, v90, v91
    v_max3_f32 v9, v9, v92, v93
    v_max3_f32 v9, v9, v94, v95
    v_mov_b32 v10, v8
    s_nop 1
    v_permlane32_swap_b32 v8, v10
    v_max_f32 v8, v8, v10
    v_sub_f32 v32, v168, v8
    v_sub_f32 v33, v169, v8
    v_sub_f32 v34, v170, v8
    v_sub_f32 v35, v171, v8
    s_waitcnt vmcnt(7)
    s_barrier
    s_or_b32 s65, s100, 4
    v_mov_b32 v12, s65
    v_mov_b32 v13, s101
    s_lshl_b32 s65, s64, 25
    s_add_u32 s65, s65, s7
    v_lshlrev_b32 v14, 25, v0
    buffer_store_dwordx2 v[12:13], v14, s[40:43], s65 offen sc1
    v_sub_f32 v36, v172, v8
    v_sub_f32 v37, v173, v8
    v_sub_f32 v38, v174, v8
    v_sub_f32 v39, v175, v8
    v_sub_f32 v40, v176, v8
    s_add_u32 m0, s23, 7168
    s_add_u32 s18, s72, 140288
    buffer_load_dwordx4 v184, s[40:43], s18 offen lds
    v_sub_f32 v41, v177, v8
    v_sub_f32 v42, v178, v8
    v_sub_f32 v43, v179, v8
    v_sub_f32 v44, v180, v8
    v_sub_f32 v45, v181, v8
    v_sub_f32 v46, v182, v8
    v_sub_f32 v47, v183, v8
    v_sub_f32 v16, 0, v8
    v_sub_f32 v17, 0, v8
    v_sub_f32 v18, 0, v8
    v_sub_f32 v19, 0, v8
    v_sub_f32 v20, 0, v8
    v_sub_f32 v21, 0, v8
    v_sub_f32 v22, 0, v8
    v_sub_f32 v23, 0, v8
    v_sub_f32 v24, 0, v8
    v_sub_f32 v25, 0, v8
    v_sub_f32 v26, 0, v8
    s_add_u32 m0, s23, 8192
    s_add_u32 s18, s72, 209920
    buffer_load_dwordx4 v184, s[40:43], s18 offen lds
    v_sub_f32 v27, 0, v8
    v_sub_f32 v28, 0, v8
    v_sub_f32 v29, 0, v8
    v_sub_f32 v30, 0, v8
    v_sub_f32 v31, 0, v8
    v_mfma_f32_32x32x16_bf16 v[64:79], a[0:3], a[120:123], v[32:47]
    v_max3_f32 v9, v9, v96, v97
    v_max3_f32 v9, v9, v98, v99
    v_max3_f32 v9, v9, v100, v101
    v_max3_f32 v9, v9, v102, v103
    v_mfma_f32_32x32x8_bf16 v[64:79], v[128:129], v[148:149], v[64:79]
    v_max3_f32 v9, v9, v104, v105
    v_max3_f32 v9, v9, v106, v107
    v_max3_f32 v9, v9, v108, v109
    v_max3_f32 v9, v9, v110, v111
    s_add_u32 m0, s23, 9216
    s_add_u32 s18, s72, 279552
    buffer_load_dwordx4 v184, s[40:43], s18 offen lds
    v_mfma_f32_32x32x16_bf16 v[80:95], a[16:19], a[124:127], 0
    v_max3_f32 v9, v9, v112, v113
    v_max3_f32 v9, v9, v114, v115
    v_max3_f32 v9, v9, v116, v117
    v_max3_f32 v9, v9, v118, v119
    v_mfma_f32_32x32x8_bf16 v[80:95], v[136:137], v[150:151], v[80:95]
    v_max3_f32 v9, v9, v120, v121
    v_max3_f32 v9, v9, v122, v123
    v_max3_f32 v9, v9, v124, v125
    v_max3_f32 v9, v9, v126, v127
    v_mfma_f32_32x32x16_bf16 v[96:111], a[4:7], a[120:123], v[16:31]
    s_cmp_ge_u32 s71, 10
    s_cselect_b32 s72, s67, s21
    s_add_u32 m0, s23, 10240
    s_add_u32 s18, s72, 2048
    buffer_load_dwordx4 v184, s[40:43], s18 offen lds
    v_exp_f32 v64, v64
    v_exp_f32 v65, v65
    v_exp_f32 v66, v66
    v_exp_f32 v67, v67
    v_exp_f32 v68, v68
    v_exp_f32 v69, v69
    v_exp_f32 v70, v70
    v_exp_f32 v71, v71
    v_exp_f32 v72, v72
    s_add_u32 m0, s23, 11264
    s_add_u32 s18, s72, 71680
    buffer_load_dwordx4 v184, s[40:43], s18 offen lds
    v_cvt_pk_bf16_f32 v64, v64, v65
    v_exp_f32 v73, v73
    v_mfma_f32_32x32x8_bf16 v[96:111], v[130:131], v[148:149], v[96:111]
    v_cvt_pk_bf16_f32 v65, v66, v67
    v_exp_f32 v74, v74
    v_cvt_pk_bf16_f32 v66, v68, v69
    v_exp_f32 v75, v75
    v_cvt_pk_bf16_f32 v67, v70, v71
    v_exp_f32 v76, v76
    v_exp_f32 v77, v77
    v_exp_f32 v78, v78
    s_add_u32 m0, s23, 12288
    s_add_u32 s18, s72, 141312
    buffer_load_dwordx4 v184, s[40:43], s18 offen lds
    v_exp_f32 v79, v79
    v_cvt_pk_bf16_f32 v72, v72, v73
    v_cvt_pk_bf16_f32 v73, v74, v75
    v_cvt_pk_bf16_f32 v74, v76, v77
    v_cvt_pk_bf16_f32 v75, v78, v79
    v_mfma_f32_32x32x16_bf16 v[48:63], a[40:43], v[64:67], 0
    v_max3_f32 v9, v9, v80, v81
    v_max3_f32 v9, v9, v82, v83
    v_mfma_f32_32x32x16_bf16 v[48:63], a[44:47], v[72:75], v[48:63]
    v_max3_f32 v9, v9, v84, v85
    v_max3_f32 v9, v9, v86, v87
    v_mfma_f32_32x32x16_bf16 v[112:127], a[20:23], a[124:127], 0
    s_add_u32 m0, s23, 13312
    s_add_u32 s18, s72, 210944
    buffer_load_dwordx4 v184, s[40:43], s18 offen lds
    v_max3_f32 v9, v9, v88, v89
    v_max3_f32 v9, v9, v90, v91
    v_mfma_f32_32x32x8_bf16 v[112:127], v[138:139], v[150:151], v[112:127]
    v_max3_f32 v9, v9, v92, v93
    v_max3_f32 v9, v9, v94, v95
    v_mfma_f32_32x32x16_bf16 v[64:79], a[8:11], a[120:123], v[16:31]
    s_add_u32 m0, s23, 14336
    s_add_u32 s18, s72, 280576
    buffer_load_dwordx4 v184, s[40:43], s18 offen lds
    v_exp_f32 v96, v96
    v_exp_f32 v97, v97
    v_exp_f32 v98, v98
    v_exp_f32 v99, v99
    v_exp_f32 v100, v100
    v_exp_f32 v101, v101
    v_exp_f32 v102, v102
    v_exp_f32 v103, v103
    v_exp_f32 v104, v104
    s_cmp_ge_u32 s71, 9
    s_cselect_b32 s72, s67, s21
    s_add_u32 m0, s23, 15360
    s_add_u32 s18, s72, 3072
    buffer_load_dwordx4 v184, s[40:43], s18 offen lds
    v_cvt_pk_bf16_f32 v96, v96, v97
    v_exp_f32 v105, v105
    v_mfma_f32_32x32x8_bf16 v[64:79], v[132:133], v[148:149], v[64:79]
    v_cvt_pk_bf16_f32 v97, v98, v99
    v_exp_f32 v106, v106
    v_cvt_pk_bf16_f32 v98, v100, v101
    v_exp_f32 v107, v107
    v_cvt_pk_bf16_f32 v99, v102, v103
    v_exp_f32 v108, v108
    v_exp_f32 v109, v109
    v_exp_f32 v110, v110
    s_add_u32 m0, s23, 16384
    s_add_u32 s18, s72, 72704
    buffer_load_dwordx4 v184, s[40:43], s18 offen lds
    v_exp_f32 v111, v111
    v_cvt_pk_bf16_f32 v104, v104, v105
    v_cvt_pk_bf16_f32 v105, v106, v107
    v_cvt_pk_bf16_f32 v106, v108, v109
    v_cvt_pk_bf16_f32 v107, v110, v111
    v_mfma_f32_32x32x16_bf16 v[48:63], a[48:51], v[96:99], v[48:63]
    v_max3_f32 v9, v9, v112, v113
    v_max3_f32 v9, v9, v114, v115
    v_mfma_f32_32x32x16_bf16 v[48:63], a[52:55], v[104:107], v[48:63]
    v_max3_f32 v9, v9, v116, v117
    v_max3_f32 v9, v9, v118, v119
    v_mfma_f32_32x32x16_bf16 v[80:95], a[24:27], a[124:127], 0
    s_add_u32 m0, s23, 17408
    s_add_u32 s18, s72, 142336
    buffer_load_dwordx4 v184, s[40:43], s18 offen lds
    v_max3_f32 v9, v9, v120, v121
    v_max3_f32 v9, v9, v122, v123
    v_mfma_f32_32x32x8_bf16 v[80:95], v[140:141], v[150:151], v[80:95]
    v_max3_f32 v9, v9, v124, v125
    v_max3_f32 v9, v9, v126, v127
    v_mfma_f32_32x32x16_bf16 v[96:111], a[12:15], a[120:123], v[16:31]
    s_add_u32 m0, s23, 18432
    s_add_u32 s18, s72, 211968
    buffer_load_dwordx4 v184, s[40:43], s18 offen lds
    v_exp_f32 v64, v64
    v_exp_f32 v65, v65
    v_exp_f32 v66, v66
    v_exp_f32 v67, v67
    v_exp_f32 v68, v68
    v_exp_f32 v69, v69
    v_exp_f32 v70, v70
    v_exp_f32 v71, v71
    v_exp_f32 v72, v72
    s_add_u32 m0, s23, 19456
    s_add_u32 s18, s72, 281600
    buffer_load_dwordx4 v184, s[40:43], s18 offen lds
    v_cvt_pk_bf16_f32 v64, v64, v65
    v_exp_f32 v73, v73
    v_mfma_f32_32x32x8_bf16 v[96:111], v[134:135], v[148:149], v[96:111]
    v_cvt_pk_bf16_f32 v65, v66, v67
    v_exp_f32 v74, v74
    v_cvt_pk_bf16_f32 v66, v68, v69
    v_exp_f32 v75, v75
    v_cvt_pk_bf16_f32 v67, v70, v71
    v_exp_f32 v76, v76
    v_exp_f32 v77, v77
    v_exp_f32 v78, v78
    s_cmp_ge_u32 s71, 8
    s_cselect_b32 s72, s67, s21
    s_add_u32 m0, s23, 20480
    s_add_u32 s18, s72, 4096
    buffer_load_dwordx4 v184, s[40:43], s18 offen lds
    v_exp_f32 v79, v79
    v_cvt_pk_bf16_f32 v72, v72, v73
    v_cvt_pk_bf16_f32 v73, v74, v75
    v_cvt_pk_bf16_f32 v74, v76, v77
    v_cvt_pk_bf16_f32 v75, v78, v79
    v_mfma_f32_32x32x16_bf16 v[48:63], a[56:59], v[64:67], v[48:63]
    v_max3_f32 v9, v9, v80, v81
    v_max3_f32 v9, v9, v82, v83
    v_mfma_f32_32x32x16_bf16 v[48:63], a[60:63], v[72:75], v[48:63]
    v_max3_f32 v9, v9, v84, v85
    v_max3_f32 v9, v9, v86, v87
    v_mfma_f32_32x32x16_bf16 v[112:127], a[28:31], a[124:127], 0
    s_add_u32 m0, s23, 21504
    s_add_u32 s18, s72, 73728
    buffer_load_dwordx4 v184, s[40:43], s18 offen lds
    v_max3_f32 v9, v9, v88, v89
    v_max3_f32 v9, v9, v90, v91
    v_mfma_f32_32x32x8_bf16 v[112:127], v[142:143], v[150:151], v[112:127]
    v_max3_f32 v9, v9, v92, v93
    v_max3_f32 v9, v9, v94, v95
    v_mfma_f32_32x32x16_bf16 v[64:79], a[16:19], a[120:123], v[16:31]
    s_add_u32 m0, s23, 22528
    s_add_u32 s18, s72, 143360
    buffer_load_dwordx4 v184, s[40:43], s18 offen lds
    v_exp_f32 v96, v96
    v_exp_f32 v97, v97
    v_exp_f32 v98, v98
    v_exp_f32 v99, v99
    v_exp_f32 v100, v100
    v_exp_f32 v101, v101
    v_exp_f32 v102, v102
    v_exp_f32 v103, v103
    v_exp_f32 v104, v104
    s_add_u32 m0, s23, 23552
    s_add_u32 s18, s72, 212992
    buffer_load_dwordx4 v184, s[40:43], s18 offen lds
    v_cvt_pk_bf16_f32 v96, v96, v97
    v_exp_f32 v105, v105
    v_mfma_f32_32x32x8_bf16 v[64:79], v[136:137], v[148:149], v[64:79]
    v_cvt_pk_bf16_f32 v97, v98, v99
    v_exp_f32 v106, v106
    v_cvt_pk_bf16_f32 v98, v100, v101
    v_exp_f32 v107, v107
    v_cvt_pk_bf16_f32 v99, v102, v103
    v_exp_f32 v108, v108
    v_exp_f32 v109, v109
    v_exp_f32 v110, v110
    s_add_u32 m0, s23, 24576
    s_add_u32 s18, s72, 282624
    buffer_load_dwordx4 v184, s[40:43], s18 offen lds
    v_exp_f32 v111, v111
    v_cvt_pk_bf16_f32 v104, v104, v105
    v_cvt_pk_bf16_f32 v105, v106, v107
    v_cvt_pk_bf16_f32 v106, v108, v109
    v_cvt_pk_bf16_f32 v107, v110, v111
    v_mfma_f32_32x32x16_bf16 v[48:63], a[64:67], v[96:99], v[48:63]
    v_sub_f32 v32, v152, v8
    v_sub_f32 v33, v153, v8
    v_sub_f32 v34, v154, v8
    v_sub_f32 v35, v155, v8
    v_mfma_f32_32x32x16_bf16 v[48:63], a[68:71], v[104:107], v[48:63]
    v_sub_f32 v36, v156, v8
    v_sub_f32 v37, v157, v8
    v_sub_f32 v38, v158, v8
    s_cmp_ge_u32 s71, 7
    s_cselect_b32 s72, s67, s21
    s_add_u32 m0, s23, 25600
    s_add_u32 s18, s72, 5120
    buffer_load_dwordx4 v184, s[40:43], s18 offen lds
    v_sub_f32 v39, v159, v8
    v_mfma_f32_32x32x16_bf16 v[80:95], a[32:35], a[124:127], 0
    v_sub_f32 v40, v160, v8
    v_sub_f32 v41, v161, v8
    v_sub_f32 v42, v162, v8
    v_sub_f32 v43, v163, v8
    v_mfma_f32_32x32x8_bf16 v[80:95], v[144:145], v[150:151], v[80:95]
    v_sub_f32 v44, v164, v8
    v_sub_f32 v45, v165, v8
    v_sub_f32 v46, v166, v8
    v_sub_f32 v47, v167, v8
    v_max3_f32 v9, v9, v112, v113
    v_max3_f32 v9, v9, v114, v115
    v_max3_f32 v9, v9, v116, v117
    buffer_load_dwordx2 v[12:13], v187, s[40:43], 0 offen sc1
    v_max3_f32 v9, v9, v118, v119
    v_max3_f32 v9, v9, v120, v121
    v_max3_f32 v9, v9, v122, v123
    v_max3_f32 v9, v9, v124, v125
    v_max3_f32 v9, v9, v126, v127
    v_mfma_f32_32x32x16_bf16 v[96:111], a[20:23], a[120:123], v[16:31]
    v_exp_f32 v64, v64
    s_add_u32 m0, s23, 26624
    s_add_u32 s18, s72, 74752
    buffer_load_dwordx4 v184, s[40:43], s18 offen lds
    v_exp_f32 v65, v65
    v_exp_f32 v66, v66
    v_exp_f32 v67, v67
    v_exp_f32 v68, v68
    v_exp_f32 v69, v69
    v_exp_f32 v70, v70
    v_exp_f32 v71, v71
    v_exp_f32 v72, v72
    v_cvt_pk_bf16_f32 v64, v64, v65
    v_exp_f32 v73, v73
    s_add_u32 m0, s23, 27648
    s_add_u32 s18, s72, 144384
    buffer_load_dwordx4 v184, s[40:43], s18 offen lds
    v_mfma_f32_32x32x8_bf16 v[96:111], v[138:139], v[148:149], v[96:111]
    v_cvt_pk_bf16_f32 v65, v66, v67
    v_exp_f32 v74, v74
    v_cvt_pk_bf16_f32 v66, v68, v69
    v_exp_f32 v75, v75
    v_cvt_pk_bf16_f32 v67, v70, v71
    v_exp_f32 v76, v76
    v_exp_f32 v77, v77
    v_exp_f32 v78, v78
    v_exp_f32 v79, v79
    v_cvt_pk_bf16_f32 v72, v72, v73
    s_add_u32 m0, s23, 28672
    s_add_u32 s18, s72, 214016
    buffer_load_dwordx4 v184, s[40:43], s18 offen lds
    v_cvt_pk_bf16_f32 v73, v74, v75
    v_cvt_pk_bf16_f32 v74, v76, v77
    v_cvt_pk_bf16_f32 v75, v78, v79
    v_mfma_f32_32x32x16_bf16 v[48:63], a[72:75], v[64:67], v[48:63]
    v_max3_f32 v9, v9, v80, v81
    v_max3_f32 v9, v9, v82, v83
    v_mfma_f32_32x32x16_bf16 v[48:63], a[76:79], v[72:75], v[48:63]
    v_max3_f32 v9, v9, v84, v85
    v_max3_f32 v9, v9, v86, v87
    v_mfma_f32_32x32x16_bf16 v[112:127], a[36:39], a[124:127], v[152:167]
    v_max3_f32 v9, v9, v88, v89
    v_max3_f32 v9, v9, v90, v91
    v_mfma_f32_32x32x8_bf16 v[112:127], v[146:147], v[150:151], v[112:127]
    s_add_u32 m0, s23, 29696
    s_add_u32 s18, s72, 283648
    buffer_load_dwordx4 v184, s[40:43], s18 offen lds
    v_max3_f32 v9, v9, v92, v93
    v_max3_f32 v9, v9, v94, v95
    v_mfma_f32_32x32x16_bf16 v[64:79], a[24:27], a[120:123], v[16:31]
    v_exp_f32 v96, v96
    v_exp_f32 v97, v97
    s_cmp_ge_u32 s71, 6
    s_cselect_b32 s72, s67, s21
    s_add_u32 m0, s23, 30720
    s_add_u32 s18, s72, 6144
    buffer_load_dwordx4 v184, s[40:43], s18 offen lds
    v_exp_f32 v98, v98
    v_exp_f32 v99, v99
    v_exp_f32 v100, v100
    v_exp_f32 v101, v101
    v_exp_f32 v102, v102
    v_exp_f32 v103, v103
    v_exp_f32 v104, v104
    v_cvt_pk_bf16_f32 v96, v96, v97
    v_exp_f32 v105, v105
    v_mfma_f32_32x32x8_bf16 v[64:79], v[140:141], v[148:149], v[64:79]
    s_add_u32 m0, s23, 31744
    s_add_u32 s18, s72, 75776
    buffer_load_dwordx4 v184, s[40:43], s18 offen lds
    v_cvt_pk_bf16_f32 v97, v98, v99
    v_exp_f32 v106, v106
    v_cvt_pk_bf16_f32 v98, v100, v101
    v_exp_f32 v107, v107
    v_cvt_pk_bf16_f32 v99, v102, v103
    v_exp_f32 v108, v108
    v_exp_f32 v109, v109
    v_exp_f32 v110, v110
    v_exp_f32 v111, v111
    v_cvt_pk_bf16_f32 v104, v104, v105
    v_cvt_pk_bf16_f32 v105, v106, v107
    s_add_u32 m0, s23, 32768
    s_add_u32 s18, s72, 145408
    buffer_load_dwordx4 v184, s[40:43], s18 offen lds
    v_cvt_pk_bf16_f32 v106, v108, v109
    v_cvt_pk_bf16_f32 v107, v110, v111
    v_mfma_f32_32x32x16_bf16 v[48:63], a[80:83], v[96:99], v[48:63]
    v_max3_f32 v9, v9, v112, v113
    v_max3_f32 v9, v9, v114, v115
    v_mfma_f32_32x32x16_bf16 v[48:63], a[84:87], v[104:107], v[48:63]
    v_max3_f32 v9, v9, v116, v117
    v_max3_f32 v9, v9, v118, v119
    v_mfma_f32_32x32x16_bf16 v[80:95], a[28:31], a[120:123], v[16:31]
    v_max3_f32 v9, v9, v120, v121
    v_max3_f32 v9, v9, v122, v123
    v_mfma_f32_32x32x8_bf16 v[80:95], v[142:143], v[148:149], v[80:95]
    s_add_u32 m0, s23, 33792
    s_add_u32 s18, s72, 215040
    buffer_load_dwordx4 v184, s[40:43], s18 offen lds
    v_max3_f32 v9, v9, v124, v125
    v_max3_f32 v9, v9, v126, v127
    v_mfma_f32_32x32x16_bf16 v[96:111], a[32:35], a[120:123], v[32:47]
    v_exp_f32 v64, v64
    v_exp_f32 v65, v65
    s_add_u32 m0, s23, 34816
    s_add_u32 s18, s72, 284672
    buffer_load_dwordx4 v184, s[40:43], s18 offen lds
    v_exp_f32 v66, v66
    v_exp_f32 v67, v67
    v_exp_f32 v68, v68
    v_exp_f32 v69, v69
    v_exp_f32 v70, v70
    v_exp_f32 v71, v71
    v_exp_f32 v72, v72
    v_cvt_pk_bf16_f32 v64, v64, v65
    v_exp_f32 v73, v73
    v_mfma_f32_32x32x8_bf16 v[96:111], v[144:145], v[148:149], v[96:111]
    s_cmp_ge_u32 s71, 5
    s_cselect_b32 s72, s67, s21
    s_add_u32 m0, s23, 35840
    s_add_u32 s18, s72, 7168
    buffer_load_dwordx4 v184, s[40:43], s18 offen lds
    v_cvt_pk_bf16_f32 v65, v66, v67
    v_exp_f32 v74, v74
    v_cvt_pk_bf16_f32 v66, v68, v69
    v_exp_f32 v75, v75
    v_cvt_pk_bf16_f32 v67, v70, v71
    v_exp_f32 v76, v76
    v_exp_f32 v77, v77
    v_exp_f32 v78, v78
    v_exp_f32 v79, v79
    v_cvt_pk_bf16_f32 v72, v72, v73
    v_cvt_pk_bf16_f32 v73, v74, v75
    s_add_u32 m0, s23, 36864
    s_add_u32 s18, s72, 76800
    buffer_load_dwordx4 v184, s[40:43], s18 offen lds
    v_cvt_pk_bf16_f32 v74, v76, v77
    v_cvt_pk_bf16_f32 v75, v78, v79
    v_mfma_f32_32x32x16_bf16 v[48:63], a[88:91], v[64:67], v[48:63]
    v_mov_b32 v10, v9
    s_nop 1
    v_permlane32_swap_b32 v9, v10
    v_max_f32 v9, v9, v10
    v_sub_f32 v208, v168, v9
    v_sub_f32 v209, v169, v9
    v_sub_f32 v210, v170, v9
    v_sub_f32 v211, v171, v9
    v_sub_f32 v212, v172, v9
    v_sub_f32 v213, v173, v9
    v_sub_f32 v214, v174, v9
    v_sub_f32 v215, v175, v9
    v_sub_f32 v216, v176, v9
    v_sub_f32 v217, v177, v9
    v_sub_f32 v218, v178, v9
    s_add_u32 m0, s23, 37888
    s_add_u32 s18, s72, 146432
    buffer_load_dwordx4 v184, s[40:43], s18 offen lds
    v_sub_f32 v219, v179, v9
    v_sub_f32 v220, v180, v9
    v_sub_f32 v221, v181, v9
    v_sub_f32 v222, v182, v9
    v_mfma_f32_32x32x16_bf16 v[48:63], a[92:95], v[72:75], v[48:63]
    v_sub_f32 v223, v183, v9
    v_sub_f32 v192, 0, v9
    v_sub_f32 v193, 0, v9
    v_sub_f32 v194, 0, v9
    v_sub_f32 v195, 0, v9
    v_sub_f32 v196, 0, v9
    v_sub_f32 v197, 0, v9
    v_sub_f32 v198, 0, v9
    v_sub_f32 v199, 0, v9
    v_sub_f32 v200, 0, v9
    v_sub_f32 v201, 0, v9
    v_sub_f32 v202, 0, v9
    s_add_u32 m0, s23, 38912
    s_add_u32 s18, s72, 216064
    buffer_load_dwordx4 v184, s[40:43], s18 offen lds
    v_sub_f32 v203, 0, v9
    v_sub_f32 v204, 0, v9
    v_sub_f32 v205, 0, v9
    v_sub_f32 v206, 0, v9
    v_sub_f32 v207, 0, v9
    v_mfma_f32_32x32x16_bf16 v[112:127], a[4:7], a[124:127], v[208:223]
    v_exp_f32 v80, v80
    v_exp_f32 v81, v81
    v_exp_f32 v82, v82
    v_exp_f32 v83, v83
    v_exp_f32 v84, v84
    v_exp_f32 v85, v85
    s_add_u32 m0, s23, 39936
    s_add_u32 s18, s72, 285696
    buffer_load_dwordx4 v184, s[40:43], s18 offen lds
    v_exp_f32 v86, v86
    s_waitcnt vmcnt(14)
    v_subrev_u32 v12, s100, v12
    v_subrev_u32 v12, 4, v12
    v_cmp_ne_u32 s[62:63], s101, v13
    v_cmp_lt_u32 vcc, 3, v12
    s_nop 0
    s_or_b64 vcc, vcc, s[62:63]
    s_cbranch_scc0 L_pok10
    s_mov_b32 s65, 0x80000
L_pl10:
    s_sleep 2
    buffer_load_dwordx2 v[12:13], v187, s[40:43], 0 offen sc1
    s_waitcnt vmcnt(0)
    v_subrev_u32 v12, s100, v12
    v_subrev_u32 v12, 4, v12
    v_cmp_ne_u32 s[62:63], s101, v13
    v_cmp_lt_u32 vcc, 3, v12
    s_nop 0
    s_or_b64 vcc, vcc, s[62:63]
    s_cbranch_scc0 L_pok10
    s_sub_u32 s65, s65, 1
    s_cbranch_scc0 L_pl10
L_pok10:
    v_exp_f32 v87, v87
    v_exp_f32 v88, v88
    v_cvt_pk_bf16_f32 v80, v80, v81
    v_exp_f32 v89, v89
    s_mov_b32 s19, s68
    buffer_load_dwordx4 a[128:131], v185, s[40:43], s19 offen offset:0
    v_mfma_f32_32x32x8_bf16 v[112:127], v[130:131], v[150:151], v[112:127]
    v_cvt_pk_bf16_f32 v81, v82, v83
    v_exp_f32 v90, v90
    v_cvt_pk_bf16_f32 v82, v84, v85
    v_exp_f32 v91, v91
    v_cvt_pk_bf16_f32 v83, v86, v87
    v_exp_f32 v92, v92
    v_exp_f32 v93, v93
    v_exp_f32 v94, v94
    v_exp_f32 v95, v95
    v_cvt_pk_bf16_f32 v88, v88, v89
    buffer_load_dwordx4 a[132:135], v185, s[40:43], s19 offen offset:256
    v_cvt_pk_bf16_f32 v89, v90, v91
    v_cvt_pk_bf16_f32 v90, v92, v93
    v_cvt_pk_bf16_f32 v91, v94, v95
    v_mfma_f32_32x32x16_bf16 v[48:63], a[96:99], v[80:83], v[48:63]
    v_exp_f32 v96, v96
    v_exp_f32 v97, v97
    v_exp_f32 v98, v98
    v_exp_f32 v99, v99
    v_exp_f32 v100, v100
    v_exp_f32 v101, v101
    v_mfma_f32_32x32x16_bf16 v[48:63], a[100:103], v[88:91], v[48:63]
    s_add_u32 s19, s19, 139264
    buffer_load_dwordx4 a[136:139], v185, s[40:43], s19 offen offset:0
    v_exp_f32 v102, v102
    v_exp_f32 v103, v103
    v_exp_f32 v104, v104
    v_cvt_pk_bf16_f32 v96, v96, v97
    v_exp_f32 v105, v105
    v_mfma_f32_32x32x16_bf16 v[64:79], a[8:11], a[124:127], v[192:207]
    v_cvt_pk_bf16_f32 v97, v98, v99
    v_exp_f32 v106, v106
    v_cvt_pk_bf16_f32 v98, v100, v101
    v_exp_f32 v107, v107
    v_cvt_pk_bf16_f32 v99, v102, v103
    buffer_load_dwordx4 a[140:143], v185, s[40:43], s19 offen offset:256
    v_exp_f32 v108, v108
    v_exp_f32 v109, v109
    v_mfma_f32_32x32x8_bf16 v[64:79], v[132:133], v[150:151], v[64:79]
    v_exp_f32 v110, v110
    v_exp_f32 v111, v111
    v_cvt_pk_bf16_f32 v104, v104, v105
    v_cvt_pk_bf16_f32 v105, v106, v107
    v_cvt_pk_bf16_f32 v106, v108, v109
    v_cvt_pk_bf16_f32 v107, v110, v111
    v_mfma_f32_32x32x16_bf16 v[48:63], a[104:107], v[96:99], v[48:63]
    v_exp_f32 v112, v112
    s_cmp_ge_u32 s71, 11
    s_cselect_b32 s19, s69, s68
    s_add_u32 s19, s19, 2048
    buffer_load_dwordx4 a[144:147], v185, s[40:43], s19 offen offset:0
    v_exp_f32 v113, v113
    v_exp_f32 v114, v114
    v_exp_f32 v115, v115
    v_exp_f32 v116, v116
    v_exp_f32 v117, v117
    v_mfma_f32_32x32x16_bf16 v[48:63], a[108:111], v[104:107], v[48:63]
    v_exp_f32 v118, v118
    v_exp_f32 v119, v119
    v_exp_f32 v120, v120
    buffer_load_dwordx4 a[148:151], v185, s[40:43], s19 offen offset:256
    v_cvt_pk_bf16_f32 v112, v112, v113
    v_exp_f32 v121, v121
    v_mfma_f32_32x32x16_bf16 v[80:95], a[12:15], a[124:127], v[192:207]
    v_cvt_pk_bf16_f32 v113, v114, v115
    v_exp_f32 v122, v122
    v_cvt_pk_bf16_f32 v114, v116, v117
    v_exp_f32 v123, v123
    v_cvt_pk_bf16_f32 v115, v118, v119
    v_exp_f32 v124, v124
    v_exp_f32 v125, v125
    v_mfma_f32_32x32x8_bf16 v[80:95], v[134:135], v[150:151], v[80:95]
    s_add_u32 s19, s19, 139264
    buffer_load_dwordx4 a[152:155], v185, s[40:43], s19 offen offset:0
    v_exp_f32 v126, v126
    v_exp_f32 v127, v127
    v_cvt_pk_bf16_f32 v120, v120, v121
    v_cvt_pk_bf16_f32 v121, v122, v123
    v_cvt_pk_bf16_f32 v122, v124, v125
    v_cvt_pk_bf16_f32 v123, v126, v127
    v_mfma_f32_32x32x16_bf16 v[224:239], a[48:51], v[112:115], 0
    v_exp_f32 v64, v64
    v_exp_f32 v65, v65
    v_exp_f32 v66, v66
    v_exp_f32 v67, v67
    buffer_load_dwordx4 a[156:159], v185, s[40:43], s19 offen offset:256
    v_exp_f32 v68, v68
    v_exp_f32 v69, v69
    v_mfma_f32_32x32x16_bf16 v[224:239], a[52:55], v[120:123], v[224:239]
    v_exp_f32 v70, v70
    v_exp_f32 v71, v71
    v_exp_f32 v72, v72
    v_cvt_pk_bf16_f32 v64, v64, v65
    v_exp_f32 v73, v73
    v_mfma_f32_32x32x16_bf16 v[96:111], a[16:19], a[124:127], v[192:207]
    v_cvt_pk_bf16_f32 v65, v66, v67
    s_cmp_ge_u32 s71, 10
    s_cselect_b32 s19, s69, s68
    s_add_u32 s19, s19, 4096
    buffer_load_dwordx4 a[160:163], v185, s[40:43], s19 offen offset:0
    v_exp_f32 v74, v74
    v_cvt_pk_bf16_f32 v66, v68, v69
    v_exp_f32 v75, v75
    v_cvt_pk_bf16_f32 v67, v70, v71
    v_exp_f32 v76, v76
    v_exp_f32 v77, v77
    v_mfma_f32_32x32x8_bf16 v[96:111], v[136:137], v[150:151], v[96:111]
    v_exp_f32 v78, v78
    v_exp_f32 v79, v79
    v_cvt_pk_bf16_f32 v72, v72, v73
    v_cvt_pk_bf16_f32 v73, v74, v75
    buffer_load_dwordx4 a[164:167], v185, s[40:43], s19 offen offset:256
    v_cvt_pk_bf16_f32 v74, v76, v77
    v_cvt_pk_bf16_f32 v75, v78, v79
    v_mfma_f32_32x32x16_bf16 v[224:239], a[56:59], v[64:67], v[224:239]
    s_mul_i32 s9, s5, 278528
    s_add_u32 s9, s9, 12681216
    s_add_u32 s6, s11, s9
    s_add_u32 s8, s12, s9
    v_rcp_f32 v11, v60
    s_nop 0
    v_mul_f32 v48, v48, v11
    v_mul_f32 v49, v49, v11
    v_mfma_f32_32x32x16_bf16 v[224:239], a[60:63], v[72:75], v[224:239]
    v_mul_f32 v50, v50, v11
    v_mul_f32 v51, v51, v11
    v_mul_f32 v52, v52, v11
    v_mul_f32 v53, v53, v11
    v_mul_f32 v54, v54, v11
    v_mul_f32 v55, v55, v11
    v_mul_f32 v56, v56, v11
    v_mul_f32 v57, v57, v11
    v_mfma_f32_32x32x16_bf16 v[112:127], a[20:23], a[124:127], v[192:207]
    s_add_u32 s19, s19, 139264
    buffer_load_dwordx4 a[168:171], v185, s[40:43], s19 offen offset:0
    v_mul_f32 v58, v58, v11
    v_mul_f32 v59, v59, v11
    v_cvt_pk_bf16_f32 v48, v48, v49
    v_cvt_pk_bf16_f32 v49, v50, v51
    v_cvt_pk_bf16_f32 v50, v52, v53
    v_cvt_pk_bf16_f32 v51, v54, v55
    v_cvt_pk_bf16_f32 v52, v56, v57
    v_mfma_f32_32x32x8_bf16 v[112:127], v[138:139], v[150:151], v[112:127]
    v_cvt_pk_bf16_f32 v53, v58, v59
    buffer_store_dwordx4 v[48:51], v4, s[40:43], s6 offen sc1
    s_mov_b32 exec_hi, 0
    buffer_store_dwordx2 v[52:53], v3, s[40:43], s8 offen sc1
    s_mov_b32 exec_hi, -1
    v_exp_f32 v80, v80
    buffer_load_dwordx4 a[172:175], v185, s[40:43], s19 offen offset:256
    v_exp_f32 v81, v81
    v_exp_f32 v82, v82
    v_exp_f32 v83, v83
    v_exp_f32 v84, v84
    v_exp_f32 v85, v85
    v_exp_f32 v86, v86
    v_exp_f32 v87, v87
    v_exp_f32 v88, v88
    v_cvt_pk_bf16_f32 v80, v80, v81
    v_exp_f32 v89, v89
    s_cmp_ge_u32 s71, 9
    s_cselect_b32 s19, s69, s68
    s_add_u32 s19, s19, 6144
    buffer_load_dwordx4 a[176:179], v185, s[40:43], s19 offen offset:0
    v_cvt_pk_bf16_f32 v81, v82, v83
    v_exp_f32 v90, v90
    v_cvt_pk_bf16_f32 v82, v84, v85
    v_exp_f32 v91, v91
    v_cvt_pk_bf16_f32 v83, v86, v87
    v_exp_f32 v92, v92
    v_exp_f32 v93, v93
    v_exp_f32 v94, v94
    v_exp_f32 v95, v95
    v_cvt_pk_bf16_f32 v88, v88, v89
    v_cvt_pk_bf16_f32 v89, v90, v91
    buffer_load_dwordx4 a[180:183], v185, s[40:43], s19 offen offset:256
    v_cvt_pk_bf16_f32 v90, v92, v93
    v_cvt_pk_bf16_f32 v91, v94, v95
    v_mfma_f32_32x32x16_bf16 v[224:239], a[64:67], v[80:83], v[224:239]
    v_exp_f32 v96, v96
    v_exp_f32 v97, v97
    v_exp_f32 v98, v98
    v_exp_f32 v99, v99
    v_exp_f32 v100, v100
    v_exp_f32 v101, v101
    v_mfma_f32_32x32x16_bf16 v[224:239], a[68:71], v[88:91], v[224:239]
    s_add_u32 s19, s19, 139264
    buffer_load_dwordx4 a[184:187], v185, s[40:43], s19 offen offset:0
    v_exp_f32 v102, v102
    v_exp_f32 v103, v103
    v_exp_f32 v104, v104
    v_cvt_pk_bf16_f32 v96, v96, v97
    v_exp_f32 v105, v105
    v_mfma_f32_32x32x16_bf16 v[64:79], a[24:27], a[124:127], v[192:207]
    v_cvt_pk_bf16_f32 v97, v98, v99
    v_exp_f32 v106, v106
    v_cvt_pk_bf16_f32 v98, v100, v101
    v_exp_f32 v107, v107
    v_cvt_pk_bf16_f32 v99, v102, v103
    buffer_load_dwordx4 a[188:191], v185, s[40:43], s19 offen offset:256
    v_exp_f32 v108, v108
    v_exp_f32 v109, v109
    v_mfma_f32_32x32x8_bf16 v[64:79], v[140:141], v[150:151], v[64:79]
    v_exp_f32 v110, v110
    v_exp_f32 v111, v111
    v_cvt_pk_bf16_f32 v104, v104, v105
    v_cvt_pk_bf16_f32 v105, v106, v107
    v_cvt_pk_bf16_f32 v106, v108, v109
    v_cvt_pk_bf16_f32 v107, v110, v111
    v_mfma_f32_32x32x16_bf16 v[224:239], a[72:75], v[96:99], v[224:239]
    v_sub_f32 v208, v152, v9
    s_cmp_ge_u32 s71, 8
    s_cselect_b32 s19, s69, s68
    s_add_u32 s19, s19, 8192
    buffer_load_dwordx4 a[192:195], v185, s[40:43], s19 offen offset:0
    v_sub_f32 v209, v153, v9
    v_sub_f32 v210, v154, v9
    v_sub_f32 v211, v155, v9
    v_mfma_f32_32x32x16_bf16 v[224:239], a[76:79], v[104:107], v[224:239]
    v_sub_f32 v212, v156, v9
    v_sub_f32 v213, v157, v9
    v_sub_f32 v214, v158, v9
    v_sub_f32 v215, v159, v9
    v_mfma_f32_32x32x16_bf16 v[80:95], a[28:31], a[124:127], v[192:207]
    v_sub_f32 v216, v160, v9
    v_sub_f32 v217, v161, v9
    v_sub_f32 v218, v162, v9
    v_sub_f32 v219, v163, v9
    v_mfma_f32_32x32x8_bf16 v[80:95], v[142:143], v[150:151], v[80:95]
    v_sub_f32 v220, v164, v9
    buffer_load_dwordx4 a[196:199], v185, s[40:43], s19 offen offset:256
    v_sub_f32 v221, v165, v9
    v_sub_f32 v222, v166, v9
    v_sub_f32 v223, v167, v9
    v_exp_f32 v112, v112
    v_exp_f32 v113, v113
    v_exp_f32 v114, v114
    v_exp_f32 v115, v115
    v_exp_f32 v116, v116
    v_exp_f32 v117, v117
    v_exp_f32 v118, v118
    s_add_u32 s19, s19, 139264
    buffer_load_dwordx4 a[200:203], v185, s[40:43], s19 offen offset:0
    v_exp_f32 v119, v119
    v_exp_f32 v120, v120
    v_cvt_pk_bf16_f32 v112, v112, v113
    v_exp_f32 v121, v121
    v_cvt_pk_bf16_f32 v113, v114, v115
    v_exp_f32 v122, v122
    v_cvt_pk_bf16_f32 v114, v116, v117
    v_exp_f32 v123, v123
    v_cvt_pk_bf16_f32 v115, v118, v119
    v_exp_f32 v124, v124
    v_exp_f32 v125, v125
    buffer_load_dwordx4 a[204:207], v185, s[40:43], s19 offen offset:256
    v_exp_f32 v126, v126
    v_exp_f32 v127, v127
    v_cvt_pk_bf16_f32 v120, v120, v121
    v_cvt_pk_bf16_f32 v121, v122, v123
    v_cvt_pk_bf16_f32 v122, v124, v125
    v_cvt_pk_bf16_f32 v123, v126, v127
    v_mfma_f32_32x32x16_bf16 v[224:239], a[80:83], v[112:115], v[224:239]
    v_exp_f32 v64, v64
    v_exp_f32 v65, v65
    v_exp_f32 v66, v66
    v_exp_f32 v67, v67
    s_cmp_ge_u32 s71, 7
    s_cselect_b32 s19, s69, s68
    s_add_u32 s19, s19, 10240
    buffer_load_dwordx4 a[208:211], v185, s[40:43], s19 offen offset:0
    v_exp_f32 v68, v68
    v_exp_f32 v69, v69
    v_mfma_f32_32x32x16_bf16 v[224:239], a[84:87], v[120:123], v[224:239]
    v_exp_f32 v70, v70
    v_exp_f32 v71, v71
    v_exp_f32 v72, v72
    v_cvt_pk_bf16_f32 v64, v64, v65
    v_exp_f32 v73, v73
    v_mfma_f32_32x32x16_bf16 v[96:111], a[32:35], a[124:127], v[192:207]
    v_cvt_pk_bf16_f32 v65, v66, v67
    buffer_load_dwordx4 a[212:215], v185, s[40:43], s19 offen offset:256
    v_exp_f32 v74, v74
    v_cvt_pk_bf16_f32 v66, v68, v69
    v_exp_f32 v75, v75
    v_cvt_pk_bf16_f32 v67, v70, v71
    v_exp_f32 v76, v76
    v_exp_f32 v77, v77
    v_mfma_f32_32x32x8_bf16 v[96:111], v[144:145], v[150:151], v[96:111]
    v_exp_f32 v78, v78
    v_exp_f32 v79, v79
    v_cvt_pk_bf16_f32 v72, v72, v73
    v_cvt_pk_bf16_f32 v73, v74, v75
    s_add_u32 s19, s19, 139264
    buffer_load_dwordx4 a[216:219], v185, s[40:43], s19 offen offset:0
    v_cvt_pk_bf16_f32 v74, v76, v77
    v_cvt_pk_bf16_f32 v75, v78, v79
    v_mfma_f32_32x32x16_bf16 v[224:239], a[88:91], v[64:67], v[224:239]
    v_exp_f32 v80, v80
    v_exp_f32 v81, v81
    v_exp_f32 v82, v82
    v_exp_f32 v83, v83
    v_exp_f32 v84, v84
    v_exp_f32 v85, v85
    v_mfma_f32_32x32x16_bf16 v[224:239], a[92:95], v[72:75], v[224:239]
    buffer_load_dwordx4 a[220:223], v185, s[40:43], s19 offen offset:256
    v_exp_f32 v86, v86
    v_exp_f32 v87, v87
    v_exp_f32 v88, v88
    v_cvt_pk_bf16_f32 v80, v80, v81
    v_exp_f32 v89, v89
    v_mfma_f32_32x32x16_bf16 v[112:127], a[36:39], a[124:127], v[208:223]
    v_cvt_pk_bf16_f32 v81, v82, v83
    v_exp_f32 v90, v90
    v_cvt_pk_bf16_f32 v82, v84, v85
    v_exp_f32 v91, v91
    v_cvt_pk_bf16_f32 v83, v86, v87
    s_cmp_ge_u32 s71, 6
    s_cselect_b32 s19, s69, s68
    s_add_u32 s19, s19, 12288
    buffer_load_dwordx4 a[224:227], v185, s[40:43], s19 offen offset:0
    v_exp_f32 v92, v92
    v_exp_f32 v93, v93
    v_mfma_f32_32x32x8_bf16 v[112:127], v[146:147], v[150:151], v[112:127]
    v_exp_f32 v94, v94
    v_exp_f32 v95, v95
    v_cvt_pk_bf16_f32 v88, v88, v89
    v_cvt_pk_bf16_f32 v89, v90, v91
    v_cvt_pk_bf16_f32 v90, v92, v93
    v_cvt_pk_bf16_f32 v91, v94, v95
    v_mfma_f32_32x32x16_bf16 v[224:239], a[96:99], v[80:83], v[224:239]
    v_exp_f32 v96, v96
    buffer_load_dwordx4 a[228:231], v185, s[40:43], s19 offen offset:256
    v_exp_f32 v97, v97
    v_exp_f32 v98, v98
    v_exp_f32 v99, v99
    v_exp_f32 v100, v100
    v_exp_f32 v101, v101
    v_exp_f32 v102, v102
    v_exp_f32 v103, v103
    v_exp_f32 v104, v104
    v_cvt_pk_bf16_f32 v96, v96, v97
    v_exp_f32 v105, v105
    s_add_u32 s19, s19, 139264
    buffer_load_dwordx4 a[232:235], v185, s[40:43], s19 offen offset:0
    v_mfma_f32_32x32x16_bf16 v[224:239], a[100:103], v[88:91], v[224:239]
    v_cvt_pk_bf16_f32 v97, v98, v99
    v_exp_f32 v106, v106
    v_cvt_pk_bf16_f32 v98, v100, v101
    v_exp_f32 v107, v107
    v_cvt_pk_bf16_f32 v99, v102, v103
    v_exp_f32 v108, v108
    v_exp_f32 v109, v109
    v_exp_f32 v110, v110
    v_exp_f32 v111, v111
    v_cvt_pk_bf16_f32 v104, v104, v105
    buffer_load_dwordx4 a[236:239], v185, s[40:43], s19 offen offset:256
    v_cvt_pk_bf16_f32 v105, v106, v107
    v_cvt_pk_bf16_f32 v106, v108, v109
    v_cvt_pk_bf16_f32 v107, v110, v111
    v_mfma_f32_32x32x16_bf16 v[224:239], a[104:107], v[96:99], v[224:239]
    v_exp_f32 v112, v112
    v_exp_f32 v113, v113
    v_exp_f32 v114, v114
    v_exp_f32 v115, v115
    v_exp_f32 v116, v116
    v_exp_f32 v117, v117
    v_exp_f32 v118, v118
    v_exp_f32 v119, v119
    v_exp_f32 v120, v120
    v_cvt_pk_bf16_f32 v112, v112, v113
    v_exp_f32 v121, v121
    v_mfma_f32_32x32x16_bf16 v[224:239], a[108:111], v[104:107], v[224:239]
    v_cvt_pk_bf16_f32 v113, v114, v115
    v_exp_f32 v122, v122
    v_cvt_pk_bf16_f32 v114, v116, v117
    v_exp_f32 v123, v123
    v_cvt_pk_bf16_f32 v115, v118, v119
    v_exp_f32 v124, v124
    v_exp_f32 v125, v125
    v_exp_f32 v126, v126
    v_exp_f32 v127, v127
    v_cvt_pk_bf16_f32 v120, v120, v121
    v_cvt_pk_bf16_f32 v121, v122, v123
    v_cvt_pk_bf16_f32 v122, v124, v125
    v_cvt_pk_bf16_f32 v123, v126, v127
    v_mfma_f32_32x32x16_bf16 v[224:239], a[112:115], v[112:115], v[224:239]
    s_nop 0
    v_mfma_f32_32x32x16_bf16 v[224:239], a[116:119], v[120:123], v[224:239]
    s_mul_i32 s9, s5, 278528
    s_add_u32 s9, s9, 12820480
    s_add_u32 s6, s11, s9
    s_add_u32 s8, s12, s9
    s_nop 7
    v_rcp_f32 v11, v236
    s_nop 0
    v_mul_f32 v224, v224, v11
    v_mul_f32 v225, v225, v11
    v_mul_f32 v226, v226, v11
    v_mul_f32 v227, v227, v11
    v_mul_f32 v228, v228, v11
    v_mul_f32 v229, v229, v11
    v_mul_f32 v230, v230, v11
    v_mul_f32 v231, v231, v11
    v_mul_f32 v232, v232, v11
    v_mul_f32 v233, v233, v11
    v_mul_f32 v234, v234, v11
    v_mul_f32 v235, v235, v11
    v_cvt_pk_bf16_f32 v224, v224, v225
    v_cvt_pk_bf16_f32 v225, v226, v227
    v_cvt_pk_bf16_f32 v226, v228, v229
    v_cvt_pk_bf16_f32 v227, v230, v231
    v_cvt_pk_bf16_f32 v228, v232, v233
    v_cvt_pk_bf16_f32 v229, v234, v235
    buffer_store_dwordx4 v[224:227], v4, s[40:43], s6 offen sc1
    s_mov_b32 exec_hi, 0
    buffer_store_dwordx2 v[228:229], v3, s[40:43], s8 offen sc1
    s_mov_b32 exec_hi, -1
    ds_read_b128 v[24:27], v186 offset:0
    ds_read_b128 v[28:31], v186 offset:1024
    ds_read_b128 v[32:35], v186 offset:2048
    ds_read_b128 v[36:39], v186 offset:3072
    ds_read_b128 v[40:43], v186 offset:4096
    v_and_b32 v20, 15, v0
    v_lshrrev_b32 v21, 4, v0
    v_mul_u32_u24 v8, 1280, v20
    v_lshl_add_u32 v8, v21, 3, v8
    s_lshl_b32 s18, s16, 2
    s_add_u32 s18, s18, s64
    s_mul_i32 s18, s18, 20480
    s_mul_i32 s19, s17, 160
    s_add_u32 s3, s18, s19
    s_lshl_b32 s18, s16, 10
    s_add_u32 s18, s18, 65536
    v_and_b32 v20, 7, v0
    v_lshl_add_u32 v7, v20, 7, s18
    s_lshl_b32 s66, s2, 7
    s_add_u32 s66, s66, 65536
    s_waitcnt vmcnt(28)
    s_waitcnt lgkmcnt(4)
    v_mfma_f32_16x16x32_bf16 v[64:67], v[24:27], a[128:131], 0
    s_cmp_ge_u32 s71, 5
    s_cselect_b32 s19, s69, s68
    s_add_u32 s19, s19, 14336
    buffer_load_dwordx4 a[240:243], v185, s[40:43], s19 offen offset:0
    v_mfma_f32_16x16x32_bf16 v[84:87], v[24:27], a[132:135], 0
    ds_read_b128 v[44:47], v186 offset:5120
    v_mfma_f32_16x16x32_bf16 v[104:107], v[24:27], a[136:139], 0
    buffer_load_dwordx4 a[244:247], v185, s[40:43], s19 offen offset:256
    v_mfma_f32_16x16x32_bf16 v[124:127], v[24:27], a[140:143], 0
    ds_read_b128 v[48:51], v186 offset:6144
    s_waitcnt lgkmcnt(5)
    v_mfma_f32_16x16x32_bf16 v[68:71], v[28:31], a[128:131], 0
    s_add_u32 s19, s19, 139264
    buffer_load_dwordx4 a[248:251], v185, s[40:43], s19 offen offset:0
    v_mfma_f32_16x16x32_bf16 v[88:91], v[28:31], a[132:135], 0
    ds_read_b128 v[52:55], v186 offset:7168
    v_mfma_f32_16x16x32_bf16 v[108:111], v[28:31], a[136:139], 0
    buffer_load_dwordx4 a[252:255], v185, s[40:43], s19 offen offset:256
    v_mfma_f32_16x16x32_bf16 v[128:131], v[28:31], a[140:143], 0
    ds_read_b128 v[56:59], v186 offset:8192
    s_waitcnt lgkmcnt(6)
    v_mfma_f32_16x16x32_bf16 v[72:75], v[32:35], a[128:131], 0
    s_cmp_ge_u32 s71, 4
    s_cselect_b32 s72, s67, s21
    s_add_u32 s18, s72, 8192
    buffer_load_dwordx4 a[0:3], v184, s[40:43], s18 offen
    v_mfma_f32_16x16x32_bf16 v[92:95], v[32:35], a[132:135], 0
    ds_read_b128 v[60:63], v186 offset:9216
    v_mfma_f32_16x16x32_bf16 v[112:115], v[32:35], a[136:139], 0
    s_add_u32 s18, s72, 77824
    buffer_load_dwordx4 a[4:7], v184, s[40:43], s18 offen
    v_mfma_f32_16x16x32_bf16 v[132:135], v[32:35], a[140:143], 0
    s_waitcnt lgkmcnt(6)
    v_mfma_f32_16x16x32_bf16 v[76:79], v[36:39], a[128:131], 0
    v_mfma_f32_16x16x32_bf16 v[96:99], v[36:39], a[132:135], 0
    v_mfma_f32_16x16x32_bf16 v[116:119], v[36:39], a[136:139], 0
    v_mfma_f32_16x16x32_bf16 v[136:139], v[36:39], a[140:143], 0
    s_waitcnt lgkmcnt(5)
    v_mfma_f32_16x16x32_bf16 v[80:83], v[40:43], a[128:131], 0
    v_mfma_f32_16x16x32_bf16 v[100:103], v[40:43], a[132:135], 0
    v_mfma_f32_16x16x32_bf16 v[120:123], v[40:43], a[136:139], 0
    v_mfma_f32_16x16x32_bf16 v[140:143], v[40:43], a[140:143], 0
    s_waitcnt vmcnt(30)
    s_waitcnt lgkmcnt(4)
    v_mfma_f32_16x16x32_bf16 v[64:67], v[44:47], a[144:147], v[64:67]
    s_add_u32 s18, s72, 147456
    buffer_load_dwordx4 a[8:11], v184, s[40:43], s18 offen
    v_mfma_f32_16x16x32_bf16 v[84:87], v[44:47], a[148:151], v[84:87]
    ds_read_b128 v[24:27], v186 offset:10240
    v_mfma_f32_16x16x32_bf16 v[104:107], v[44:47], a[152:155], v[104:107]
    s_add_u32 s18, s72, 217088
    buffer_load_dwordx4 a[12:15], v184, s[40:43], s18 offen
    v_mfma_f32_16x16x32_bf16 v[124:127], v[44:47], a[156:159], v[124:127]
    ds_read_b128 v[28:31], v186 offset:11264
    s_waitcnt lgkmcnt(5)
    v_mfma_f32_16x16x32_bf16 v[68:71], v[48:51], a[144:147], v[68:71]
    s_add_u32 s18, s72, 286720
    buffer_load_dwordx4 a[16:19], v184, s[40:43], s18 offen
    v_mfma_f32_16x16x32_bf16 v[88:91], v[48:51], a[148:151], v[88:91]
    ds_read_b128 v[32:35], v186 offset:12288
    v_mfma_f32_16x16x32_bf16 v[108:111], v[48:51], a[152:155], v[108:111]
    s_cmp_ge_u32 s71, 4
    s_cselect_b32 s19, s69, s68
    s_add_u32 s19, s19, 16384
    buffer_load_dwordx4 a[128:131], v185, s[40:43], s19 offen offset:0
    v_mfma_f32_16x16x32_bf16 v[128:131], v[48:51], a[156:159], v[128:131]
    ds_read_b128 v[36:39], v186 offset:13312
    s_waitcnt lgkmcnt(6)
    v_mfma_f32_16x16x32_bf16 v[72:75], v[52:55], a[144:147], v[72:75]
    buffer_load_dwordx4 a[132:135], v185, s[40:43], s19 offen offset:256
    v_mfma_f32_16x16x32_bf16 v[92:95], v[52:55], a[148:151], v[92:95]
    ds_read_b128 v[40:43], v186 offset:14336
    v_mfma_f32_16x16x32_bf16 v[112:115], v[52:55], a[152:155], v[112:115]
    s_add_u32 s19, s19, 139264
    buffer_load_dwordx4 a[136:139], v185, s[40:43], s19 offen offset:0
    v_mfma_f32_16x16x32_bf16 v[132:135], v[52:55], a[156:159], v[132:135]
    s_waitcnt lgkmcnt(6)
    v_mfma_f32_16x16x32_bf16 v[76:79], v[56:59], a[144:147], v[76:79]
    v_mfma_f32_16x16x32_bf16 v[96:99], v[56:59], a[148:151], v[96:99]
    v_mfma_f32_16x16x32_bf16 v[116:119], v[56:59], a[152:155], v[116:119]
    v_mfma_f32_16x16x32_bf16 v[136:139], v[56:59], a[156:159], v[136:139]
    s_waitcnt lgkmcnt(5)
    v_mfma_f32_16x16x32_bf16 v[80:83], v[60:63], a[144:147], v[80:83]
    v_mfma_f32_16x16x32_bf16 v[100:103], v[60:63], a[148:151], v[100:103]
    v_mfma_f32_16x16x32_bf16 v[120:123], v[60:63], a[152:155], v[120:123]
    v_mfma_f32_16x16x32_bf16 v[140:143], v[60:63], a[156:159], v[140:143]
    s_waitcnt vmcnt(30)
    s_waitcnt lgkmcnt(4)
    v_mfma_f32_16x16x32_bf16 v[64:67], v[24:27], a[160:163], v[64:67]
    buffer_load_dwordx4 a[140:143], v185, s[40:43], s19 offen offset:256
    v_mfma_f32_16x16x32_bf16 v[84:87], v[24:27], a[164:167], v[84:87]
    ds_read_b128 v[44:47], v186 offset:15360
    v_mfma_f32_16x16x32_bf16 v[104:107], v[24:27], a[168:171], v[104:107]
    s_cmp_ge_u32 s71, 3
    s_cselect_b32 s72, s67, s21
    s_add_u32 s18, s72, 9216
    buffer_load_dwordx4 a[20:23], v184, s[40:43], s18 offen
    v_mfma_f32_16x16x32_bf16 v[124:127], v[24:27], a[172:175], v[124:127]
    ds_read_b128 v[48:51], v186 offset:16384
    s_waitcnt lgkmcnt(5)
    v_mfma_f32_16x16x32_bf16 v[68:71], v[28:31], a[160:163], v[68:71]
    s_add_u32 s18, s72, 78848
    buffer_load_dwordx4 a[24:27], v184, s[40:43], s18 offen
    v_mfma_f32_16x16x32_bf16 v[88:91], v[28:31], a[164:167], v[88:91]
    ds_read_b128 v[52:55], v186 offset:17408
    v_mfma_f32_16x16x32_bf16 v[108:111], v[28:31], a[168:171], v[108:111]
    s_add_u32 s18, s72, 148480
    buffer_load_dwordx4 a[28:31], v184, s[40:43], s18 offen
    v_mfma_f32_16x16x32_bf16 v[128:131], v[28:31], a[172:175], v[128:131]
    ds_read_b128 v[56:59], v186 offset:18432
    s_waitcnt lgkmcnt(6)
    v_mfma_f32_16x16x32_bf16 v[72:75], v[32:35], a[160:163], v[72:75]
    s_add_u32 s18, s72, 218112
    buffer_load_dwordx4 a[32:35], v184, s[40:43], s18 offen
    v_mfma_f32_16x16x32_bf16 v[92:95], v[32:35], a[164:167], v[92:95]
    ds_read_b128 v[60:63], v186 offset:19456
    v_mfma_f32_16x16x32_bf16 v[112:115], v[32:35], a[168:171], v[112:115]
    s_add_u32 s18, s72, 287744
    buffer_load_dwordx4 a[36:39], v184, s[40:43], s18 offen
    v_mfma_f32_16x16x32_bf16 v[132:135], v[32:35], a[172:175], v[132:135]
    s_waitcnt lgkmcnt(6)
    v_mfma_f32_16x16x32_bf16 v[76:79], v[36:39], a[160:163], v[76:79]
    v_mfma_f32_16x16x32_bf16 v[96:99], v[36:39], a[164:167], v[96:99]
    v_mfma_f32_16x16x32_bf16 v[116:119], v[36:39], a[168:171], v[116:119]
    v_mfma_f32_16x16x32_bf16 v[136:139], v[36:39], a[172:175], v[136:139]
    s_waitcnt lgkmcnt(5)
    v_mfma_f32_16x16x32_bf16 v[80:83], v[40:43], a[160:163], v[80:83]
    v_mfma_f32_16x16x32_bf16 v[100:103], v[40:43], a[164:167], v[100:103]
    v_mfma_f32_16x16x32_bf16 v[120:123], v[40:43], a[168:171], v[120:123]
    v_mfma_f32_16x16x32_bf16 v[140:143], v[40:43], a[172:175], v[140:143]
    s_waitcnt vmcnt(32)
    s_waitcnt lgkmcnt(4)
    v_mfma_f32_16x16x32_bf16 v[64:67], v[44:47], a[176:179], v[64:67]
    s_waitcnt vmcnt(18)
    s_barrier
    s_or_b32 s65, s100, 5
    v_mov_b32 v20, s65
    v_mov_b32 v21, s101
    s_lshl_b32 s65, s64, 25
    s_add_u32 s65, s65, s66
    v_lshlrev_b32 v22, 25, v0
    buffer_store_dwordx2 v[20:21], v22, s[40:43], s65 offen sc1
    v_mfma_f32_16x16x32_bf16 v[84:87], v[44:47], a[180:183], v[84:87]
    ds_read_b128 v[24:27], v186 offset:20480
    v_mfma_f32_16x16x32_bf16 v[104:107], v[44:47], a[184:187], v[104:107]
    s_cmp_ge_u32 s71, 3
    s_cselect_b32 s19, s69, s68
    s_add_u32 s19, s19, 18432
    buffer_load_dwordx4 a[144:147], v185, s[40:43], s19 offen offset:0
    v_mfma_f32_16x16x32_bf16 v[124:127], v[44:47], a[188:191], v[124:127]
    ds_read_b128 v[28:31], v186 offset:21504
    s_waitcnt lgkmcnt(5)
    v_mfma_f32_16x16x32_bf16 v[68:71], v[48:51], a[176:179], v[68:71]
    buffer_load_dwordx4 a[148:151], v185, s[40:43], s19 offen offset:256
    v_mfma_f32_16x16x32_bf16 v[88:91], v[48:51], a[180:183], v[88:91]
    ds_read_b128 v[32:35], v186 offset:22528
    v_mfma_f32_16x16x32_bf16 v[108:111], v[48:51], a[184:187], v[108:111]
    s_add_u32 s19, s19, 139264
    buffer_load_dwordx4 a[152:155], v185, s[40:43], s19 offen offset:0
    v_mfma_f32_16x16x32_bf16 v[128:131], v[48:51], a[188:191], v[128:131]
    ds_read_b128 v[36:39], v186 offset:23552
    s_waitcnt lgkmcnt(6)
    v_mfma_f32_16x16x32_bf16 v[72:75], v[52:55], a[176:179], v[72:75]
    buffer_load_dwordx4 a[156:159], v185, s[40:43], s19 offen offset:256
    v_mfma_f32_16x16x32_bf16 v[92:95], v[52:55], a[180:183], v[92:95]
    ds_read_b128 v[40:43], v186 offset:24576
    v_mfma_f32_16x16x32_bf16 v[112:115], v[52:55], a[184:187], v[112:115]
    s_cmp_ge_u32 s71, 2
    s_cselect_b32 s72, s67, s21
    s_add_u32 s18, s72, 10240
    buffer_load_dwordx4 a[40:43], v184, s[40:43], s18 offen
    v_mfma_f32_16x16x32_bf16 v[132:135], v[52:55], a[188:191], v[132:135]
    s_waitcnt lgkmcnt(6)
    v_mfma_f32_16x16x32_bf16 v[76:79], v[56:59], a[176:179], v[76:79]
    s_add_u32 s18, s72, 79872
    buffer_load_dwordx4 a[44:47], v184, s[40:43], s18 offen
    v_mfma_f32_16x16x32_bf16 v[96:99], v[56:59], a[180:183], v[96:99]
    v_mfma_f32_16x16x32_bf16 v[116:119], v[56:59], a[184:187], v[116:119]
    v_mfma_f32_16x16x32_bf16 v[136:139], v[56:59], a[188:191], v[136:139]
    s_waitcnt lgkmcnt(5)
    v_mfma_f32_16x16x32_bf16 v[80:83], v[60:63], a[176:179], v[80:83]
    v_mfma_f32_16x16x32_bf16 v[100:103], v[60:63], a[180:183], v[100:103]
    v_mfma_f32_16x16x32_bf16 v[120:123], v[60:63], a[184:187], v[120:123]
    v_mfma_f32_16x16x32_bf16 v[140:143], v[60:63], a[188:191], v[140:143]
    s_waitcnt lgkmcnt(4)
    v_mfma_f32_16x16x32_bf16 v[64:67], v[24:27], a[192:195], v[64:67]
    s_add_u32 s18, s72, 149504
    buffer_load_dwordx4 a[48:51], v184, s[40:43], s18 offen
    v_mfma_f32_16x16x32_bf16 v[84:87], v[24:27], a[196:199], v[84:87]
    ds_read_b128 v[44:47], v186 offset:25600
    v_mfma_f32_16x16x32_bf16 v[104:107], v[24:27], a[200:203], v[104:107]
    s_add_u32 s18, s72, 219136
    buffer_load_dwordx4 a[52:55], v184, s[40:43], s18 offen
    v_mfma_f32_16x16x32_bf16 v[124:127], v[24:27], a[204:207], v[124:127]
    ds_read_b128 v[48:51], v186 offset:26624
    s_waitcnt lgkmcnt(5)
    v_mfma_f32_16x16x32_bf16 v[68:71], v[28:31], a[192:195], v[68:71]
    s_add_u32 s18, s72, 288768
    buffer_load_dwordx4 a[56:59], v184, s[40:43], s18 offen
    v_mfma_f32_16x16x32_bf16 v[88:91], v[28:31], a[196:199], v[88:91]
    ds_read_b128 v[52:55], v186 offset:27648
    v_mfma_f32_16x16x32_bf16 v[108:111], v[28:31], a[200:203], v[108:111]
    s_cmp_ge_u32 s71, 2
    s_cselect_b32 s19, s69, s68
    s_add_u32 s19, s19, 20480
    buffer_load_dwordx4 a[160:163], v185, s[40:43], s19 offen offset:0
    v_mfma_f32_16x16x32_bf16 v[128:131], v[28:31], a[204:207], v[128:131]
    ds_read_b128 v[56:59], v186 offset:28672
    s_waitcnt lgkmcnt(6)
    v_mfma_f32_16x16x32_bf16 v[72:75], v[32:35], a[192:195], v[72:75]
    buffer_load_dwordx4 a[164:167], v185, s[40:43], s19 offen offset:256
    v_mfma_f32_16x16x32_bf16 v[92:95], v[32:35], a[196:199], v[92:95]
    ds_read_b128 v[60:63], v186 offset:29696
    v_mfma_f32_16x16x32_bf16 v[112:115], v[32:35], a[200:203], v[112:115]
    s_add_u32 s19, s19, 139264
    buffer_load_dwordx4 a[168:171], v185, s[40:43], s19 offen offset:0
    v_mfma_f32_16x16x32_bf16 v[132:135], v[32:35], a[204:207], v[132:135]
    s_waitcnt lgkmcnt(6)
    v_mfma_f32_16x16x32_bf16 v[76:79], v[36:39], a[192:195], v[76:79]
    v_mfma_f32_16x16x32_bf16 v[96:99], v[36:39], a[196:199], v[96:99]
    v_mfma_f32_16x16x32_bf16 v[116:119], v[36:39], a[200:203], v[116:119]
    v_mfma_f32_16x16x32_bf16 v[136:139], v[36:39], a[204:207], v[136:139]
    s_waitcnt lgkmcnt(5)
    v_mfma_f32_16x16x32_bf16 v[80:83], v[40:43], a[192:195], v[80:83]
    v_mfma_f32_16x16x32_bf16 v[100:103], v[40:43], a[196:199], v[100:103]
    v_mfma_f32_16x16x32_bf16 v[120:123], v[40:43], a[200:203], v[120:123]
    v_mfma_f32_16x16x32_bf16 v[140:143], v[40:43], a[204:207], v[140:143]
    s_waitcnt lgkmcnt(4)
    v_mfma_f32_16x16x32_bf16 v[64:67], v[44:47], a[208:211], v[64:67]
    buffer_load_dwordx4 a[172:175], v185, s[40:43], s19 offen offset:256
    v_mfma_f32_16x16x32_bf16 v[84:87], v[44:47], a[212:215], v[84:87]
    ds_read_b128 v[24:27], v186 offset:30720
    v_mfma_f32_16x16x32_bf16 v[104:107], v[44:47], a[216:219], v[104:107]
    s_cmp_ge_u32 s71, 1
    s_cselect_b32 s72, s67, s21
    s_add_u32 s18, s72, 11264
    buffer_load_dwordx4 a[60:63], v184, s[40:43], s18 offen
    v_mfma_f32_16x16x32_bf16 v[124:127], v[44:47], a[220:223], v[124:127]
    ds_read_b128 v[28:31], v186 offset:31744
    s_waitcnt lgkmcnt(5)
    v_mfma_f32_16x16x32_bf16 v[68:71], v[48:51], a[208:211], v[68:71]
    s_add_u32 s18, s72, 80896
    buffer_load_dwordx4 a[64:67], v184, s[40:43], s18 offen
    v_mfma_f32_16x16x32_bf16 v[88:91], v[48:51], a[212:215], v[88:91]
    ds_read_b128 v[32:35], v186 offset:32768
    v_mfma_f32_16x16x32_bf16 v[108:111], v[48:51], a[216:219], v[108:111]
    s_add_u32 s18, s72, 150528
    buffer_load_dwordx4 a[68:71], v184, s[40:43], s18 offen
    v_mfma_f32_16x16x32_bf16 v[128:131], v[48:51], a[220:223], v[128:131]
    ds_read_b128 v[36:39], v186 offset:33792
    s_waitcnt lgkmcnt(6)
    v_mfma_f32_16x16x32_bf16 v[72:75], v[52:55], a[208:211], v[72:75]
    s_add_u32 s18, s72, 220160
    buffer_load_dwordx4 a[72:75], v184, s[40:43], s18 offen
    v_mfma_f32_16x16x32_bf16 v[92:95], v[52:55], a[212:215], v[92:95]
    ds_read_b128 v[40:43], v186 offset:34816
    v_mfma_f32_16x16x32_bf16 v[112:115], v[52:55], a[216:219], v[112:115]
    s_add_u32 s18, s72, 289792
    buffer_load_dwordx4 a[76:79], v184, s[40:43], s18 offen
    v_mfma_f32_16x16x32_bf16 v[132:135], v[52:55], a[220:223], v[132:135]
    s_waitcnt lgkmcnt(6)
    v_mfma_f32_16x16x32_bf16 v[76:79], v[56:59], a[208:211], v[76:79]
    v_mfma_f32_16x16x32_bf16 v[96:99], v[56:59], a[212:215], v[96:99]
    v_mfma_f32_16x16x32_bf16 v[116:119], v[56:59], a[216:219], v[116:119]
    v_mfma_f32_16x16x32_bf16 v[136:139], v[56:59], a[220:223], v[136:139]
    s_waitcnt lgkmcnt(5)
    v_mfma_f32_16x16x32_bf16 v[80:83], v[60:63], a[208:211], v[80:83]
    v_mfma_f32_16x16x32_bf16 v[100:103], v[60:63], a[212:215], v[100:103]
    v_mfma_f32_16x16x32_bf16 v[120:123], v[60:63], a[216:219], v[120:123]
    v_mfma_f32_16x16x32_bf16 v[140:143], v[60:63], a[220:223], v[140:143]
    s_waitcnt lgkmcnt(4)
    v_mfma_f32_16x16x32_bf16 v[64:67], v[24:27], a[224:227], v[64:67]
    s_cmp_ge_u32 s71, 1
    s_cselect_b32 s19, s69, s68
    s_add_u32 s19, s19, 22528
    buffer_load_dwordx4 a[176:179], v185, s[40:43], s19 offen offset:0
    v_mfma_f32_16x16x32_bf16 v[84:87], v[24:27], a[228:231], v[84:87]
    ds_read_b128 v[44:47], v186 offset:35840
    v_mfma_f32_16x16x32_bf16 v[104:107], v[24:27], a[232:235], v[104:107]
    buffer_load_dwordx4 a[180:183], v185, s[40:43], s19 offen offset:256
    v_mfma_f32_16x16x32_bf16 v[124:127], v[24:27], a[236:239], v[124:127]
    ds_read_b128 v[48:51], v186 offset:36864
    s_waitcnt lgkmcnt(5)
    v_mfma_f32_16x16x32_bf16 v[68:71], v[28:31], a[224:227], v[68:71]
    s_add_u32 s19, s19, 139264
    buffer_load_dwordx4 a[184:187], v185, s[40:43], s19 offen offset:0
    v_mfma_f32_16x16x32_bf16 v[88:91], v[28:31], a[228:231], v[88:91]
    ds_read_b128 v[52:55], v186 offset:37888
    v_mfma_f32_16x16x32_bf16 v[108:111], v[28:31], a[232:235], v[108:111]
    buffer_load_dwordx4 a[188:191], v185, s[40:43], s19 offen offset:256
    v_mfma_f32_16x16x32_bf16 v[128:131], v[28:31], a[236:239], v[128:131]
    ds_read_b128 v[56:59], v186 offset:38912
    s_waitcnt lgkmcnt(6)
    v_mfma_f32_16x16x32_bf16 v[72:75], v[32:35], a[224:227], v[72:75]
    s_mov_b32 s72, s22
    s_add_u32 s18, s72, 0
    buffer_load_dwordx4 a[80:83], v184, s[40:43], s18 offen
    v_mfma_f32_16x16x32_bf16 v[92:95], v[32:35], a[228:231], v[92:95]
    ds_read_b128 v[60:63], v186 offset:39936
    v_mfma_f32_16x16x32_bf16 v[112:115], v[32:35], a[232:235], v[112:115]
    s_add_u32 s18, s72, 69632
    buffer_load_dwordx4 a[84:87], v184, s[40:43], s18 offen
    v_mfma_f32_16x16x32_bf16 v[132:135], v[32:35], a[236:239], v[132:135]
    s_waitcnt lgkmcnt(6)
    v_mfma_f32_16x16x32_bf16 v[76:79], v[36:39], a[224:227], v[76:79]
    v_mfma_f32_16x16x32_bf16 v[96:99], v[36:39], a[228:231], v[96:99]
    v_mfma_f32_16x16x32_bf16 v[116:119], v[36:39], a[232:235], v[116:119]
    v_mfma_f32_16x16x32_bf16 v[136:139], v[36:39], a[236:239], v[136:139]
    s_waitcnt lgkmcnt(5)
    v_mfma_f32_16x16x32_bf16 v[80:83], v[40:43], a[224:227], v[80:83]
    v_mfma_f32_16x16x32_bf16 v[100:103], v[40:43], a[228:231], v[100:103]
    v_mfma_f32_16x16x32_bf16 v[120:123], v[40:43], a[232:235], v[120:123]
    v_mfma_f32_16x16x32_bf16 v[140:143], v[40:43], a[236:239], v[140:143]
    s_waitcnt vmcnt(39)
    s_waitcnt lgkmcnt(4)
    v_mfma_f32_16x16x32_bf16 v[64:67], v[44:47], a[240:243], v[64:67]
    buffer_load_dwordx2 v[20:21], v7, s[40:43], 0 offen sc1
    v_mfma_f32_16x16x32_bf16 v[84:87], v[44:47], a[244:247], v[84:87]
    v_mfma_f32_16x16x32_bf16 v[104:107], v[44:47], a[248:251], v[104:107]
    s_add_u32 s18, s72, 139264
    buffer_load_dwordx4 a[88:91], v184, s[40:43], s18 offen
    v_mfma_f32_16x16x32_bf16 v[124:127], v[44:47], a[252:255], v[124:127]
    s_waitcnt lgkmcnt(3)
    v_mfma_f32_16x16x32_bf16 v[68:71], v[48:51], a[240:243], v[68:71]
    s_add_u32 s18, s72, 208896
    buffer_load_dwordx4 a[92:95], v184, s[40:43], s18 offen
    v_mfma_f32_16x16x32_bf16 v[88:91], v[48:51], a[244:247], v[88:91]
    v_mfma_f32_16x16x32_bf16 v[108:111], v[48:51], a[248:251], v[108:111]
    s_add_u32 s18, s72, 278528
    buffer_load_dwordx4 a[96:99], v184, s[40:43], s18 offen
    v_mfma_f32_16x16x32_bf16 v[128:131], v[48:51], a[252:255], v[128:131]
    s_waitcnt lgkmcnt(2)
    v_mfma_f32_16x16x32_bf16 v[72:75], v[52:55], a[240:243], v[72:75]
    s_mov_b32 s72, s22
    s_add_u32 s18, s72, 1024
    buffer_load_dwordx4 a[100:103], v184, s[40:43], s18 offen
    v_mfma_f32_16x16x32_bf16 v[92:95], v[52:55], a[244:247], v[92:95]
    v_mfma_f32_16x16x32_bf16 v[112:115], v[52:55], a[248:251], v[112:115]
    s_add_u32 s18, s72, 70656
    buffer_load_dwordx4 a[104:107], v184, s[40:43], s18 offen
    v_mfma_f32_16x16x32_bf16 v[132:135], v[52:55], a[252:255], v[132:135]
    s_waitcnt lgkmcnt(1)
    v_mfma_f32_16x16x32_bf16 v[76:79], v[56:59], a[240:243], v[76:79]
    s_add_u32 s18, s72, 140288
    buffer_load_dwordx4 a[108:111], v184, s[40:43], s18 offen
    v_mfma_f32_16x16x32_bf16 v[96:99], v[56:59], a[244:247], v[96:99]
    v_mfma_f32_16x16x32_bf16 v[116:119], v[56:59], a[248:251], v[116:119]
    v_mfma_f32_16x16x32_bf16 v[136:139], v[56:59], a[252:255], v[136:139]
    s_waitcnt lgkmcnt(0)
    v_mfma_f32_16x16x32_bf16 v[80:83], v[60:63], a[240:243], v[80:83]
    v_mfma_f32_16x16x32_bf16 v[100:103], v[60:63], a[244:247], v[100:103]
    v_mfma_f32_16x16x32_bf16 v[120:123], v[60:63], a[248:251], v[120:123]
    v_mfma_f32_16x16x32_bf16 v[140:143], v[60:63], a[252:255], v[140:143]
    s_waitcnt vmcnt(37)
    v_mfma_f32_16x16x32_bf16 v[64:67], a[0:3], a[128:131], v[64:67]
    s_add_u32 s18, s72, 209920
    buffer_load_dwordx4 a[112:115], v184, s[40:43], s18 offen
    v_mfma_f32_16x16x32_bf16 v[84:87], a[0:3], a[132:135], v[84:87]
    v_mfma_f32_16x16x32_bf16 v[104:107], a[0:3], a[136:139], v[104:107]
    s_add_u32 s18, s72, 279552
    buffer_load_dwordx4 a[116:119], v184, s[40:43], s18 offen
    v_mfma_f32_16x16x32_bf16 v[124:127], a[0:3], a[140:143], v[124:127]
    v_mfma_f32_16x16x32_bf16 v[68:71], a[4:7], a[128:131], v[68:71]
    s_mov_b32 s72, s22
    s_add_u32 s18, s72, 2048
    buffer_load_dwordx4 v[192:195], v184, s[40:43], s18 offen
    v_mfma_f32_16x16x32_bf16 v[88:91], a[4:7], a[132:135], v[88:91]
    v_mfma_f32_16x16x32_bf16 v[108:111], a[4:7], a[136:139], v[108:111]
    s_add_u32 s18, s72, 71680
    buffer_load_dwordx4 v[196:199], v184, s[40:43], s18 offen
    v_mfma_f32_16x16x32_bf16 v[128:131], a[4:7], a[140:143], v[128:131]
    v_mfma_f32_16x16x32_bf16 v[72:75], a[8:11], a[128:131], v[72:75]
    s_add_u32 s18, s72, 141312
    buffer_load_dwordx4 v[200:203], v184, s[40:43], s18 offen
    v_mfma_f32_16x16x32_bf16 v[92:95], a[8:11], a[132:135], v[92:95]
    v_mfma_f32_16x16x32_bf16 v[112:115], a[8:11], a[136:139], v[112:115]
    s_add_u32 s18, s72, 210944
    buffer_load_dwordx4 v[204:207], v184, s[40:43], s18 offen
    v_mfma_f32_16x16x32_bf16 v[132:135], a[8:11], a[140:143], v[132:135]
    v_mfma_f32_16x16x32_bf16 v[76:79], a[12:15], a[128:131], v[76:79]
    v_mfma_f32_16x16x32_bf16 v[96:99], a[12:15], a[132:135], v[96:99]
    v_mfma_f32_16x16x32_bf16 v[116:119], a[12:15], a[136:139], v[116:119]
    v_mfma_f32_16x16x32_bf16 v[136:139], a[12:15], a[140:143], v[136:139]
    v_mfma_f32_16x16x32_bf16 v[80:83], a[16:19], a[128:131], v[80:83]
    v_mfma_f32_16x16x32_bf16 v[100:103], a[16:19], a[132:135], v[100:103]
    v_mfma_f32_16x16x32_bf16 v[120:123], a[16:19], a[136:139], v[120:123]
    v_mfma_f32_16x16x32_bf16 v[140:143], a[16:19], a[140:143], v[140:143]
    s_waitcnt vmcnt(33)
    v_mfma_f32_16x16x32_bf16 v[64:67], a[20:23], a[144:147], v[64:67]
    s_waitcnt vmcnt(12)
    v_subrev_u32 v20, s100, v20
    v_subrev_u32 v20, 5, v20
    v_cmp_ne_u32 s[62:63], s101, v21
    v_cmp_lt_u32 vcc, 2, v20
    s_nop 0
    s_or_b64 vcc, vcc, s[62:63]
    s_cbranch_scc0 L_pok11
    s_mov_b32 s65, 0x80000
L_pl11:
    s_sleep 2
    buffer_load_dwordx2 v[20:21], v7, s[40:43], 0 offen sc1
    s_waitcnt vmcnt(0)
    v_subrev_u32 v20, s100, v20
    v_subrev_u32 v20, 5, v20
    v_cmp_ne_u32 s[62:63], s101, v21
    v_cmp_lt_u32 vcc, 2, v20
    s_nop 0
    s_or_b64 vcc, vcc, s[62:63]
    s_cbranch_scc0 L_pok11
    s_sub_u32 s65, s65, 1
    s_cbranch_scc0 L_pl11
L_pok11:
    v_mfma_f32_16x16x32_bf16 v[84:87], a[20:23], a[148:151], v[84:87]
    v_mfma_f32_16x16x32_bf16 v[104:107], a[20:23], a[152:155], v[104:107]
    s_add_u32 s19, s70, 0
    buffer_load_dwordx4 a[192:195], v185, s[40:43], s19 offen offset:0
    v_mfma_f32_16x16x32_bf16 v[124:127], a[20:23], a[156:159], v[124:127]
    v_mfma_f32_16x16x32_bf16 v[68:71], a[24:27], a[144:147], v[68:71]
    buffer_load_dwordx4 a[196:199], v185, s[40:43], s19 offen offset:256
    v_mfma_f32_16x16x32_bf16 v[88:91], a[24:27], a[148:151], v[88:91]
    v_mfma_f32_16x16x32_bf16 v[108:111], a[24:27], a[152:155], v[108:111]
    s_add_u32 s19, s19, 139264
    buffer_load_dwordx4 a[200:203], v185, s[40:43], s19 offen offset:0
    v_mfma_f32_16x16x32_bf16 v[128:131], a[24:27], a[156:159], v[128:131]
    v_mfma_f32_16x16x32_bf16 v[72:75], a[28:31], a[144:147], v[72:75]
    buffer_load_dwordx4 a[204:207], v185, s[40:43], s19 offen offset:256
    v_mfma_f32_16x16x32_bf16 v[92:95], a[28:31], a[148:151], v[92:95]
    v_mfma_f32_16x16x32_bf16 v[112:115], a[28:31], a[152:155], v[112:115]
    s_add_u32 s19, s70, 2048
    buffer_load_dwordx4 a[208:211], v185, s[40:43], s19 offen offset:0
    v_mfma_f32_16x16x32_bf16 v[132:135], a[28:31], a[156:159], v[132:135]
    v_mfma_f32_16x16x32_bf16 v[76:79], a[32:35], a[144:147], v[76:79]
    buffer_load_dwordx4 a[212:215], v185, s[40:43], s19 offen offset:256
    v_mfma_f32_16x16x32_bf16 v[96:99], a[32:35], a[148:151], v[96:99]
    v_mfma_f32_16x16x32_bf16 v[116:119], a[32:35], a[152:155], v[116:119]
    v_mfma_f32_16x16x32_bf16 v[136:139], a[32:35], a[156:159], v[136:139]
    v_mfma_f32_16x16x32_bf16 v[80:83], a[36:39], a[144:147], v[80:83]
    v_mfma_f32_16x16x32_bf16 v[100:103], a[36:39], a[148:151], v[100:103]
    v_mfma_f32_16x16x32_bf16 v[120:123], a[36:39], a[152:155], v[120:123]
    v_mfma_f32_16x16x32_bf16 v[140:143], a[36:39], a[156:159], v[140:143]
    v_mfma_f32_16x16x32_bf16 v[64:67], a[40:43], a[160:163], v[64:67]
    s_add_u32 s19, s19, 139264
    buffer_load_dwordx4 a[216:219], v185, s[40:43], s19 offen offset:0
    v_mfma_f32_16x16x32_bf16 v[84:87], a[40:43], a[164:167], v[84:87]
    v_mfma_f32_16x16x32_bf16 v[104:107], a[40:43], a[168:171], v[104:107]
    buffer_load_dwordx4 a[220:223], v185, s[40:43], s19 offen offset:256
    v_mfma_f32_16x16x32_bf16 v[124:127], a[40:43], a[172:175], v[124:127]
    v_mfma_f32_16x16x32_bf16 v[68:71], a[44:47], a[160:163], v[68:71]
    s_add_u32 s18, s72, 280576
    buffer_load_dwordx4 v[208:211], v184, s[40:43], s18 offen
    v_mfma_f32_16x16x32_bf16 v[88:91], a[44:47], a[164:167], v[88:91]
    v_mfma_f32_16x16x32_bf16 v[108:111], a[44:47], a[168:171], v[108:111]
    s_mov_b32 s72, s22
    s_add_u32 s18, s72, 3072
    buffer_load_dwordx4 v[212:215], v184, s[40:43], s18 offen
    v_mfma_f32_16x16x32_bf16 v[128:131], a[44:47], a[172:175], v[128:131]
    v_mfma_f32_16x16x32_bf16 v[72:75], a[48:51], a[160:163], v[72:75]
    s_add_u32 s18, s72, 72704
    buffer_load_dwordx4 v[216:219], v184, s[40:43], s18 offen
    v_mfma_f32_16x16x32_bf16 v[92:95], a[48:51], a[164:167], v[92:95]
    v_mfma_f32_16x16x32_bf16 v[112:115], a[48:51], a[168:171], v[112:115]
    s_add_u32 s18, s72, 142336
    buffer_load_dwordx4 v[220:223], v184, s[40:43], s18 offen
    v_mfma_f32_16x16x32_bf16 v[132:135], a[48:51], a[172:175], v[132:135]
    v_mfma_f32_16x16x32_bf16 v[76:79], a[52:55], a[160:163], v[76:79]
    v_mfma_f32_16x16x32_bf16 v[96:99], a[52:55], a[164:167], v[96:99]
    v_mfma_f32_16x16x32_bf16 v[116:119], a[52:55], a[168:171], v[116:119]
    v_mfma_f32_16x16x32_bf16 v[136:139], a[52:55], a[172:175], v[136:139]
    v_mfma_f32_16x16x32_bf16 v[80:83], a[56:59], a[160:163], v[80:83]
    v_mfma_f32_16x16x32_bf16 v[100:103], a[56:59], a[164:167], v[100:103]
    v_mfma_f32_16x16x32_bf16 v[120:123], a[56:59], a[168:171], v[120:123]
    v_mfma_f32_16x16x32_bf16 v[140:143], a[56:59], a[172:175], v[140:143]
    v_mfma_f32_16x16x32_bf16 v[64:67], a[60:63], a[176:179], v[64:67]
    s_add_u32 s18, s72, 211968
    buffer_load_dwordx4 v[224:227], v184, s[40:43], s18 offen
    v_mfma_f32_16x16x32_bf16 v[84:87], a[60:63], a[180:183], v[84:87]
    v_mfma_f32_16x16x32_bf16 v[104:107], a[60:63], a[184:187], v[104:107]
    s_add_u32 s18, s72, 281600
    buffer_load_dwordx4 v[228:231], v184, s[40:43], s18 offen
    v_mfma_f32_16x16x32_bf16 v[124:127], a[60:63], a[188:191], v[124:127]
    v_mfma_f32_16x16x32_bf16 v[68:71], a[64:67], a[176:179], v[68:71]
    s_mov_b32 s72, s22
    s_add_u32 s18, s72, 4096
    buffer_load_dwordx4 v[232:235], v184, s[40:43], s18 offen
    v_mfma_f32_16x16x32_bf16 v[88:91], a[64:67], a[180:183], v[88:91]
    v_mfma_f32_16x16x32_bf16 v[108:111], a[64:67], a[184:187], v[108:111]
    s_add_u32 s18, s72, 73728
    buffer_load_dwordx4 v[236:239], v184, s[40:43], s18 offen
    v_mfma_f32_16x16x32_bf16 v[128:131], a[64:67], a[188:191], v[128:131]
    v_mfma_f32_16x16x32_bf16 v[72:75], a[68:71], a[176:179], v[72:75]
    s_add_u32 s18, s72, 143360
    buffer_load_dwordx4 v[240:243], v184, s[40:43], s18 offen
    v_mfma_f32_16x16x32_bf16 v[92:95], a[68:71], a[180:183], v[92:95]
    v_mfma_f32_16x16x32_bf16 v[112:115], a[68:71], a[184:187], v[112:115]
    s_add_u32 s18, s72, 212992
    buffer_load_dwordx4 v[244:247], v184, s[40:43], s18 offen
    v_mfma_f32_16x16x32_bf16 v[132:135], a[68:71], a[188:191], v[132:135]
    v_mfma_f32_16x16x32_bf16 v[76:79], a[72:75], a[176:179], v[76:79]
    v_mfma_f32_16x16x32_bf16 v[96:99], a[72:75], a[180:183], v[96:99]
    v_mfma_f32_16x16x32_bf16 v[116:119], a[72:75], a[184:187], v[116:119]
    v_mfma_f32_16x16x32_bf16 v[136:139], a[72:75], a[188:191], v[136:139]
    v_mfma_f32_16x16x32_bf16 v[80:83], a[76:79], a[176:179], v[80:83]
    v_mfma_f32_16x16x32_bf16 v[100:103], a[76:79], a[180:183], v[100:103]
    v_mfma_f32_16x16x32_bf16 v[120:123], a[76:79], a[184:187], v[120:123]
    v_mfma_f32_16x16x32_bf16 v[140:143], a[76:79], a[188:191], v[140:143]
    s_waitcnt vmcnt(14)
    v_mfma_f32_16x16x32_bf16 v[64:67], a[80:83], a[192:195], v[64:67]
    s_add_u32 s18, s72, 282624
    buffer_load_dwordx4 v[248:251], v184, s[40:43], s18 offen
    v_mfma_f32_16x16x32_bf16 v[84:87], a[80:83], a[196:199], v[84:87]
    v_mfma_f32_16x16x32_bf16 v[104:107], a[80:83], a[200:203], v[104:107]
    s_add_u32 s19, s70, 4096
    buffer_load_dwordx4 a[224:227], v185, s[40:43], s19 offen offset:0
    v_mfma_f32_16x16x32_bf16 v[124:127], a[80:83], a[204:207], v[124:127]
    v_mfma_f32_16x16x32_bf16 v[68:71], a[84:87], a[192:195], v[68:71]
    buffer_load_dwordx4 a[228:231], v185, s[40:43], s19 offen offset:256
    v_mfma_f32_16x16x32_bf16 v[88:91], a[84:87], a[196:199], v[88:91]
    v_mfma_f32_16x16x32_bf16 v[108:111], a[84:87], a[200:203], v[108:111]
    s_add_u32 s19, s19, 139264
    buffer_load_dwordx4 a[232:235], v185, s[40:43], s19 offen offset:0
    v_mfma_f32_16x16x32_bf16 v[128:131], a[84:87], a[204:207], v[128:131]
    v_mfma_f32_16x16x32_bf16 v[72:75], a[88:91], a[192:195], v[72:75]
    buffer_load_dwordx4 a[236:239], v185, s[40:43], s19 offen offset:256
    v_mfma_f32_16x16x32_bf16 v[92:95], a[88:91], a[196:199], v[92:95]
    v_mfma_f32_16x16x32_bf16 v[112:115], a[88:91], a[200:203], v[112:115]
    s_add_u32 s19, s70, 6144
    buffer_load_dwordx4 a[240:243], v185, s[40:43], s19 offen offset:0
    v_mfma_f32_16x16x32_bf16 v[132:135], a[88:91], a[204:207], v[132:135]
    v_mfma_f32_16x16x32_bf16 v[76:79], a[92:95], a[192:195], v[76:79]
    v_mfma_f32_16x16x32_bf16 v[96:99], a[92:95], a[196:199], v[96:99]
    v_mfma_f32_16x16x32_bf16 v[116:119], a[92:95], a[200:203], v[116:119]
    v_mfma_f32_16x16x32_bf16 v[136:139], a[92:95], a[204:207], v[136:139]
    v_mfma_f32_16x16x32_bf16 v[80:83], a[96:99], a[192:195], v[80:83]
    v_mfma_f32_16x16x32_bf16 v[100:103], a[96:99], a[196:199], v[100:103]
    v_mfma_f32_16x16x32_bf16 v[120:123], a[96:99], a[200:203], v[120:123]
    v_mfma_f32_16x16x32_bf16 v[140:143], a[96:99], a[204:207], v[140:143]
    s_waitcnt vmcnt(16)
    v_mfma_f32_16x16x32_bf16 v[64:67], a[100:103], a[208:211], v[64:67]
    buffer_load_dwordx4 a[244:247], v185, s[40:43], s19 offen offset:256
    v_mfma_f32_16x16x32_bf16 v[84:87], a[100:103], a[212:215], v[84:87]
    v_mfma_f32_16x16x32_bf16 v[104:107], a[100:103], a[216:219], v[104:107]
    s_add_u32 s19, s19, 139264
    buffer_load_dwordx4 a[248:251], v185, s[40:43], s19 offen offset:0
    v_mfma_f32_16x16x32_bf16 v[124:127], a[100:103], a[220:223], v[124:127]
    v_mfma_f32_16x16x32_bf16 v[68:71], a[104:107], a[208:211], v[68:71]
    buffer_load_dwordx4 a[252:255], v185, s[40:43], s19 offen offset:256
    v_mfma_f32_16x16x32_bf16 v[88:91], a[104:107], a[212:215], v[88:91]
    v_mfma_f32_16x16x32_bf16 v[108:111], a[104:107], a[216:219], v[108:111]
    s_add_u32 s19, s70, 8192
    buffer_load_dwordx4 a[128:131], v185, s[40:43], s19 offen offset:0
    v_mfma_f32_16x16x32_bf16 v[128:131], a[104:107], a[220:223], v[128:131]
    v_mfma_f32_16x16x32_bf16 v[72:75], a[108:111], a[208:211], v[72:75]
    buffer_load_dwordx4 a[132:135], v185, s[40:43], s19 offen offset:256
    v_mfma_f32_16x16x32_bf16 v[92:95], a[108:111], a[212:215], v[92:95]
    v_mfma_f32_16x16x32_bf16 v[112:115], a[108:111], a[216:219], v[112:115]
    s_add_u32 s19, s19, 139264
    buffer_load_dwordx4 a[136:139], v185, s[40:43], s19 offen offset:0
    v_mfma_f32_16x16x32_bf16 v[132:135], a[108:111], a[220:223], v[132:135]
    v_mfma_f32_16x16x32_bf16 v[76:79], a[112:115], a[208:211], v[76:79]
    s_mul_i32 s18, s64, 5440
    v_lshrrev_b32 v20, 4, v0
    v_lshl_add_u32 v159, v20, 4, v186
    v_add_u32 v20, 0, v0
    v_mul_u32_u24 v21, 3277, v20
    v_lshrrev_b32 v21, 16, v21
    v_mfma_f32_16x16x32_bf16 v[96:99], a[112:115], a[212:215], v[96:99]
    v_mfma_f32_16x16x32_bf16 v[116:119], a[112:115], a[216:219], v[116:119]
    v_mul_u32_u24 v22, 20, v21
    v_sub_u32 v22, v20, v22
    v_mul_u32_u24 v154, 1280, v21
    v_lshl_add_u32 v154, v22, 3, v154
    v_mul_u32_u24 v22, 272, v22
    v_lshl_add_u32 v22, v21, 4, v22
    v_mfma_f32_16x16x32_bf16 v[136:139], a[112:115], a[220:223], v[136:139]
    v_mfma_f32_16x16x32_bf16 v[80:83], a[116:119], a[208:211], v[80:83]
    v_add_u32 v144, s18, v22
    v_add_u32 v149, 81920, v144
    v_add_u32 v20, 64, v0
    v_mul_u32_u24 v21, 3277, v20
    v_lshrrev_b32 v21, 16, v21
    v_mul_u32_u24 v22, 20, v21
    v_mfma_f32_16x16x32_bf16 v[100:103], a[116:119], a[212:215], v[100:103]
    v_mfma_f32_16x16x32_bf16 v[120:123], a[116:119], a[216:219], v[120:123]
    v_sub_u32 v22, v20, v22
    v_mul_u32_u24 v155, 1280, v21
    v_lshl_add_u32 v155, v22, 3, v155
    v_mul_u32_u24 v22, 272, v22
    v_lshl_add_u32 v22, v21, 4, v22
    v_add_u32 v145, s18, v22
    v_mfma_f32_16x16x32_bf16 v[140:143], a[116:119], a[220:223], v[140:143]
    v_add_u32 v150, 81920, v145
    v_add_u32 v20, 128, v0
    v_mul_u32_u24 v21, 3277, v20
    v_lshrrev_b32 v21, 16, v21
    v_mul_u32_u24 v22, 20, v21
    v_sub_u32 v22, v20, v22
    v_mul_u32_u24 v156, 1280, v21
    v_lshl_add_u32 v156, v22, 3, v156
    v_mul_u32_u24 v22, 272, v22
    v_lshl_add_u32 v22, v21, 4, v22
    v_add_u32 v146, s18, v22
    v_add_u32 v151, 81920, v146
    v_add_u32 v20, 192, v0
    v_mul_u32_u24 v21, 3277, v20
    v_lshrrev_b32 v21, 16, v21
    v_mul_u32_u24 v22, 20, v21
    v_sub_u32 v22, v20, v22
    v_mul_u32_u24 v157, 1280, v21
    v_lshl_add_u32 v157, v22, 3, v157
    v_mul_u32_u24 v22, 272, v22
    v_lshl_add_u32 v22, v21, 4, v22
    v_add_u32 v147, s18, v22
    v_add_u32 v152, 81920, v147
    v_add_u32 v20, 256, v0
    v_mul_u32_u24 v21, 3277, v20
    v_lshrrev_b32 v21, 16, v21
    v_mul_u32_u24 v22, 20, v21
    v_sub_u32 v22, v20, v22
    v_mul_u32_u24 v158, 1280, v21
    v_lshl_add_u32 v158, v22, 3, v158
    v_mul_u32_u24 v22, 272, v22
    v_lshl_add_u32 v22, v21, 4, v22
    v_add_u32 v148, s18, v22
    v_add_u32 v153, 81920, v148
    s_waitcnt vmcnt(7)
    v_mfma_f32_16x16x32_bf16 v[64:67], v[192:195], a[224:227], v[64:67]
    buffer_load_dwordx4 a[140:143], v185, s[40:43], s19 offen offset:256
    v_mfma_f32_16x16x32_bf16 v[84:87], v[192:195], a[228:231], v[84:87]
    v_mfma_f32_16x16x32_bf16 v[104:107], v[192:195], a[232:235], v[104:107]
    buffer_load_dwordx2 v[10:11], v154, s[24:27], s3 offen
    v_mfma_f32_16x16x32_bf16 v[124:127], v[192:195], a[236:239], v[124:127]
    v_mfma_f32_16x16x32_bf16 v[68:71], v[196:199], a[224:227], v[68:71]
    buffer_load_dwordx2 v[12:13], v155, s[24:27], s3 offen
    v_mfma_f32_16x16x32_bf16 v[88:91], v[196:199], a[228:231], v[88:91]
    v_mfma_f32_16x16x32_bf16 v[108:111], v[196:199], a[232:235], v[108:111]
    buffer_load_dwordx2 v[14:15], v156, s[24:27], s3 offen
    v_mfma_f32_16x16x32_bf16 v[128:131], v[196:199], a[236:239], v[128:131]
    v_mfma_f32_16x16x32_bf16 v[72:75], v[200:203], a[224:227], v[72:75]
    buffer_load_dwordx2 v[16:17], v157, s[24:27], s3 offen
    v_mfma_f32_16x16x32_bf16 v[92:95], v[200:203], a[228:231], v[92:95]
    v_mfma_f32_16x16x32_bf16 v[112:115], v[200:203], a[232:235], v[112:115]
    buffer_load_dwordx2 v[18:19], v158, s[24:27], s3 offen
    v_mfma_f32_16x16x32_bf16 v[132:135], v[200:203], a[236:239], v[132:135]
    v_mfma_f32_16x16x32_bf16 v[76:79], v[204:207], a[224:227], v[76:79]
    v_mfma_f32_16x16x32_bf16 v[96:99], v[204:207], a[228:231], v[96:99]
    v_mfma_f32_16x16x32_bf16 v[116:119], v[204:207], a[232:235], v[116:119]
    v_mfma_f32_16x16x32_bf16 v[136:139], v[204:207], a[236:239], v[136:139]
    v_mfma_f32_16x16x32_bf16 v[80:83], v[208:211], a[224:227], v[80:83]
    v_mfma_f32_16x16x32_bf16 v[100:103], v[208:211], a[228:231], v[100:103]
    v_mfma_f32_16x16x32_bf16 v[120:123], v[208:211], a[232:235], v[120:123]
    v_mfma_f32_16x16x32_bf16 v[140:143], v[208:211], a[236:239], v[140:143]
    s_waitcnt vmcnt(9)
    v_mfma_f32_16x16x32_bf16 v[64:67], v[212:215], a[240:243], v[64:67]
    v_mfma_f32_16x16x32_bf16 v[84:87], v[212:215], a[244:247], v[84:87]
    v_mfma_f32_16x16x32_bf16 v[104:107], v[212:215], a[248:251], v[104:107]
    v_mfma_f32_16x16x32_bf16 v[124:127], v[212:215], a[252:255], v[124:127]
    v_mfma_f32_16x16x32_bf16 v[68:71], v[216:219], a[240:243], v[68:71]
    v_mfma_f32_16x16x32_bf16 v[88:91], v[216:219], a[244:247], v[88:91]
    v_mfma_f32_16x16x32_bf16 v[108:111], v[216:219], a[248:251], v[108:111]
    v_mfma_f32_16x16x32_bf16 v[128:131], v[216:219], a[252:255], v[128:131]
    v_mfma_f32_16x16x32_bf16 v[72:75], v[220:223], a[240:243], v[72:75]
    v_mfma_f32_16x16x32_bf16 v[92:95], v[220:223], a[244:247], v[92:95]
    v_mfma_f32_16x16x32_bf16 v[112:115], v[220:223], a[248:251], v[112:115]
    v_mfma_f32_16x16x32_bf16 v[132:135], v[220:223], a[252:255], v[132:135]
    v_mfma_f32_16x16x32_bf16 v[76:79], v[224:227], a[240:243], v[76:79]
    v_mfma_f32_16x16x32_bf16 v[96:99], v[224:227], a[244:247], v[96:99]
    v_mfma_f32_16x16x32_bf16 v[116:119], v[224:227], a[248:251], v[116:119]
    v_mfma_f32_16x16x32_bf16 v[136:139], v[224:227], a[252:255], v[136:139]
    v_mfma_f32_16x16x32_bf16 v[80:83], v[228:231], a[240:243], v[80:83]
    v_mfma_f32_16x16x32_bf16 v[100:103], v[228:231], a[244:247], v[100:103]
    v_mfma_f32_16x16x32_bf16 v[120:123], v[228:231], a[248:251], v[120:123]
    v_mfma_f32_16x16x32_bf16 v[140:143], v[228:231], a[252:255], v[140:143]
    s_waitcnt vmcnt(5)
    v_mfma_f32_16x16x32_bf16 v[64:67], v[232:235], a[128:131], v[64:67]
    v_mfma_f32_16x16x32_bf16 v[68:71], v[236:239], a[128:131], v[68:71]
    v_mfma_f32_16x16x32_bf16 v[72:75], v[240:243], a[128:131], v[72:75]
    v_mfma_f32_16x16x32_bf16 v[76:79], v[244:247], a[128:131], v[76:79]
    v_mfma_f32_16x16x32_bf16 v[80:83], v[248:251], a[128:131], v[80:83]
    v_mfma_f32_16x16x32_bf16 v[84:87], v[232:235], a[132:135], v[84:87]
    s_nop 2
    ds_write_b128 v159, v[64:67] offset:0
    v_mfma_f32_16x16x32_bf16 v[88:91], v[236:239], a[132:135], v[88:91]
    ds_write_b128 v159, v[68:71] offset:1088
    v_mfma_f32_16x16x32_bf16 v[92:95], v[240:243], a[132:135], v[92:95]
    ds_write_b128 v159, v[72:75] offset:2176
    v_mfma_f32_16x16x32_bf16 v[96:99], v[244:247], a[132:135], v[96:99]
    ds_write_b128 v159, v[76:79] offset:3264
    v_mfma_f32_16x16x32_bf16 v[100:103], v[248:251], a[132:135], v[100:103]
    ds_write_b128 v159, v[80:83] offset:4352
    v_mfma_f32_16x16x32_bf16 v[104:107], v[232:235], a[136:139], v[104:107]
    ds_write_b128 v159, v[84:87] offset:5440
    v_mfma_f32_16x16x32_bf16 v[108:111], v[236:239], a[136:139], v[108:111]
    ds_write_b128 v159, v[88:91] offset:6528
    v_mfma_f32_16x16x32_bf16 v[112:115], v[240:243], a[136:139], v[112:115]
    ds_write_b128 v159, v[92:95] offset:7616
    v_mfma_f32_16x16x32_bf16 v[116:119], v[244:247], a[136:139], v[116:119]
    ds_write_b128 v159, v[96:99] offset:8704
    v_mfma_f32_16x16x32_bf16 v[120:123], v[248:251], a[136:139], v[120:123]
    ds_write_b128 v159, v[100:103] offset:9792
    v_mfma_f32_16x16x32_bf16 v[124:127], v[232:235], a[140:143], v[124:127]
    ds_write_b128 v159, v[104:107] offset:10880
    v_mfma_f32_16x16x32_bf16 v[128:131], v[236:239], a[140:143], v[128:131]
    ds_write_b128 v159, v[108:111] offset:11968
    v_mfma_f32_16x16x32_bf16 v[132:135], v[240:243], a[140:143], v[132:135]
    ds_write_b128 v159, v[112:115] offset:13056
    v_mfma_f32_16x16x32_bf16 v[136:139], v[244:247], a[140:143], v[136:139]
    ds_write_b128 v159, v[116:119] offset:14144
    v_mfma_f32_16x16x32_bf16 v[140:143], v[248:251], a[140:143], v[140:143]
    ds_write_b128 v159, v[120:123] offset:15232
    ds_write_b128 v159, v[124:127] offset:16320
    ds_write_b128 v159, v[128:131] offset:17408
    s_nop 0
    ds_write_b128 v159, v[132:135] offset:18496
    s_nop 0
    ds_write_b128 v159, v[136:139] offset:19584
    s_nop 0
    ds_write_b128 v159, v[140:143] offset:20672
    s_waitcnt vmcnt(0)
    v_lshlrev_b32 v24, 16, v10
    v_and_b32 v25, 0xffff0000, v10
    v_lshlrev_b32 v26, 16, v11
    v_and_b32 v27, 0xffff0000, v11
    v_lshlrev_b32 v28, 16, v12
    v_and_b32 v29, 0xffff0000, v12
    v_lshlrev_b32 v30, 16, v13
    v_and_b32 v31, 0xffff0000, v13
    v_lshlrev_b32 v32, 16, v14
    v_and_b32 v33, 0xffff0000, v14
    v_lshlrev_b32 v34, 16, v15
    v_and_b32 v35, 0xffff0000, v15
    v_lshlrev_b32 v36, 16, v16
    v_and_b32 v37, 0xffff0000, v16
    v_lshlrev_b32 v38, 16, v17
    v_and_b32 v39, 0xffff0000, v17
    v_lshlrev_b32 v40, 16, v18
    v_and_b32 v41, 0xffff0000, v18
    v_lshlrev_b32 v42, 16, v19
    v_and_b32 v43, 0xffff0000, v19
    s_waitcnt lgkmcnt(0)
    s_barrier
    ds_read_b128 v[64:67], v144 offset:0
    ds_read_b128 v[68:71], v144 offset:40960
    ds_read_b128 v[72:75], v149 offset:0
    ds_read_b128 v[76:79], v149 offset:40960
    ds_read_b128 v[80:83], v145 offset:0
    ds_read_b128 v[84:87], v145 offset:40960
    ds_read_b128 v[88:91], v150 offset:0
    ds_read_b128 v[92:95], v150 offset:40960
    ds_read_b128 v[96:99], v146 offset:0
    ds_read_b128 v[100:103], v146 offset:40960
    ds_read_b128 v[104:107], v151 offset:0
    ds_read_b128 v[108:111], v151 offset:40960
    ds_read_b128 v[112:115], v147 offset:0
    ds_read_b128 v[116:119], v147 offset:40960
    ds_read_b128 v[120:123], v152 offset:0
    ds_read_b128 v[124:127], v152 offset:40960
    ds_read_b128 v[128:131], v148 offset:0
    ds_read_b128 v[132:135], v148 offset:40960
    ds_read_b128 v[136:139], v153 offset:0
    ds_read_b128 v[140:143], v153 offset:40960
    s_waitcnt lgkmcnt(15)
    v_add_f32 v24, v24, v64
    v_add_f32 v25, v25, v65
    v_add_f32 v26, v26, v66
    v_add_f32 v27, v27, v67
    v_add_f32 v24, v24, v68
    v_add_f32 v25, v25, v69
    v_add_f32 v26, v26, v70
    v_add_f32 v27, v27, v71
    v_add_f32 v24, v24, v72
    v_add_f32 v25, v25, v73
    v_add_f32 v26, v26, v74
    v_add_f32 v27, v27, v75
    v_add_f32 v24, v24, v76
    v_add_f32 v25, v25, v77
    v_add_f32 v26, v26, v78
    v_add_f32 v27, v27, v79
    v_cvt_pk_bf16_f32 v24, v24, v25
    v_cvt_pk_bf16_f32 v25, v26, v27
    buffer_store_dwordx2 v[24:25], v154, s[52:55], s3 offen sc0 sc1
    v_add_f32 v28, v28, v80
    v_add_f32 v29, v29, v81
    v_add_f32 v30, v30, v82
    v_add_f32 v31, v31, v83
    s_waitcnt lgkmcnt(14)
    v_add_f32 v28, v28, v84
    v_add_f32 v29, v29, v85
    v_add_f32 v30, v30, v86
    v_add_f32 v31, v31, v87
    s_waitcnt lgkmcnt(13)
    v_add_f32 v28, v28, v88
    v_add_f32 v29, v29, v89
    v_add_f32 v30, v30, v90
    v_add_f32 v31, v31, v91
    s_waitcnt lgkmcnt(12)
    v_add_f32 v28, v28, v92
    v_add_f32 v29, v29, v93
    v_add_f32 v30, v30, v94
    v_add_f32 v31, v31, v95
    v_cvt_pk_bf16_f32 v28, v28, v29
    v_cvt_pk_bf16_f32 v29, v30, v31
    buffer_store_dwordx2 v[28:29], v155, s[52:55], s3 offen sc0 sc1
    s_waitcnt lgkmcnt(11)
    v_add_f32 v32, v32, v96
    v_add_f32 v33, v33, v97
    v_add_f32 v34, v34, v98
    v_add_f32 v35, v35, v99
    s_waitcnt lgkmcnt(10)
    v_add_f32 v32, v32, v100
    v_add_f32 v33, v33, v101
    v_add_f32 v34, v34, v102
    v_add_f32 v35, v35, v103
    s_waitcnt lgkmcnt(9)
    v_add_f32 v32, v32, v104
    v_add_f32 v33, v33, v105
    v_add_f32 v34, v34, v106
    v_add_f32 v35, v35, v107
    s_waitcnt lgkmcnt(8)
    v_add_f32 v32, v32, v108
    v_add_f32 v33, v33, v109
    v_add_f32 v34, v34, v110
    v_add_f32 v35, v35, v111
    v_cvt_pk_bf16_f32 v32, v32, v33
    v_cvt_pk_bf16_f32 v33, v34, v35
    buffer_store_dwordx2 v[32:33], v156, s[52:55], s3 offen sc0 sc1
    s_waitcnt lgkmcnt(7)
    v_add_f32 v36, v36, v112
    v_add_f32 v37, v37, v113
    v_add_f32 v38, v38, v114
    v_add_f32 v39, v39, v115
    s_waitcnt lgkmcnt(6)
    v_add_f32 v36, v36, v116
    v_add_f32 v37, v37, v117
    v_add_f32 v38, v38, v118
    v_add_f32 v39, v39, v119
    s_waitcnt lgkmcnt(5)
    v_add_f32 v36, v36, v120
    v_add_f32 v37, v37, v121
    v_add_f32 v38, v38, v122
    v_add_f32 v39, v39, v123
    s_waitcnt lgkmcnt(4)
    v_add_f32 v36, v36, v124
    v_add_f32 v37, v37, v125
    v_add_f32 v38, v38, v126
    v_add_f32 v39, v39, v127
    v_cvt_pk_bf16_f32 v36, v36, v37
    v_cvt_pk_bf16_f32 v37, v38, v39
    buffer_store_dwordx2 v[36:37], v157, s[52:55], s3 offen sc0 sc1
    s_waitcnt lgkmcnt(3)
    v_add_f32 v40, v40, v128
    v_add_f32 v41, v41, v129
    v_add_f32 v42, v42, v130
    v_add_f32 v43, v43, v131
    s_waitcnt lgkmcnt(2)
    v_add_f32 v40, v40, v132
    v_add_f32 v41, v41, v133
    v_add_f32 v42, v42, v134
    v_add_f32 v43, v43, v135
    s_waitcnt lgkmcnt(1)
    v_add_f32 v40, v40, v136
    v_add_f32 v41, v41, v137
    v_add_f32 v42, v42, v138
    v_add_f32 v43, v43, v139
    s_waitcnt lgkmcnt(0)
    v_add_f32 v40, v40, v140
    v_add_f32 v41, v41, v141
    v_add_f32 v42, v42, v142
    v_add_f32 v43, v43, v143
    v_cvt_pk_bf16_f32 v40, v40, v41
    v_cvt_pk_bf16_f32 v41, v42, v43
    buffer_store_dwordx2 v[40:41], v158, s[52:55], s3 offen sc0 sc1
L_end:
    s_endpgm
L_codeend:
.section .rodata,"a"
.p2align 6
.amdhsa_kernel parallel_sum__sliding_block__glu_gated_glu__prompt_kernel
  .amdhsa_next_free_vgpr 512
  .amdhsa_next_free_sgpr 102
  .amdhsa_accum_offset 256
  .amdhsa_group_segment_fixed_size 0
  .amdhsa_kernarg_size 80
  .amdhsa_user_sgpr_count 2
  .amdhsa_user_sgpr_kernarg_segment_ptr 1
  .amdhsa_system_sgpr_workgroup_id_x 1
.end_amdhsa_kernel
```
